```python
import torch

def _softmax(x, axis=-1):
    return torch.softmax(x, dim=axis)

def _gelu(x):
    return torch.nn.functional.gelu(x, approximate='tanh')

def _silu(x):
    return torch.nn.functional.silu(x)

def _sigmoid(x):
    return torch.sigmoid(x)

def _layernorm(x, axis=-1, eps=1e-05):
    m = x.mean(dim=axis, keepdim=True)
    v = x.var(dim=axis, keepdim=True, unbiased=False)
    return (x - m) / torch.sqrt(v + eps)

def _scatter_add(tgt, idx, src, axis=0):
    return tgt.clone().index_add_(axis, idx, src)

def _segment_sum(src, seg, n):
    out = torch.zeros((n,) + src.shape[1:], dtype=src.dtype)
    return out.index_add_(0, seg, src)

def _pad(x, pw):
    flat = tuple((v for pair in reversed(pw) for v in pair))
    return torch.nn.functional.pad(x, flat)
kernel_name = 'adaLN_cond__gqa_block_cached__moe_arch_mod__prompt'

def setup_inputs():

    _w = lambda a: (lambda t: t.to(torch.bfloat16) if t.is_floating_point() else t)(torch.as_tensor(a))

    def _A_setup():
        B, Sq, D = (1, 2048, 448)
        Hq, Hkv, Sk, Dh = (16, 8, 2048, 256)
        assert Hq % Hkv == 0, (Hq, Hkv)
        return {'x': _w((lambda *s: torch.randn(*s, dtype=torch.bfloat16) * 0.05)(B, Sq, D)), 'k_cache': _w((lambda *s: torch.randn(*s, dtype=torch.bfloat16) * 3.2)(B, Hkv, Sk, Dh)), 'v_cache': _w((lambda *s: torch.randn(*s, dtype=torch.bfloat16) * 0.4)(B, Hkv, Sk, Dh)), 'wq': _w((lambda *s: torch.randn(*s, dtype=torch.bfloat16) * 3.2)(D, Hq * Dh) * D ** (-0.5)), 'wo': _w((lambda *s: torch.randn(*s, dtype=torch.bfloat16) * 0.4)(Hq * Dh, D) * (Hq * Dh) ** (-0.5))}
    _A_in = _A_setup()

    def _B_setup():
        B, S, D, F, C = (1, 2048, 448, 1792, 1)
        return {'x': _w((lambda *s: torch.randn(*s, dtype=torch.bfloat16) * 0.05)(B, S, D)), 'w_r': _w((lambda *s: torch.randn(*s, dtype=torch.bfloat16) * 3.2)(D)), 'w_gate': _w((lambda *s: torch.randn(*s, dtype=torch.bfloat16) * 0.1)(D, F)), 'w_up': _w((lambda *s: torch.randn(*s, dtype=torch.bfloat16) * 0.1)(D, F)), 'w_down': _w((lambda *s: torch.randn(*s, dtype=torch.bfloat16) * 0.1)(F, D))}
    _B_in = _B_setup()
    return {'A_x': _A_in['x'], 'A_k_cache': _A_in['k_cache'], 'A_v_cache': _A_in['v_cache'], 'A_wq': _A_in['wq'], 'A_wo': _A_in['wo'], 'B_x': _B_in['x'], 'B_w_r': _B_in['w_r'], 'B_w_gate': _B_in['w_gate'], 'B_w_up': _B_in['w_up'], 'B_w_down': _B_in['w_down'], 'c': _w((lambda *s: torch.randn(*s, dtype=torch.bfloat16) * 0.1)(1, 448) * 8.0), 'w_mod': _w((lambda *s: torch.randn(*s, dtype=torch.bfloat16) * 0.1)(448, 6 * 448) * 448 ** (-0.5) * 8.0)}

def reference(A_x, A_k_cache, A_v_cache, A_wq, A_wo, B_x, B_w_r, B_w_gate, B_w_up, B_w_down, c, w_mod):

    def _A_ref(x, k_cache, v_cache, wq, wo):
        B, Sq, D = x.shape
        Hq, Dh = (16, 256)
        Hkv = k_cache.shape[1]
        rep = Hq // Hkv
        q = (lambda x, *d: x.permute(*d))((x @ wq).reshape(B, Sq, Hq, Dh), 0, 2, 1, 3)
        k = (lambda x, n, axis: torch.repeat_interleave(x, n, dim=axis))(k_cache, rep, axis=1)
        v = (lambda x, n, axis: torch.repeat_interleave(x, n, dim=axis))(v_cache, rep, axis=1)
        scores = torch.einsum('bhqd,bhkd->bhqk', q, k) * Dh ** (-0.5)
        p = _softmax(scores, axis=-1)
        o = torch.einsum('bhqk,bhkd->bhqd', p, v)
        return (lambda x, *d: x.permute(*d))(o, 0, 2, 1, 3).reshape(B, Sq, Hq * Dh) @ wo

    def _B_ref(x, w_r, w_gate, w_up, w_down):
        B, S, D = x.shape
        C = 1
        r = x @ w_r
        idx = torch.argsort(-r, axis=-1)[:, :C]
        idx_e = (lambda x, n, axis: torch.repeat_interleave(x, n, dim=axis))(idx.reshape(B, C, 1), D, axis=2)
        x_sel = (lambda x, i, axis: torch.take_along_dim(x, i, dim=axis))(x, idx_e, axis=1)
        g = _silu(x_sel @ w_gate)
        u = x_sel @ w_up
        y = g * u @ w_down
        r_sel = _sigmoid((lambda x, i, axis: torch.take_along_dim(x, i, dim=axis))(r, idx, axis=1))
        y = y * r_sel.reshape(B, C, 1)
        b_off = (torch.arange(B) * S).reshape(B, 1)
        flat_idx = (idx + b_off).reshape(B * C)
        zero = (x * 0.0).reshape(B * S, D)
        upd = _scatter_add(zero, flat_idx, y.reshape(B * C, D), axis=0)
        return x + upd.reshape(B, S, D)
    x = A_x
    mod = (_silu(c) @ w_mod).reshape(c.shape[0], 6, 1, -1)
    sa, ca, ga, sb, cb, gb = (mod[:, 0].clone(), mod[:, 1].clone(), mod[:, 2].clone(), mod[:, 3].clone(), mod[:, 4].clone(), mod[:, 5].clone())
    h = _layernorm(x, axis=-1) * (1 + ca) + sa
    x = x + ga * _A_ref(h, A_k_cache, A_v_cache, A_wq, A_wo)
    h = _layernorm(x, axis=-1) * (1 + cb) + sb
    x = x + gb * _B_ref(h, B_w_r, B_w_gate, B_w_up, B_w_down)
    return x
```

```asm
; @launch kernel=adaLN_cond__gqa_block_cached__moe_arch_mod__prompt_kernel grid=(256,1,1) block=(256,1,1) lds=163840
; @launch kernel=k2_kernel grid=(256,1,1) block=(256,1,1) lds=24576
.amdgcn_target "amdgcn-amd-amdhsa--gfx950"
.text
.globl adaLN_cond__gqa_block_cached__moe_arch_mod__prompt_kernel
.p2align 8
.type adaLN_cond__gqa_block_cached__moe_arch_mod__prompt_kernel,@function
adaLN_cond__gqa_block_cached__moe_arch_mod__prompt_kernel:
    s_cmp_ge_u32 s2, 256
    s_cbranch_scc1 K1_END
    s_load_dwordx2 s[4:5], s[0:1], 0
    s_load_dwordx2 s[8:9], s[0:1], 8
    s_load_dwordx2 s[12:13], s[0:1], 16
    s_load_dwordx2 s[16:17], s[0:1], 24
    s_load_dwordx2 s[20:21], s[0:1], 32
    s_load_dwordx2 s[24:25], s[0:1], 112
    s_load_dwordx2 s[48:49], s[0:1], 88
    s_load_dwordx2 s[52:53], s[0:1], 80
    s_load_dwordx2 s[56:57], s[0:1], 104
    v_lshrrev_b32 v1, 6, v0
    v_and_b32 v2, 63, v0
    s_nop 0
    v_readfirstlane_b32 s30, v1
    s_and_b32 s28, s2, 7
    s_lshr_b32 s29, s2, 3
    v_lshrrev_b32 v3, 4, v2
    v_and_b32 v4, 15, v2
    s_nop 2
    s_and_b32 s31, s30, 1
    s_lshr_b32 s32, s30, 1
    s_lshl_b32 s44, s30, 13
    s_lshl_b32 s33, s28, 20
    s_mov_b32 s34, s33
    s_mov_b32 s41, 0xc2800000
    s_waitcnt lgkmcnt(0)
    s_and_b32 s5, s5, 0xffff
    s_mov_b32 s6, 1835008
    s_mov_b32 s7, 0x00020000
    s_and_b32 s9, s9, 0xffff
    s_mov_b32 s10, 8388608
    s_mov_b32 s11, 0x00020000
    s_and_b32 s13, s13, 0xffff
    s_mov_b32 s14, 8388608
    s_mov_b32 s15, 0x00020000
    s_and_b32 s17, s17, 0xffff
    s_mov_b32 s18, 3670016
    s_mov_b32 s19, 0x00020000
    s_and_b32 s21, s21, 0xffff
    s_mov_b32 s22, 3670016
    s_mov_b32 s23, 0x00020000
    s_and_b32 s25, s25, 0xffff
    s_mov_b32 s26, 18874368
    s_mov_b32 s27, 0x00020000
    s_and_b32 s49, s49, 0xffff
    s_mov_b32 s50, 2408448
    s_mov_b32 s51, 0x00020000
    s_and_b32 s53, s53, 0xffff
    s_mov_b32 s54, 896
    s_mov_b32 s55, 0x00020000
    s_and_b32 s57, s57, 0xffff
    s_mov_b32 s58, 256
    s_mov_b32 s59, 0x00020000
    s_lshl_b32 s35, s30, 16
    s_lshl_b32 s36, s31, 3
    v_xor_b32 v6, s36, v2
    v_xor_b32 v24, 0, v6
    v_lshlrev_b32 v24, 4, v24
    v_add_u32 v24, 0, v24
    v_add_u32 v24, s35, v24
    v_xor_b32 v25, 2, v6
    v_lshlrev_b32 v25, 4, v25
    v_add_u32 v25, 7168, v25
    v_add_u32 v25, s35, v25
    v_xor_b32 v26, 4, v6
    v_lshlrev_b32 v26, 4, v26
    v_add_u32 v26, 14336, v26
    v_add_u32 v26, s35, v26
    v_xor_b32 v27, 6, v6
    v_lshlrev_b32 v27, 4, v27
    v_add_u32 v27, 21504, v27
    v_add_u32 v27, s35, v27
    s_lshl_b32 s37, s28, 10
    v_mov_b32 v6, 0
    buffer_load_dword v30, v6, s[24:27], 0 offen sc0 sc1
    buffer_load_dword v31, v6, s[56:59], 0 offen sc0 sc1
    s_cmp_lg_u32 s2, 100
    s_cbranch_scc1 NOZERO
    v_lshlrev_b32 v6, 5, v0
    v_mov_b32 v32, 0
    v_mov_b32 v33, 0
    v_mov_b32 v34, 0
    v_mov_b32 v35, 0
    s_mov_b32 s3, 16384
    buffer_store_dwordx4 v[32:35], v6, s[24:27], s3 offen
    buffer_store_dwordx4 v[32:35], v6, s[24:27], s3 offen offset:16
NOZERO:
    s_cmp_ge_u32 s2, 42
    s_cbranch_scc1 NOPROD1
    v_and_b32 v6, 7, v0
    v_lshrrev_b32 v7, 3, v0
    s_lshl_b32 s3, s2, 7
    v_mul_u32_u24 v28, 14*5376, v7
    v_lshl_add_u32 v28, v6, 4, v28
    v_mul_u32_u24 v29, 28, v7
    buffer_load_ushort v112, v29, s[52:55], 0 offen offset:0
    buffer_load_ushort v113, v29, s[52:55], 0 offen offset:2
    buffer_load_ushort v114, v29, s[52:55], 0 offen offset:4
    buffer_load_ushort v115, v29, s[52:55], 0 offen offset:6
    buffer_load_ushort v116, v29, s[52:55], 0 offen offset:8
    buffer_load_ushort v117, v29, s[52:55], 0 offen offset:10
    buffer_load_ushort v118, v29, s[52:55], 0 offen offset:12
    buffer_load_ushort v119, v29, s[52:55], 0 offen offset:14
    buffer_load_ushort v120, v29, s[52:55], 0 offen offset:16
    buffer_load_ushort v121, v29, s[52:55], 0 offen offset:18
    buffer_load_ushort v122, v29, s[52:55], 0 offen offset:20
    buffer_load_ushort v123, v29, s[52:55], 0 offen offset:22
    buffer_load_ushort v124, v29, s[52:55], 0 offen offset:24
    buffer_load_ushort v125, v29, s[52:55], 0 offen offset:26
    buffer_load_dwordx4 v[32:35], v28, s[48:51], s3 offen
    s_add_u32 s3, s3, 5376
    buffer_load_dwordx4 v[36:39], v28, s[48:51], s3 offen
    s_add_u32 s3, s3, 5376
    buffer_load_dwordx4 v[40:43], v28, s[48:51], s3 offen
    s_add_u32 s3, s3, 5376
    buffer_load_dwordx4 v[44:47], v28, s[48:51], s3 offen
    s_add_u32 s3, s3, 5376
    buffer_load_dwordx4 v[48:51], v28, s[48:51], s3 offen
    s_add_u32 s3, s3, 5376
    buffer_load_dwordx4 v[52:55], v28, s[48:51], s3 offen
    s_add_u32 s3, s3, 5376
    buffer_load_dwordx4 v[56:59], v28, s[48:51], s3 offen
    s_add_u32 s3, s3, 5376
    buffer_load_dwordx4 v[60:63], v28, s[48:51], s3 offen
    s_add_u32 s3, s3, 5376
    buffer_load_dwordx4 v[64:67], v28, s[48:51], s3 offen
    s_add_u32 s3, s3, 5376
    buffer_load_dwordx4 v[68:71], v28, s[48:51], s3 offen
    s_add_u32 s3, s3, 5376
    buffer_load_dwordx4 v[72:75], v28, s[48:51], s3 offen
    s_add_u32 s3, s3, 5376
    buffer_load_dwordx4 v[76:79], v28, s[48:51], s3 offen
    s_add_u32 s3, s3, 5376
    buffer_load_dwordx4 v[80:83], v28, s[48:51], s3 offen
    s_add_u32 s3, s3, 5376
    buffer_load_dwordx4 v[84:87], v28, s[48:51], s3 offen
    s_add_u32 s3, s3, 5376
    s_cmp_eq_u32 s30, 0
    s_cbranch_scc1 PW0
NOPROD1:
    s_lshl_b32 s3, s29, 6
    s_lshl_b32 s35, s32, 5
    s_add_u32 s3, s3, s35
    s_mul_i32 s3, s3, 896
    s_add_u32 s35, s3, 16*896
    v_mul_u32_u24 v5, 896, v4
    v_lshl_add_u32 v5, v3, 4, v5
    buffer_load_dwordx4 v[128:131], v5, s[4:7], s3 offen offset:0
    buffer_load_dwordx4 v[132:135], v5, s[4:7], s35 offen offset:0
    buffer_load_dwordx4 v[136:139], v5, s[4:7], s3 offen offset:64
    buffer_load_dwordx4 v[140:143], v5, s[4:7], s35 offen offset:64
    buffer_load_dwordx4 v[144:147], v5, s[4:7], s3 offen offset:128
    buffer_load_dwordx4 v[148:151], v5, s[4:7], s35 offen offset:128
    buffer_load_dwordx4 v[152:155], v5, s[4:7], s3 offen offset:192
    buffer_load_dwordx4 v[156:159], v5, s[4:7], s35 offen offset:192
    buffer_load_dwordx4 v[160:163], v5, s[4:7], s3 offen offset:256
    buffer_load_dwordx4 v[164:167], v5, s[4:7], s35 offen offset:256
    buffer_load_dwordx4 v[168:171], v5, s[4:7], s3 offen offset:320
    buffer_load_dwordx4 v[172:175], v5, s[4:7], s35 offen offset:320
    buffer_load_dwordx4 v[176:179], v5, s[4:7], s3 offen offset:384
    buffer_load_dwordx4 v[180:183], v5, s[4:7], s35 offen offset:384
    buffer_load_dwordx4 v[184:187], v5, s[4:7], s3 offen offset:448
    buffer_load_dwordx4 v[188:191], v5, s[4:7], s35 offen offset:448
    buffer_load_dwordx4 v[192:195], v5, s[4:7], s3 offen offset:512
    buffer_load_dwordx4 v[196:199], v5, s[4:7], s35 offen offset:512
    buffer_load_dwordx4 v[200:203], v5, s[4:7], s3 offen offset:576
    buffer_load_dwordx4 v[204:207], v5, s[4:7], s35 offen offset:576
    buffer_load_dwordx4 v[208:211], v5, s[4:7], s3 offen offset:640
    buffer_load_dwordx4 v[212:215], v5, s[4:7], s35 offen offset:640
    buffer_load_dwordx4 v[216:219], v5, s[4:7], s3 offen offset:704
    buffer_load_dwordx4 v[220:223], v5, s[4:7], s35 offen offset:704
    buffer_load_dwordx4 v[224:227], v5, s[4:7], s3 offen offset:768
    buffer_load_dwordx4 v[228:231], v5, s[4:7], s35 offen offset:768
    buffer_load_dwordx4 v[232:235], v5, s[4:7], s3 offen offset:832
    buffer_load_dwordx4 v[236:239], v5, s[4:7], s35 offen offset:832
    s_add_u32 m0, s44, 131072
    s_add_u32 s38, s37, 32768
    buffer_load_dwordx4 v24, s[16:19], s37 offen offset:0 lds
    buffer_load_dwordx4 v25, s[16:19], s37 offen offset:1024 lds
    buffer_load_dwordx4 v26, s[16:19], s37 offen offset:2048 lds
    buffer_load_dwordx4 v27, s[16:19], s37 offen offset:3072 lds
    s_add_u32 m0, s44, 135168
    s_add_u32 s37, s37, 262144
    buffer_load_dwordx4 v24, s[16:19], s38 offen offset:0 lds
    buffer_load_dwordx4 v25, s[16:19], s38 offen offset:1024 lds
    buffer_load_dwordx4 v26, s[16:19], s38 offen offset:2048 lds
    buffer_load_dwordx4 v27, s[16:19], s38 offen offset:3072 lds
    s_add_u32 m0, s44, 98304
    s_add_u32 s38, s37, 32768
    buffer_load_dwordx4 v24, s[16:19], s37 offen offset:0 lds
    buffer_load_dwordx4 v25, s[16:19], s37 offen offset:1024 lds
    buffer_load_dwordx4 v26, s[16:19], s37 offen offset:2048 lds
    buffer_load_dwordx4 v27, s[16:19], s37 offen offset:3072 lds
    s_add_u32 m0, s44, 102400
    s_add_u32 s37, s37, 262144
    buffer_load_dwordx4 v24, s[16:19], s38 offen offset:0 lds
    buffer_load_dwordx4 v25, s[16:19], s38 offen offset:1024 lds
    buffer_load_dwordx4 v26, s[16:19], s38 offen offset:2048 lds
    buffer_load_dwordx4 v27, s[16:19], s38 offen offset:3072 lds
    s_add_u32 m0, s44, 32768
    s_add_u32 s38, s37, 32768
    buffer_load_dwordx4 v24, s[16:19], s37 offen offset:0 lds
    buffer_load_dwordx4 v25, s[16:19], s37 offen offset:1024 lds
    buffer_load_dwordx4 v26, s[16:19], s37 offen offset:2048 lds
    buffer_load_dwordx4 v27, s[16:19], s37 offen offset:3072 lds
    s_add_u32 m0, s44, 36864
    s_add_u32 s37, s37, 262144
    buffer_load_dwordx4 v24, s[16:19], s38 offen offset:0 lds
    buffer_load_dwordx4 v25, s[16:19], s38 offen offset:1024 lds
    buffer_load_dwordx4 v26, s[16:19], s38 offen offset:2048 lds
    buffer_load_dwordx4 v27, s[16:19], s38 offen offset:3072 lds
    s_add_u32 m0, s44, 65536
    s_add_u32 s38, s37, 32768
    buffer_load_dwordx4 v24, s[16:19], s37 offen offset:0 lds
    buffer_load_dwordx4 v25, s[16:19], s37 offen offset:1024 lds
    buffer_load_dwordx4 v26, s[16:19], s37 offen offset:2048 lds
    buffer_load_dwordx4 v27, s[16:19], s37 offen offset:3072 lds
    s_add_u32 m0, s44, 69632
    s_add_u32 s37, s37, 262144
    buffer_load_dwordx4 v24, s[16:19], s38 offen offset:0 lds
    buffer_load_dwordx4 v25, s[16:19], s38 offen offset:1024 lds
    buffer_load_dwordx4 v26, s[16:19], s38 offen offset:2048 lds
    buffer_load_dwordx4 v27, s[16:19], s38 offen offset:3072 lds
    s_cmp_ge_u32 s2, 42
    s_cbranch_scc1 NOPROD2
    s_waitcnt vmcnt(60)
PW0:
    s_cmp_lg_u32 s30, 0
    s_cbranch_scc1 PW1
    s_waitcnt vmcnt(14)
PW1:
    v_lshlrev_b32 v112, 16, v112
    v_mul_f32 v6, 0xbfb8aa3b, v112
    v_exp_f32 v6, v6
    s_nop 0
    v_add_f32 v6, 1.0, v6
    v_rcp_f32 v6, v6
    s_nop 0
    v_mul_f32 v112, v112, v6
    v_cvt_pk_bf16_f32 v112, v112, v112
    v_lshlrev_b32 v112, 16, v112
    v_lshlrev_b32 v113, 16, v113
    v_mul_f32 v6, 0xbfb8aa3b, v113
    v_exp_f32 v6, v6
    s_nop 0
    v_add_f32 v6, 1.0, v6
    v_rcp_f32 v6, v6
    s_nop 0
    v_mul_f32 v113, v113, v6
    v_cvt_pk_bf16_f32 v113, v113, v113
    v_lshlrev_b32 v113, 16, v113
    v_lshlrev_b32 v114, 16, v114
    v_mul_f32 v6, 0xbfb8aa3b, v114
    v_exp_f32 v6, v6
    s_nop 0
    v_add_f32 v6, 1.0, v6
    v_rcp_f32 v6, v6
    s_nop 0
    v_mul_f32 v114, v114, v6
    v_cvt_pk_bf16_f32 v114, v114, v114
    v_lshlrev_b32 v114, 16, v114
    v_lshlrev_b32 v115, 16, v115
    v_mul_f32 v6, 0xbfb8aa3b, v115
    v_exp_f32 v6, v6
    s_nop 0
    v_add_f32 v6, 1.0, v6
    v_rcp_f32 v6, v6
    s_nop 0
    v_mul_f32 v115, v115, v6
    v_cvt_pk_bf16_f32 v115, v115, v115
    v_lshlrev_b32 v115, 16, v115
    v_lshlrev_b32 v116, 16, v116
    v_mul_f32 v6, 0xbfb8aa3b, v116
    v_exp_f32 v6, v6
    s_nop 0
    v_add_f32 v6, 1.0, v6
    v_rcp_f32 v6, v6
    s_nop 0
    v_mul_f32 v116, v116, v6
    v_cvt_pk_bf16_f32 v116, v116, v116
    v_lshlrev_b32 v116, 16, v116
    v_lshlrev_b32 v117, 16, v117
    v_mul_f32 v6, 0xbfb8aa3b, v117
    v_exp_f32 v6, v6
    s_nop 0
    v_add_f32 v6, 1.0, v6
    v_rcp_f32 v6, v6
    s_nop 0
    v_mul_f32 v117, v117, v6
    v_cvt_pk_bf16_f32 v117, v117, v117
    v_lshlrev_b32 v117, 16, v117
    v_lshlrev_b32 v118, 16, v118
    v_mul_f32 v6, 0xbfb8aa3b, v118
    v_exp_f32 v6, v6
    s_nop 0
    v_add_f32 v6, 1.0, v6
    v_rcp_f32 v6, v6
    s_nop 0
    v_mul_f32 v118, v118, v6
    v_cvt_pk_bf16_f32 v118, v118, v118
    v_lshlrev_b32 v118, 16, v118
    v_lshlrev_b32 v119, 16, v119
    v_mul_f32 v6, 0xbfb8aa3b, v119
    v_exp_f32 v6, v6
    s_nop 0
    v_add_f32 v6, 1.0, v6
    v_rcp_f32 v6, v6
    s_nop 0
    v_mul_f32 v119, v119, v6
    v_cvt_pk_bf16_f32 v119, v119, v119
    v_lshlrev_b32 v119, 16, v119
    v_lshlrev_b32 v120, 16, v120
    v_mul_f32 v6, 0xbfb8aa3b, v120
    v_exp_f32 v6, v6
    s_nop 0
    v_add_f32 v6, 1.0, v6
    v_rcp_f32 v6, v6
    s_nop 0
    v_mul_f32 v120, v120, v6
    v_cvt_pk_bf16_f32 v120, v120, v120
    v_lshlrev_b32 v120, 16, v120
    v_lshlrev_b32 v121, 16, v121
    v_mul_f32 v6, 0xbfb8aa3b, v121
    v_exp_f32 v6, v6
    s_nop 0
    v_add_f32 v6, 1.0, v6
    v_rcp_f32 v6, v6
    s_nop 0
    v_mul_f32 v121, v121, v6
    v_cvt_pk_bf16_f32 v121, v121, v121
    v_lshlrev_b32 v121, 16, v121
    v_lshlrev_b32 v122, 16, v122
    v_mul_f32 v6, 0xbfb8aa3b, v122
    v_exp_f32 v6, v6
    s_nop 0
    v_add_f32 v6, 1.0, v6
    v_rcp_f32 v6, v6
    s_nop 0
    v_mul_f32 v122, v122, v6
    v_cvt_pk_bf16_f32 v122, v122, v122
    v_lshlrev_b32 v122, 16, v122
    v_lshlrev_b32 v123, 16, v123
    v_mul_f32 v6, 0xbfb8aa3b, v123
    v_exp_f32 v6, v6
    s_nop 0
    v_add_f32 v6, 1.0, v6
    v_rcp_f32 v6, v6
    s_nop 0
    v_mul_f32 v123, v123, v6
    v_cvt_pk_bf16_f32 v123, v123, v123
    v_lshlrev_b32 v123, 16, v123
    v_lshlrev_b32 v124, 16, v124
    v_mul_f32 v6, 0xbfb8aa3b, v124
    v_exp_f32 v6, v6
    s_nop 0
    v_add_f32 v6, 1.0, v6
    v_rcp_f32 v6, v6
    s_nop 0
    v_mul_f32 v124, v124, v6
    v_cvt_pk_bf16_f32 v124, v124, v124
    v_lshlrev_b32 v124, 16, v124
    v_lshlrev_b32 v125, 16, v125
    v_mul_f32 v6, 0xbfb8aa3b, v125
    v_exp_f32 v6, v6
    s_nop 0
    v_add_f32 v6, 1.0, v6
    v_rcp_f32 v6, v6
    s_nop 0
    v_mul_f32 v125, v125, v6
    v_cvt_pk_bf16_f32 v125, v125, v125
    v_lshlrev_b32 v125, 16, v125
    v_mov_b32 v96, 0
    v_mov_b32 v97, 0
    v_mov_b32 v98, 0
    v_mov_b32 v99, 0
    v_mov_b32 v100, 0
    v_mov_b32 v101, 0
    v_mov_b32 v102, 0
    v_mov_b32 v103, 0
    s_cmp_lg_u32 s30, 0
    s_cbranch_scc1 PW2
    s_waitcnt vmcnt(0)
PW2:
    v_lshlrev_b32 v88, 16, v32
    v_and_b32 v89, 0xffff0000, v32
    v_lshlrev_b32 v90, 16, v33
    v_and_b32 v91, 0xffff0000, v33
    v_lshlrev_b32 v92, 16, v34
    v_and_b32 v93, 0xffff0000, v34
    v_lshlrev_b32 v94, 16, v35
    v_and_b32 v95, 0xffff0000, v35
    v_fmac_f32 v96, v88, v112
    v_fmac_f32 v97, v89, v112
    v_fmac_f32 v98, v90, v112
    v_fmac_f32 v99, v91, v112
    v_fmac_f32 v100, v92, v112
    v_fmac_f32 v101, v93, v112
    v_fmac_f32 v102, v94, v112
    v_fmac_f32 v103, v95, v112
    v_lshlrev_b32 v88, 16, v36
    v_and_b32 v89, 0xffff0000, v36
    v_lshlrev_b32 v90, 16, v37
    v_and_b32 v91, 0xffff0000, v37
    v_lshlrev_b32 v92, 16, v38
    v_and_b32 v93, 0xffff0000, v38
    v_lshlrev_b32 v94, 16, v39
    v_and_b32 v95, 0xffff0000, v39
    v_fmac_f32 v96, v88, v113
    v_fmac_f32 v97, v89, v113
    v_fmac_f32 v98, v90, v113
    v_fmac_f32 v99, v91, v113
    v_fmac_f32 v100, v92, v113
    v_fmac_f32 v101, v93, v113
    v_fmac_f32 v102, v94, v113
    v_fmac_f32 v103, v95, v113
    v_lshlrev_b32 v88, 16, v40
    v_and_b32 v89, 0xffff0000, v40
    v_lshlrev_b32 v90, 16, v41
    v_and_b32 v91, 0xffff0000, v41
    v_lshlrev_b32 v92, 16, v42
    v_and_b32 v93, 0xffff0000, v42
    v_lshlrev_b32 v94, 16, v43
    v_and_b32 v95, 0xffff0000, v43
    v_fmac_f32 v96, v88, v114
    v_fmac_f32 v97, v89, v114
    v_fmac_f32 v98, v90, v114
    v_fmac_f32 v99, v91, v114
    v_fmac_f32 v100, v92, v114
    v_fmac_f32 v101, v93, v114
    v_fmac_f32 v102, v94, v114
    v_fmac_f32 v103, v95, v114
    v_lshlrev_b32 v88, 16, v44
    v_and_b32 v89, 0xffff0000, v44
    v_lshlrev_b32 v90, 16, v45
    v_and_b32 v91, 0xffff0000, v45
    v_lshlrev_b32 v92, 16, v46
    v_and_b32 v93, 0xffff0000, v46
    v_lshlrev_b32 v94, 16, v47
    v_and_b32 v95, 0xffff0000, v47
    v_fmac_f32 v96, v88, v115
    v_fmac_f32 v97, v89, v115
    v_fmac_f32 v98, v90, v115
    v_fmac_f32 v99, v91, v115
    v_fmac_f32 v100, v92, v115
    v_fmac_f32 v101, v93, v115
    v_fmac_f32 v102, v94, v115
    v_fmac_f32 v103, v95, v115
    v_lshlrev_b32 v88, 16, v48
    v_and_b32 v89, 0xffff0000, v48
    v_lshlrev_b32 v90, 16, v49
    v_and_b32 v91, 0xffff0000, v49
    v_lshlrev_b32 v92, 16, v50
    v_and_b32 v93, 0xffff0000, v50
    v_lshlrev_b32 v94, 16, v51
    v_and_b32 v95, 0xffff0000, v51
    v_fmac_f32 v96, v88, v116
    v_fmac_f32 v97, v89, v116
    v_fmac_f32 v98, v90, v116
    v_fmac_f32 v99, v91, v116
    v_fmac_f32 v100, v92, v116
    v_fmac_f32 v101, v93, v116
    v_fmac_f32 v102, v94, v116
    v_fmac_f32 v103, v95, v116
    v_lshlrev_b32 v88, 16, v52
    v_and_b32 v89, 0xffff0000, v52
    v_lshlrev_b32 v90, 16, v53
    v_and_b32 v91, 0xffff0000, v53
    v_lshlrev_b32 v92, 16, v54
    v_and_b32 v93, 0xffff0000, v54
    v_lshlrev_b32 v94, 16, v55
    v_and_b32 v95, 0xffff0000, v55
    v_fmac_f32 v96, v88, v117
    v_fmac_f32 v97, v89, v117
    v_fmac_f32 v98, v90, v117
    v_fmac_f32 v99, v91, v117
    v_fmac_f32 v100, v92, v117
    v_fmac_f32 v101, v93, v117
    v_fmac_f32 v102, v94, v117
    v_fmac_f32 v103, v95, v117
    v_lshlrev_b32 v88, 16, v56
    v_and_b32 v89, 0xffff0000, v56
    v_lshlrev_b32 v90, 16, v57
    v_and_b32 v91, 0xffff0000, v57
    v_lshlrev_b32 v92, 16, v58
    v_and_b32 v93, 0xffff0000, v58
    v_lshlrev_b32 v94, 16, v59
    v_and_b32 v95, 0xffff0000, v59
    v_fmac_f32 v96, v88, v118
    v_fmac_f32 v97, v89, v118
    v_fmac_f32 v98, v90, v118
    v_fmac_f32 v99, v91, v118
    v_fmac_f32 v100, v92, v118
    v_fmac_f32 v101, v93, v118
    v_fmac_f32 v102, v94, v118
    v_fmac_f32 v103, v95, v118
    v_lshlrev_b32 v88, 16, v60
    v_and_b32 v89, 0xffff0000, v60
    v_lshlrev_b32 v90, 16, v61
    v_and_b32 v91, 0xffff0000, v61
    v_lshlrev_b32 v92, 16, v62
    v_and_b32 v93, 0xffff0000, v62
    v_lshlrev_b32 v94, 16, v63
    v_and_b32 v95, 0xffff0000, v63
    v_fmac_f32 v96, v88, v119
    v_fmac_f32 v97, v89, v119
    v_fmac_f32 v98, v90, v119
    v_fmac_f32 v99, v91, v119
    v_fmac_f32 v100, v92, v119
    v_fmac_f32 v101, v93, v119
    v_fmac_f32 v102, v94, v119
    v_fmac_f32 v103, v95, v119
    v_lshlrev_b32 v88, 16, v64
    v_and_b32 v89, 0xffff0000, v64
    v_lshlrev_b32 v90, 16, v65
    v_and_b32 v91, 0xffff0000, v65
    v_lshlrev_b32 v92, 16, v66
    v_and_b32 v93, 0xffff0000, v66
    v_lshlrev_b32 v94, 16, v67
    v_and_b32 v95, 0xffff0000, v67
    v_fmac_f32 v96, v88, v120
    v_fmac_f32 v97, v89, v120
    v_fmac_f32 v98, v90, v120
    v_fmac_f32 v99, v91, v120
    v_fmac_f32 v100, v92, v120
    v_fmac_f32 v101, v93, v120
    v_fmac_f32 v102, v94, v120
    v_fmac_f32 v103, v95, v120
    v_lshlrev_b32 v88, 16, v68
    v_and_b32 v89, 0xffff0000, v68
    v_lshlrev_b32 v90, 16, v69
    v_and_b32 v91, 0xffff0000, v69
    v_lshlrev_b32 v92, 16, v70
    v_and_b32 v93, 0xffff0000, v70
    v_lshlrev_b32 v94, 16, v71
    v_and_b32 v95, 0xffff0000, v71
    v_fmac_f32 v96, v88, v121
    v_fmac_f32 v97, v89, v121
    v_fmac_f32 v98, v90, v121
    v_fmac_f32 v99, v91, v121
    v_fmac_f32 v100, v92, v121
    v_fmac_f32 v101, v93, v121
    v_fmac_f32 v102, v94, v121
    v_fmac_f32 v103, v95, v121
    v_lshlrev_b32 v88, 16, v72
    v_and_b32 v89, 0xffff0000, v72
    v_lshlrev_b32 v90, 16, v73
    v_and_b32 v91, 0xffff0000, v73
    v_lshlrev_b32 v92, 16, v74
    v_and_b32 v93, 0xffff0000, v74
    v_lshlrev_b32 v94, 16, v75
    v_and_b32 v95, 0xffff0000, v75
    v_fmac_f32 v96, v88, v122
    v_fmac_f32 v97, v89, v122
    v_fmac_f32 v98, v90, v122
    v_fmac_f32 v99, v91, v122
    v_fmac_f32 v100, v92, v122
    v_fmac_f32 v101, v93, v122
    v_fmac_f32 v102, v94, v122
    v_fmac_f32 v103, v95, v122
    v_lshlrev_b32 v88, 16, v76
    v_and_b32 v89, 0xffff0000, v76
    v_lshlrev_b32 v90, 16, v77
    v_and_b32 v91, 0xffff0000, v77
    v_lshlrev_b32 v92, 16, v78
    v_and_b32 v93, 0xffff0000, v78
    v_lshlrev_b32 v94, 16, v79
    v_and_b32 v95, 0xffff0000, v79
    v_fmac_f32 v96, v88, v123
    v_fmac_f32 v97, v89, v123
    v_fmac_f32 v98, v90, v123
    v_fmac_f32 v99, v91, v123
    v_fmac_f32 v100, v92, v123
    v_fmac_f32 v101, v93, v123
    v_fmac_f32 v102, v94, v123
    v_fmac_f32 v103, v95, v123
    v_lshlrev_b32 v88, 16, v80
    v_and_b32 v89, 0xffff0000, v80
    v_lshlrev_b32 v90, 16, v81
    v_and_b32 v91, 0xffff0000, v81
    v_lshlrev_b32 v92, 16, v82
    v_and_b32 v93, 0xffff0000, v82
    v_lshlrev_b32 v94, 16, v83
    v_and_b32 v95, 0xffff0000, v83
    v_fmac_f32 v96, v88, v124
    v_fmac_f32 v97, v89, v124
    v_fmac_f32 v98, v90, v124
    v_fmac_f32 v99, v91, v124
    v_fmac_f32 v100, v92, v124
    v_fmac_f32 v101, v93, v124
    v_fmac_f32 v102, v94, v124
    v_fmac_f32 v103, v95, v124
    v_lshlrev_b32 v88, 16, v84
    v_and_b32 v89, 0xffff0000, v84
    v_lshlrev_b32 v90, 16, v85
    v_and_b32 v91, 0xffff0000, v85
    v_lshlrev_b32 v92, 16, v86
    v_and_b32 v93, 0xffff0000, v86
    v_lshlrev_b32 v94, 16, v87
    v_and_b32 v95, 0xffff0000, v87
    v_fmac_f32 v96, v88, v125
    v_fmac_f32 v97, v89, v125
    v_fmac_f32 v98, v90, v125
    v_fmac_f32 v99, v91, v125
    v_fmac_f32 v100, v92, v125
    v_fmac_f32 v101, v93, v125
    v_fmac_f32 v102, v94, v125
    v_fmac_f32 v103, v95, v125
    v_lshlrev_b32 v6, 5, v0
    ds_write_b128 v6, v[96:99] offset:8192
    ds_write_b128 v6, v[100:103] offset:8208
    s_waitcnt lgkmcnt(0)
    s_barrier
    s_cmp_lg_u32 s30, 0
    s_cbranch_scc1 NOPROD2
    v_lshlrev_b32 v6, 2, v0
    ds_read_b32 v32, v6 offset:8192
    ds_read_b32 v33, v6 offset:8448
    ds_read_b32 v34, v6 offset:8704
    ds_read_b32 v35, v6 offset:8960
    ds_read_b32 v36, v6 offset:9216
    ds_read_b32 v37, v6 offset:9472
    ds_read_b32 v38, v6 offset:9728
    ds_read_b32 v39, v6 offset:9984
    ds_read_b32 v40, v6 offset:10240
    ds_read_b32 v41, v6 offset:10496
    ds_read_b32 v42, v6 offset:10752
    ds_read_b32 v43, v6 offset:11008
    ds_read_b32 v44, v6 offset:11264
    ds_read_b32 v45, v6 offset:11520
    ds_read_b32 v46, v6 offset:11776
    ds_read_b32 v47, v6 offset:12032
    ds_read_b32 v48, v6 offset:12288
    ds_read_b32 v49, v6 offset:12544
    ds_read_b32 v50, v6 offset:12800
    ds_read_b32 v51, v6 offset:13056
    ds_read_b32 v52, v6 offset:13312
    ds_read_b32 v53, v6 offset:13568
    ds_read_b32 v54, v6 offset:13824
    ds_read_b32 v55, v6 offset:14080
    ds_read_b32 v56, v6 offset:14336
    ds_read_b32 v57, v6 offset:14592
    ds_read_b32 v58, v6 offset:14848
    ds_read_b32 v59, v6 offset:15104
    ds_read_b32 v60, v6 offset:15360
    ds_read_b32 v61, v6 offset:15616
    ds_read_b32 v62, v6 offset:15872
    ds_read_b32 v63, v6 offset:16128
    s_waitcnt lgkmcnt(0)
    v_add_f32 v32, v32, v33
    v_add_f32 v32, v32, v34
    v_add_f32 v32, v32, v35
    v_add_f32 v32, v32, v36
    v_add_f32 v32, v32, v37
    v_add_f32 v32, v32, v38
    v_add_f32 v32, v32, v39
    v_add_f32 v32, v32, v40
    v_add_f32 v32, v32, v41
    v_add_f32 v32, v32, v42
    v_add_f32 v32, v32, v43
    v_add_f32 v32, v32, v44
    v_add_f32 v32, v32, v45
    v_add_f32 v32, v32, v46
    v_add_f32 v32, v32, v47
    v_add_f32 v32, v32, v48
    v_add_f32 v32, v32, v49
    v_add_f32 v32, v32, v50
    v_add_f32 v32, v32, v51
    v_add_f32 v32, v32, v52
    v_add_f32 v32, v32, v53
    v_add_f32 v32, v32, v54
    v_add_f32 v32, v32, v55
    v_add_f32 v32, v32, v56
    v_add_f32 v32, v32, v57
    v_add_f32 v32, v32, v58
    v_add_f32 v32, v32, v59
    v_add_f32 v32, v32, v60
    v_add_f32 v32, v32, v61
    v_add_f32 v32, v32, v62
    v_add_f32 v32, v32, v63
    v_cvt_pk_bf16_f32 v32, v32, v32
    v_lshlrev_b32 v32, 16, v32
    s_mul_i32 s3, s2, 37
    s_lshr_b32 s3, s3, 8
    s_cmp_eq_u32 s3, 1
    s_cbranch_scc1 K0_ADD1
    s_cmp_eq_u32 s3, 4
    s_cbranch_scc0 K0_NOADD
K0_ADD1:
    v_add_f32 v32, 1.0, v32
    v_cvt_pk_bf16_f32 v32, v32, v32
    v_lshlrev_b32 v32, 16, v32
K0_NOADD:
    s_cmp_lt_u32 s3, 2
    s_cbranch_scc0 K0_NOSC
    v_mul_f32 v32, 0x3db8aa3b, v32
K0_NOSC:
    s_lshl_b32 s3, s2, 8
    buffer_store_dword v32, v6, s[24:27], s3 offen sc0 sc1
    s_waitcnt vmcnt(0)
    v_mov_b32 v32, 1
    v_mov_b32 v6, 0
    v_cmp_eq_u32 vcc, 0, v0
    s_and_saveexec_b64 s[46:47], vcc
    buffer_store_byte v32, v6, s[56:59], s2 offen sc0 sc1
    s_mov_b64 exec, -1
    s_lshl_b32 s3, s29, 6
    s_lshl_b32 s35, s32, 5
    s_add_u32 s3, s3, s35
    s_mul_i32 s3, s3, 896
    s_add_u32 s35, s3, 16*896
    v_mul_u32_u24 v5, 896, v4
    v_lshl_add_u32 v5, v3, 4, v5
    buffer_load_dwordx4 v[128:131], v5, s[4:7], s3 offen offset:0
    buffer_load_dwordx4 v[132:135], v5, s[4:7], s35 offen offset:0
    buffer_load_dwordx4 v[136:139], v5, s[4:7], s3 offen offset:64
    buffer_load_dwordx4 v[140:143], v5, s[4:7], s35 offen offset:64
    buffer_load_dwordx4 v[144:147], v5, s[4:7], s3 offen offset:128
    buffer_load_dwordx4 v[148:151], v5, s[4:7], s35 offen offset:128
    buffer_load_dwordx4 v[152:155], v5, s[4:7], s3 offen offset:192
    buffer_load_dwordx4 v[156:159], v5, s[4:7], s35 offen offset:192
    buffer_load_dwordx4 v[160:163], v5, s[4:7], s3 offen offset:256
    buffer_load_dwordx4 v[164:167], v5, s[4:7], s35 offen offset:256
    buffer_load_dwordx4 v[168:171], v5, s[4:7], s3 offen offset:320
    buffer_load_dwordx4 v[172:175], v5, s[4:7], s35 offen offset:320
    buffer_load_dwordx4 v[176:179], v5, s[4:7], s3 offen offset:384
    buffer_load_dwordx4 v[180:183], v5, s[4:7], s35 offen offset:384
    buffer_load_dwordx4 v[184:187], v5, s[4:7], s3 offen offset:448
    buffer_load_dwordx4 v[188:191], v5, s[4:7], s35 offen offset:448
    buffer_load_dwordx4 v[192:195], v5, s[4:7], s3 offen offset:512
    buffer_load_dwordx4 v[196:199], v5, s[4:7], s35 offen offset:512
    buffer_load_dwordx4 v[200:203], v5, s[4:7], s3 offen offset:576
    buffer_load_dwordx4 v[204:207], v5, s[4:7], s35 offen offset:576
    buffer_load_dwordx4 v[208:211], v5, s[4:7], s3 offen offset:640
    buffer_load_dwordx4 v[212:215], v5, s[4:7], s35 offen offset:640
    buffer_load_dwordx4 v[216:219], v5, s[4:7], s3 offen offset:704
    buffer_load_dwordx4 v[220:223], v5, s[4:7], s35 offen offset:704
    buffer_load_dwordx4 v[224:227], v5, s[4:7], s3 offen offset:768
    buffer_load_dwordx4 v[228:231], v5, s[4:7], s35 offen offset:768
    buffer_load_dwordx4 v[232:235], v5, s[4:7], s3 offen offset:832
    buffer_load_dwordx4 v[236:239], v5, s[4:7], s35 offen offset:832
    s_add_u32 m0, s44, 131072
    s_add_u32 s38, s37, 32768
    buffer_load_dwordx4 v24, s[16:19], s37 offen offset:0 lds
    buffer_load_dwordx4 v25, s[16:19], s37 offen offset:1024 lds
    buffer_load_dwordx4 v26, s[16:19], s37 offen offset:2048 lds
    buffer_load_dwordx4 v27, s[16:19], s37 offen offset:3072 lds
    s_add_u32 m0, s44, 135168
    s_add_u32 s37, s37, 262144
    buffer_load_dwordx4 v24, s[16:19], s38 offen offset:0 lds
    buffer_load_dwordx4 v25, s[16:19], s38 offen offset:1024 lds
    buffer_load_dwordx4 v26, s[16:19], s38 offen offset:2048 lds
    buffer_load_dwordx4 v27, s[16:19], s38 offen offset:3072 lds
    s_add_u32 m0, s44, 98304
    s_add_u32 s38, s37, 32768
    buffer_load_dwordx4 v24, s[16:19], s37 offen offset:0 lds
    buffer_load_dwordx4 v25, s[16:19], s37 offen offset:1024 lds
    buffer_load_dwordx4 v26, s[16:19], s37 offen offset:2048 lds
    buffer_load_dwordx4 v27, s[16:19], s37 offen offset:3072 lds
    s_add_u32 m0, s44, 102400
    s_add_u32 s37, s37, 262144
    buffer_load_dwordx4 v24, s[16:19], s38 offen offset:0 lds
    buffer_load_dwordx4 v25, s[16:19], s38 offen offset:1024 lds
    buffer_load_dwordx4 v26, s[16:19], s38 offen offset:2048 lds
    buffer_load_dwordx4 v27, s[16:19], s38 offen offset:3072 lds
    s_add_u32 m0, s44, 32768
    s_add_u32 s38, s37, 32768
    buffer_load_dwordx4 v24, s[16:19], s37 offen offset:0 lds
    buffer_load_dwordx4 v25, s[16:19], s37 offen offset:1024 lds
    buffer_load_dwordx4 v26, s[16:19], s37 offen offset:2048 lds
    buffer_load_dwordx4 v27, s[16:19], s37 offen offset:3072 lds
    s_add_u32 m0, s44, 36864
    s_add_u32 s37, s37, 262144
    buffer_load_dwordx4 v24, s[16:19], s38 offen offset:0 lds
    buffer_load_dwordx4 v25, s[16:19], s38 offen offset:1024 lds
    buffer_load_dwordx4 v26, s[16:19], s38 offen offset:2048 lds
    buffer_load_dwordx4 v27, s[16:19], s38 offen offset:3072 lds
    s_add_u32 m0, s44, 65536
    s_add_u32 s38, s37, 32768
    buffer_load_dwordx4 v24, s[16:19], s37 offen offset:0 lds
    buffer_load_dwordx4 v25, s[16:19], s37 offen offset:1024 lds
    buffer_load_dwordx4 v26, s[16:19], s37 offen offset:2048 lds
    buffer_load_dwordx4 v27, s[16:19], s37 offen offset:3072 lds
    s_add_u32 m0, s44, 69632
    s_add_u32 s37, s37, 262144
    buffer_load_dwordx4 v24, s[16:19], s38 offen offset:0 lds
    buffer_load_dwordx4 v25, s[16:19], s38 offen offset:1024 lds
    buffer_load_dwordx4 v26, s[16:19], s38 offen offset:2048 lds
    buffer_load_dwordx4 v27, s[16:19], s38 offen offset:3072 lds
NOPROD2:
    v_lshrrev_b32 v28, 5, v2
    v_and_b32 v29, 31, v2
    v_lshlrev_b32 v6, 9, v28
    v_add_u32 v6, s44, v6
    v_add_u32 v7, 0, v28
    v_xor_b32 v7, v7, v29
    v_lshl_add_u32 v8, v7, 4, v6
    v_add_u32 v7, 2, v28
    v_xor_b32 v7, v7, v29
    v_lshl_add_u32 v9, v7, 4, v6
    v_add_u32 v7, 4, v28
    v_xor_b32 v7, v7, v29
    v_lshl_add_u32 v10, v7, 4, v6
    v_add_u32 v7, 6, v28
    v_xor_b32 v7, v7, v29
    v_lshl_add_u32 v11, v7, 4, v6
    v_add_u32 v7, 8, v28
    v_xor_b32 v7, v7, v29
    v_lshl_add_u32 v12, v7, 4, v6
    v_add_u32 v7, 10, v28
    v_xor_b32 v7, v7, v29
    v_lshl_add_u32 v13, v7, 4, v6
    v_add_u32 v7, 12, v28
    v_xor_b32 v7, v7, v29
    v_lshl_add_u32 v14, v7, 4, v6
    v_add_u32 v7, 14, v28
    v_xor_b32 v7, v7, v29
    v_lshl_add_u32 v15, v7, 4, v6
    v_add_u32 v7, 0, v28
    v_lshlrev_b32 v7, 1, v7
    v_xor_b32 v7, v7, v29
    v_lshl_add_u32 v120, v7, 4, v6
    v_add_u32 v7, 2, v28
    v_lshlrev_b32 v7, 1, v7
    v_xor_b32 v7, v7, v29
    v_lshl_add_u32 v121, v7, 4, v6
    v_add_u32 v7, 4, v28
    v_lshlrev_b32 v7, 1, v7
    v_xor_b32 v7, v7, v29
    v_lshl_add_u32 v122, v7, 4, v6
    v_add_u32 v7, 6, v28
    v_lshlrev_b32 v7, 1, v7
    v_xor_b32 v7, v7, v29
    v_lshl_add_u32 v123, v7, 4, v6
    v_lshlrev_b32 v7, 9, v4
    v_add_u32 v28, 0, v3
    v_xor_b32 v28, v28, v4
    v_lshl_add_u32 v240, v28, 4, v7
    v_add_u32 v28, 4, v3
    v_xor_b32 v28, v28, v4
    v_lshl_add_u32 v241, v28, 4, v7
    v_add_u32 v28, 8, v3
    v_xor_b32 v28, v28, v4
    v_lshl_add_u32 v242, v28, 4, v7
    v_add_u32 v28, 12, v3
    v_xor_b32 v28, v28, v4
    v_lshl_add_u32 v243, v28, 4, v7
    v_bfe_u32 v28, v2, 2, 2
    v_and_b32 v29, 3, v2
    v_and_b32 v30, 1, v3
    v_lshl_add_u32 v30, v30, 2, v28
    v_lshl_add_u32 v6, v3, 2, v28
    v_lshlrev_b32 v6, 9, v6
    v_lshl_add_u32 v6, v29, 3, v6
    v_add_u32 v6, 65536, v6
    v_xor_b32 v7, 0, v30
    v_lshl_add_u32 v244, v7, 5, v6
    v_xor_b32 v7, 1, v30
    v_lshl_add_u32 v245, v7, 5, v6
    v_xor_b32 v7, 2, v30
    v_lshl_add_u32 v246, v7, 5, v6
    v_xor_b32 v7, 3, v30
    v_lshl_add_u32 v247, v7, 5, v6
    v_xor_b32 v7, 4, v30
    v_lshl_add_u32 v248, v7, 5, v6
    v_xor_b32 v7, 5, v30
    v_lshl_add_u32 v249, v7, 5, v6
    v_xor_b32 v7, 6, v30
    v_lshl_add_u32 v250, v7, 5, v6
    v_xor_b32 v7, 7, v30
    v_lshl_add_u32 v251, v7, 5, v6
    v_lshl_add_u32 v6, v3, 3, v28
    v_lshlrev_b32 v6, 10, v6
    v_lshl_add_u32 v6, v29, 3, v6
    s_lshl_b32 s35, s31, 9
    s_add_u32 s35, s35, 32768
    v_add_u32 v6, s35, v6
    v_xor_b32 v7, 0, v30
    v_lshl_add_u32 v96, v7, 5, v6
    v_add_u32 v104, 65536, v96
    v_xor_b32 v7, 1, v30
    v_lshl_add_u32 v97, v7, 5, v6
    v_add_u32 v105, 65536, v97
    v_xor_b32 v7, 2, v30
    v_lshl_add_u32 v98, v7, 5, v6
    v_add_u32 v106, 65536, v98
    v_xor_b32 v7, 3, v30
    v_lshl_add_u32 v99, v7, 5, v6
    v_add_u32 v107, 65536, v99
    v_xor_b32 v7, 4, v30
    v_lshl_add_u32 v100, v7, 5, v6
    v_add_u32 v108, 65536, v100
    v_xor_b32 v7, 5, v30
    v_lshl_add_u32 v101, v7, 5, v6
    v_add_u32 v109, 65536, v101
    v_xor_b32 v7, 6, v30
    v_lshl_add_u32 v102, v7, 5, v6
    v_add_u32 v110, 65536, v102
    v_xor_b32 v7, 7, v30
    v_lshl_add_u32 v103, v7, 5, v6
    v_add_u32 v111, 65536, v103
    s_waitcnt vmcnt(32)
    v_mov_b32 v31, 0x3f803f80
    s_cmp_eq_u32 s30, 3
    s_cbranch_scc0 PF4
    v_lshrrev_b32 v6, 3, v2
    v_and_b32 v7, 7, v2
    v_lshlrev_b32 v6, 13, v6
    v_lshl_add_u32 v6, v7, 7, v6
    s_mul_i32 s3, s29, 81920
    s_lshl_b32 s35, s28, 10
    s_add_u32 s3, s3, s35
    s_add_u32 s3, s3, 1048576
    buffer_load_dword v64, v6, s[16:19], s3 offen
    s_add_u32 s3, s3, 16384
    buffer_load_dword v65, v6, s[16:19], s3 offen
PF4:
    v_mov_b32 v40, 0
    v_mov_b32 v41, 0
    v_mov_b32 v42, 0
    v_mov_b32 v43, 0
    v_mov_b32 v44, 0
    v_mov_b32 v45, 0
    v_mov_b32 v46, 0
    v_mov_b32 v47, 0
    v_dot2_f32_bf16 v40, v128, v31, v40
    v_dot2_f32_bf16 v44, v128, v128, v44
    v_dot2_f32_bf16 v41, v129, v31, v41
    v_dot2_f32_bf16 v45, v129, v129, v45
    v_dot2_f32_bf16 v40, v130, v31, v40
    v_dot2_f32_bf16 v44, v130, v130, v44
    v_dot2_f32_bf16 v41, v131, v31, v41
    v_dot2_f32_bf16 v45, v131, v131, v45
    v_dot2_f32_bf16 v42, v132, v31, v42
    v_dot2_f32_bf16 v46, v132, v132, v46
    v_dot2_f32_bf16 v43, v133, v31, v43
    v_dot2_f32_bf16 v47, v133, v133, v47
    v_dot2_f32_bf16 v42, v134, v31, v42
    v_dot2_f32_bf16 v46, v134, v134, v46
    v_dot2_f32_bf16 v43, v135, v31, v43
    v_dot2_f32_bf16 v47, v135, v135, v47
    v_dot2_f32_bf16 v40, v136, v31, v40
    v_dot2_f32_bf16 v44, v136, v136, v44
    v_dot2_f32_bf16 v41, v137, v31, v41
    v_dot2_f32_bf16 v45, v137, v137, v45
    v_dot2_f32_bf16 v40, v138, v31, v40
    v_dot2_f32_bf16 v44, v138, v138, v44
    v_dot2_f32_bf16 v41, v139, v31, v41
    v_dot2_f32_bf16 v45, v139, v139, v45
    v_dot2_f32_bf16 v42, v140, v31, v42
    v_dot2_f32_bf16 v46, v140, v140, v46
    v_dot2_f32_bf16 v43, v141, v31, v43
    v_dot2_f32_bf16 v47, v141, v141, v47
    v_dot2_f32_bf16 v42, v142, v31, v42
    v_dot2_f32_bf16 v46, v142, v142, v46
    v_dot2_f32_bf16 v43, v143, v31, v43
    v_dot2_f32_bf16 v47, v143, v143, v47
    v_dot2_f32_bf16 v40, v144, v31, v40
    v_dot2_f32_bf16 v44, v144, v144, v44
    v_dot2_f32_bf16 v41, v145, v31, v41
    v_dot2_f32_bf16 v45, v145, v145, v45
    v_dot2_f32_bf16 v40, v146, v31, v40
    v_dot2_f32_bf16 v44, v146, v146, v44
    v_dot2_f32_bf16 v41, v147, v31, v41
    v_dot2_f32_bf16 v45, v147, v147, v45
    v_dot2_f32_bf16 v42, v148, v31, v42
    v_dot2_f32_bf16 v46, v148, v148, v46
    v_dot2_f32_bf16 v43, v149, v31, v43
    v_dot2_f32_bf16 v47, v149, v149, v47
    v_dot2_f32_bf16 v42, v150, v31, v42
    v_dot2_f32_bf16 v46, v150, v150, v46
    v_dot2_f32_bf16 v43, v151, v31, v43
    v_dot2_f32_bf16 v47, v151, v151, v47
    v_dot2_f32_bf16 v40, v152, v31, v40
    v_dot2_f32_bf16 v44, v152, v152, v44
    v_dot2_f32_bf16 v41, v153, v31, v41
    v_dot2_f32_bf16 v45, v153, v153, v45
    v_dot2_f32_bf16 v40, v154, v31, v40
    v_dot2_f32_bf16 v44, v154, v154, v44
    v_dot2_f32_bf16 v41, v155, v31, v41
    v_dot2_f32_bf16 v45, v155, v155, v45
    v_dot2_f32_bf16 v42, v156, v31, v42
    v_dot2_f32_bf16 v46, v156, v156, v46
    v_dot2_f32_bf16 v43, v157, v31, v43
    v_dot2_f32_bf16 v47, v157, v157, v47
    v_dot2_f32_bf16 v42, v158, v31, v42
    v_dot2_f32_bf16 v46, v158, v158, v46
    v_dot2_f32_bf16 v43, v159, v31, v43
    v_dot2_f32_bf16 v47, v159, v159, v47
    v_dot2_f32_bf16 v40, v160, v31, v40
    v_dot2_f32_bf16 v44, v160, v160, v44
    v_dot2_f32_bf16 v41, v161, v31, v41
    v_dot2_f32_bf16 v45, v161, v161, v45
    v_dot2_f32_bf16 v40, v162, v31, v40
    v_dot2_f32_bf16 v44, v162, v162, v44
    v_dot2_f32_bf16 v41, v163, v31, v41
    v_dot2_f32_bf16 v45, v163, v163, v45
    v_dot2_f32_bf16 v42, v164, v31, v42
    v_dot2_f32_bf16 v46, v164, v164, v46
    v_dot2_f32_bf16 v43, v165, v31, v43
    v_dot2_f32_bf16 v47, v165, v165, v47
    v_dot2_f32_bf16 v42, v166, v31, v42
    v_dot2_f32_bf16 v46, v166, v166, v46
    v_dot2_f32_bf16 v43, v167, v31, v43
    v_dot2_f32_bf16 v47, v167, v167, v47
    v_dot2_f32_bf16 v40, v168, v31, v40
    v_dot2_f32_bf16 v44, v168, v168, v44
    v_dot2_f32_bf16 v41, v169, v31, v41
    v_dot2_f32_bf16 v45, v169, v169, v45
    v_dot2_f32_bf16 v40, v170, v31, v40
    v_dot2_f32_bf16 v44, v170, v170, v44
    v_dot2_f32_bf16 v41, v171, v31, v41
    v_dot2_f32_bf16 v45, v171, v171, v45
    v_dot2_f32_bf16 v42, v172, v31, v42
    v_dot2_f32_bf16 v46, v172, v172, v46
    v_dot2_f32_bf16 v43, v173, v31, v43
    v_dot2_f32_bf16 v47, v173, v173, v47
    v_dot2_f32_bf16 v42, v174, v31, v42
    v_dot2_f32_bf16 v46, v174, v174, v46
    v_dot2_f32_bf16 v43, v175, v31, v43
    v_dot2_f32_bf16 v47, v175, v175, v47
    v_dot2_f32_bf16 v40, v176, v31, v40
    v_dot2_f32_bf16 v44, v176, v176, v44
    v_dot2_f32_bf16 v41, v177, v31, v41
    v_dot2_f32_bf16 v45, v177, v177, v45
    v_dot2_f32_bf16 v40, v178, v31, v40
    v_dot2_f32_bf16 v44, v178, v178, v44
    v_dot2_f32_bf16 v41, v179, v31, v41
    v_dot2_f32_bf16 v45, v179, v179, v45
    v_dot2_f32_bf16 v42, v180, v31, v42
    v_dot2_f32_bf16 v46, v180, v180, v46
    v_dot2_f32_bf16 v43, v181, v31, v43
    v_dot2_f32_bf16 v47, v181, v181, v47
    v_dot2_f32_bf16 v42, v182, v31, v42
    v_dot2_f32_bf16 v46, v182, v182, v46
    v_dot2_f32_bf16 v43, v183, v31, v43
    v_dot2_f32_bf16 v47, v183, v183, v47
    v_dot2_f32_bf16 v40, v184, v31, v40
    v_dot2_f32_bf16 v44, v184, v184, v44
    v_dot2_f32_bf16 v41, v185, v31, v41
    v_dot2_f32_bf16 v45, v185, v185, v45
    v_dot2_f32_bf16 v40, v186, v31, v40
    v_dot2_f32_bf16 v44, v186, v186, v44
    v_dot2_f32_bf16 v41, v187, v31, v41
    v_dot2_f32_bf16 v45, v187, v187, v45
    v_dot2_f32_bf16 v42, v188, v31, v42
    v_dot2_f32_bf16 v46, v188, v188, v46
    v_dot2_f32_bf16 v43, v189, v31, v43
    v_dot2_f32_bf16 v47, v189, v189, v47
    v_dot2_f32_bf16 v42, v190, v31, v42
    v_dot2_f32_bf16 v46, v190, v190, v46
    v_dot2_f32_bf16 v43, v191, v31, v43
    v_dot2_f32_bf16 v47, v191, v191, v47
    v_dot2_f32_bf16 v40, v192, v31, v40
    v_dot2_f32_bf16 v44, v192, v192, v44
    v_dot2_f32_bf16 v41, v193, v31, v41
    v_dot2_f32_bf16 v45, v193, v193, v45
    v_dot2_f32_bf16 v40, v194, v31, v40
    v_dot2_f32_bf16 v44, v194, v194, v44
    v_dot2_f32_bf16 v41, v195, v31, v41
    v_dot2_f32_bf16 v45, v195, v195, v45
    v_dot2_f32_bf16 v42, v196, v31, v42
    v_dot2_f32_bf16 v46, v196, v196, v46
    v_dot2_f32_bf16 v43, v197, v31, v43
    v_dot2_f32_bf16 v47, v197, v197, v47
    v_dot2_f32_bf16 v42, v198, v31, v42
    v_dot2_f32_bf16 v46, v198, v198, v46
    v_dot2_f32_bf16 v43, v199, v31, v43
    v_dot2_f32_bf16 v47, v199, v199, v47
    v_dot2_f32_bf16 v40, v200, v31, v40
    v_dot2_f32_bf16 v44, v200, v200, v44
    v_dot2_f32_bf16 v41, v201, v31, v41
    v_dot2_f32_bf16 v45, v201, v201, v45
    v_dot2_f32_bf16 v40, v202, v31, v40
    v_dot2_f32_bf16 v44, v202, v202, v44
    v_dot2_f32_bf16 v41, v203, v31, v41
    v_dot2_f32_bf16 v45, v203, v203, v45
    v_dot2_f32_bf16 v42, v204, v31, v42
    v_dot2_f32_bf16 v46, v204, v204, v46
    v_dot2_f32_bf16 v43, v205, v31, v43
    v_dot2_f32_bf16 v47, v205, v205, v47
    v_dot2_f32_bf16 v42, v206, v31, v42
    v_dot2_f32_bf16 v46, v206, v206, v46
    v_dot2_f32_bf16 v43, v207, v31, v43
    v_dot2_f32_bf16 v47, v207, v207, v47
    v_dot2_f32_bf16 v40, v208, v31, v40
    v_dot2_f32_bf16 v44, v208, v208, v44
    v_dot2_f32_bf16 v41, v209, v31, v41
    v_dot2_f32_bf16 v45, v209, v209, v45
    v_dot2_f32_bf16 v40, v210, v31, v40
    v_dot2_f32_bf16 v44, v210, v210, v44
    v_dot2_f32_bf16 v41, v211, v31, v41
    v_dot2_f32_bf16 v45, v211, v211, v45
    v_dot2_f32_bf16 v42, v212, v31, v42
    v_dot2_f32_bf16 v46, v212, v212, v46
    v_dot2_f32_bf16 v43, v213, v31, v43
    v_dot2_f32_bf16 v47, v213, v213, v47
    v_dot2_f32_bf16 v42, v214, v31, v42
    v_dot2_f32_bf16 v46, v214, v214, v46
    v_dot2_f32_bf16 v43, v215, v31, v43
    v_dot2_f32_bf16 v47, v215, v215, v47
    v_dot2_f32_bf16 v40, v216, v31, v40
    v_dot2_f32_bf16 v44, v216, v216, v44
    v_dot2_f32_bf16 v41, v217, v31, v41
    v_dot2_f32_bf16 v45, v217, v217, v45
    v_dot2_f32_bf16 v40, v218, v31, v40
    v_dot2_f32_bf16 v44, v218, v218, v44
    v_dot2_f32_bf16 v41, v219, v31, v41
    v_dot2_f32_bf16 v45, v219, v219, v45
    v_dot2_f32_bf16 v42, v220, v31, v42
    v_dot2_f32_bf16 v46, v220, v220, v46
    v_dot2_f32_bf16 v43, v221, v31, v43
    v_dot2_f32_bf16 v47, v221, v221, v47
    v_dot2_f32_bf16 v42, v222, v31, v42
    v_dot2_f32_bf16 v46, v222, v222, v46
    v_dot2_f32_bf16 v43, v223, v31, v43
    v_dot2_f32_bf16 v47, v223, v223, v47
    v_dot2_f32_bf16 v40, v224, v31, v40
    v_dot2_f32_bf16 v44, v224, v224, v44
    v_dot2_f32_bf16 v41, v225, v31, v41
    v_dot2_f32_bf16 v45, v225, v225, v45
    v_dot2_f32_bf16 v40, v226, v31, v40
    v_dot2_f32_bf16 v44, v226, v226, v44
    v_dot2_f32_bf16 v41, v227, v31, v41
    v_dot2_f32_bf16 v45, v227, v227, v45
    v_dot2_f32_bf16 v42, v228, v31, v42
    v_dot2_f32_bf16 v46, v228, v228, v46
    v_dot2_f32_bf16 v43, v229, v31, v43
    v_dot2_f32_bf16 v47, v229, v229, v47
    v_dot2_f32_bf16 v42, v230, v31, v42
    v_dot2_f32_bf16 v46, v230, v230, v46
    v_dot2_f32_bf16 v43, v231, v31, v43
    v_dot2_f32_bf16 v47, v231, v231, v47
    v_dot2_f32_bf16 v40, v232, v31, v40
    v_dot2_f32_bf16 v44, v232, v232, v44
    v_dot2_f32_bf16 v41, v233, v31, v41
    v_dot2_f32_bf16 v45, v233, v233, v45
    v_dot2_f32_bf16 v40, v234, v31, v40
    v_dot2_f32_bf16 v44, v234, v234, v44
    v_dot2_f32_bf16 v41, v235, v31, v41
    v_dot2_f32_bf16 v45, v235, v235, v45
    v_dot2_f32_bf16 v42, v236, v31, v42
    v_dot2_f32_bf16 v46, v236, v236, v46
    v_dot2_f32_bf16 v43, v237, v31, v43
    v_dot2_f32_bf16 v47, v237, v237, v47
    v_dot2_f32_bf16 v42, v238, v31, v42
    v_dot2_f32_bf16 v46, v238, v238, v46
    v_dot2_f32_bf16 v43, v239, v31, v43
    v_dot2_f32_bf16 v47, v239, v239, v47
    s_nop 3
    v_add_f32 v40, v40, v41
    v_add_f32 v44, v44, v45
    v_mov_b32 v41, v40
    s_nop 1
    v_permlane32_swap_b32 v40, v41
    s_nop 1
    v_add_f32 v40, v40, v41
    v_mov_b32 v41, v40
    s_nop 1
    v_permlane16_swap_b32 v40, v41
    s_nop 1
    v_add_f32 v40, v40, v41
    v_mov_b32 v45, v44
    s_nop 1
    v_permlane32_swap_b32 v44, v45
    s_nop 1
    v_add_f32 v44, v44, v45
    v_mov_b32 v45, v44
    s_nop 1
    v_permlane16_swap_b32 v44, v45
    s_nop 1
    v_add_f32 v44, v44, v45
    v_mul_f32 v40, 0x3b124925, v40
    v_mul_f32 v44, 0x3b124925, v44
    v_fma_f32 v44, -v40, v40, v44
    v_max_f32 v44, 0, v44
    v_add_f32 v44, 0x3727c5ac, v44
    v_rsq_f32 v88, v44
    s_nop 0
    v_mov_b32 v89, v88
    v_mul_f32 v90, v40, v88
    v_sub_f32 v90, 0, v90
    v_mov_b32 v91, v90
    v_add_f32 v42, v42, v43
    v_add_f32 v46, v46, v47
    v_mov_b32 v43, v42
    s_nop 1
    v_permlane32_swap_b32 v42, v43
    s_nop 1
    v_add_f32 v42, v42, v43
    v_mov_b32 v43, v42
    s_nop 1
    v_permlane16_swap_b32 v42, v43
    s_nop 1
    v_add_f32 v42, v42, v43
    v_mov_b32 v47, v46
    s_nop 1
    v_permlane32_swap_b32 v46, v47
    s_nop 1
    v_add_f32 v46, v46, v47
    v_mov_b32 v47, v46
    s_nop 1
    v_permlane16_swap_b32 v46, v47
    s_nop 1
    v_add_f32 v46, v46, v47
    v_mul_f32 v42, 0x3b124925, v42
    v_mul_f32 v46, 0x3b124925, v46
    v_fma_f32 v46, -v42, v42, v46
    v_max_f32 v46, 0, v46
    v_add_f32 v46, 0x3727c5ac, v46
    v_rsq_f32 v92, v46
    s_nop 0
    v_mov_b32 v93, v92
    v_mul_f32 v94, v42, v92
    v_sub_f32 v94, 0, v94
    v_mov_b32 v95, v94
    v_lshlrev_b32 v80, 16, v128
    v_and_b32 v81, 0xffff0000, v128
    v_pk_fma_f32 v[80:81], v[80:81], v[88:89], v[90:91]
    v_cvt_pk_bf16_f32 v128, v80, v81
    v_lshlrev_b32 v82, 16, v129
    v_and_b32 v83, 0xffff0000, v129
    v_pk_fma_f32 v[82:83], v[82:83], v[88:89], v[90:91]
    v_cvt_pk_bf16_f32 v129, v82, v83
    v_lshlrev_b32 v84, 16, v130
    v_and_b32 v85, 0xffff0000, v130
    v_pk_fma_f32 v[84:85], v[84:85], v[88:89], v[90:91]
    v_cvt_pk_bf16_f32 v130, v84, v85
    v_lshlrev_b32 v86, 16, v131
    v_and_b32 v87, 0xffff0000, v131
    v_pk_fma_f32 v[86:87], v[86:87], v[88:89], v[90:91]
    v_cvt_pk_bf16_f32 v131, v86, v87
    v_lshlrev_b32 v80, 16, v132
    v_and_b32 v81, 0xffff0000, v132
    v_pk_fma_f32 v[80:81], v[80:81], v[92:93], v[94:95]
    v_cvt_pk_bf16_f32 v132, v80, v81
    v_lshlrev_b32 v82, 16, v133
    v_and_b32 v83, 0xffff0000, v133
    v_pk_fma_f32 v[82:83], v[82:83], v[92:93], v[94:95]
    v_cvt_pk_bf16_f32 v133, v82, v83
    v_lshlrev_b32 v84, 16, v134
    v_and_b32 v85, 0xffff0000, v134
    v_pk_fma_f32 v[84:85], v[84:85], v[92:93], v[94:95]
    v_cvt_pk_bf16_f32 v134, v84, v85
    v_lshlrev_b32 v86, 16, v135
    v_and_b32 v87, 0xffff0000, v135
    v_pk_fma_f32 v[86:87], v[86:87], v[92:93], v[94:95]
    v_cvt_pk_bf16_f32 v135, v86, v87
    v_lshlrev_b32 v80, 16, v136
    v_and_b32 v81, 0xffff0000, v136
    v_pk_fma_f32 v[80:81], v[80:81], v[88:89], v[90:91]
    v_cvt_pk_bf16_f32 v136, v80, v81
    v_lshlrev_b32 v82, 16, v137
    v_and_b32 v83, 0xffff0000, v137
    v_pk_fma_f32 v[82:83], v[82:83], v[88:89], v[90:91]
    v_cvt_pk_bf16_f32 v137, v82, v83
    v_lshlrev_b32 v84, 16, v138
    v_and_b32 v85, 0xffff0000, v138
    v_pk_fma_f32 v[84:85], v[84:85], v[88:89], v[90:91]
    v_cvt_pk_bf16_f32 v138, v84, v85
    v_lshlrev_b32 v86, 16, v139
    v_and_b32 v87, 0xffff0000, v139
    v_pk_fma_f32 v[86:87], v[86:87], v[88:89], v[90:91]
    v_cvt_pk_bf16_f32 v139, v86, v87
    v_lshlrev_b32 v80, 16, v140
    v_and_b32 v81, 0xffff0000, v140
    v_pk_fma_f32 v[80:81], v[80:81], v[92:93], v[94:95]
    v_cvt_pk_bf16_f32 v140, v80, v81
    v_lshlrev_b32 v82, 16, v141
    v_and_b32 v83, 0xffff0000, v141
    v_pk_fma_f32 v[82:83], v[82:83], v[92:93], v[94:95]
    v_cvt_pk_bf16_f32 v141, v82, v83
    v_lshlrev_b32 v84, 16, v142
    v_and_b32 v85, 0xffff0000, v142
    v_pk_fma_f32 v[84:85], v[84:85], v[92:93], v[94:95]
    v_cvt_pk_bf16_f32 v142, v84, v85
    v_lshlrev_b32 v86, 16, v143
    v_and_b32 v87, 0xffff0000, v143
    v_pk_fma_f32 v[86:87], v[86:87], v[92:93], v[94:95]
    v_cvt_pk_bf16_f32 v143, v86, v87
    v_lshlrev_b32 v80, 16, v144
    v_and_b32 v81, 0xffff0000, v144
    v_pk_fma_f32 v[80:81], v[80:81], v[88:89], v[90:91]
    v_cvt_pk_bf16_f32 v144, v80, v81
    v_lshlrev_b32 v82, 16, v145
    v_and_b32 v83, 0xffff0000, v145
    v_pk_fma_f32 v[82:83], v[82:83], v[88:89], v[90:91]
    v_cvt_pk_bf16_f32 v145, v82, v83
    v_lshlrev_b32 v84, 16, v146
    v_and_b32 v85, 0xffff0000, v146
    v_pk_fma_f32 v[84:85], v[84:85], v[88:89], v[90:91]
    v_cvt_pk_bf16_f32 v146, v84, v85
    v_lshlrev_b32 v86, 16, v147
    v_and_b32 v87, 0xffff0000, v147
    v_pk_fma_f32 v[86:87], v[86:87], v[88:89], v[90:91]
    v_cvt_pk_bf16_f32 v147, v86, v87
    v_lshlrev_b32 v80, 16, v148
    v_and_b32 v81, 0xffff0000, v148
    v_pk_fma_f32 v[80:81], v[80:81], v[92:93], v[94:95]
    v_cvt_pk_bf16_f32 v148, v80, v81
    v_lshlrev_b32 v82, 16, v149
    v_and_b32 v83, 0xffff0000, v149
    v_pk_fma_f32 v[82:83], v[82:83], v[92:93], v[94:95]
    v_cvt_pk_bf16_f32 v149, v82, v83
    v_lshlrev_b32 v84, 16, v150
    v_and_b32 v85, 0xffff0000, v150
    v_pk_fma_f32 v[84:85], v[84:85], v[92:93], v[94:95]
    v_cvt_pk_bf16_f32 v150, v84, v85
    v_lshlrev_b32 v86, 16, v151
    v_and_b32 v87, 0xffff0000, v151
    v_pk_fma_f32 v[86:87], v[86:87], v[92:93], v[94:95]
    v_cvt_pk_bf16_f32 v151, v86, v87
    v_lshlrev_b32 v80, 16, v152
    v_and_b32 v81, 0xffff0000, v152
    v_pk_fma_f32 v[80:81], v[80:81], v[88:89], v[90:91]
    v_cvt_pk_bf16_f32 v152, v80, v81
    v_lshlrev_b32 v82, 16, v153
    v_and_b32 v83, 0xffff0000, v153
    v_pk_fma_f32 v[82:83], v[82:83], v[88:89], v[90:91]
    v_cvt_pk_bf16_f32 v153, v82, v83
    v_lshlrev_b32 v84, 16, v154
    v_and_b32 v85, 0xffff0000, v154
    v_pk_fma_f32 v[84:85], v[84:85], v[88:89], v[90:91]
    v_cvt_pk_bf16_f32 v154, v84, v85
    v_lshlrev_b32 v86, 16, v155
    v_and_b32 v87, 0xffff0000, v155
    v_pk_fma_f32 v[86:87], v[86:87], v[88:89], v[90:91]
    v_cvt_pk_bf16_f32 v155, v86, v87
    v_lshlrev_b32 v80, 16, v156
    v_and_b32 v81, 0xffff0000, v156
    v_pk_fma_f32 v[80:81], v[80:81], v[92:93], v[94:95]
    v_cvt_pk_bf16_f32 v156, v80, v81
    v_lshlrev_b32 v82, 16, v157
    v_and_b32 v83, 0xffff0000, v157
    v_pk_fma_f32 v[82:83], v[82:83], v[92:93], v[94:95]
    v_cvt_pk_bf16_f32 v157, v82, v83
    v_lshlrev_b32 v84, 16, v158
    v_and_b32 v85, 0xffff0000, v158
    v_pk_fma_f32 v[84:85], v[84:85], v[92:93], v[94:95]
    v_cvt_pk_bf16_f32 v158, v84, v85
    v_lshlrev_b32 v86, 16, v159
    v_and_b32 v87, 0xffff0000, v159
    v_pk_fma_f32 v[86:87], v[86:87], v[92:93], v[94:95]
    v_cvt_pk_bf16_f32 v159, v86, v87
    v_lshlrev_b32 v80, 16, v160
    v_and_b32 v81, 0xffff0000, v160
    v_pk_fma_f32 v[80:81], v[80:81], v[88:89], v[90:91]
    v_cvt_pk_bf16_f32 v160, v80, v81
    v_lshlrev_b32 v82, 16, v161
    v_and_b32 v83, 0xffff0000, v161
    v_pk_fma_f32 v[82:83], v[82:83], v[88:89], v[90:91]
    v_cvt_pk_bf16_f32 v161, v82, v83
    v_lshlrev_b32 v84, 16, v162
    v_and_b32 v85, 0xffff0000, v162
    v_pk_fma_f32 v[84:85], v[84:85], v[88:89], v[90:91]
    v_cvt_pk_bf16_f32 v162, v84, v85
    v_lshlrev_b32 v86, 16, v163
    v_and_b32 v87, 0xffff0000, v163
    v_pk_fma_f32 v[86:87], v[86:87], v[88:89], v[90:91]
    v_cvt_pk_bf16_f32 v163, v86, v87
    v_lshlrev_b32 v80, 16, v164
    v_and_b32 v81, 0xffff0000, v164
    v_pk_fma_f32 v[80:81], v[80:81], v[92:93], v[94:95]
    v_cvt_pk_bf16_f32 v164, v80, v81
    v_lshlrev_b32 v82, 16, v165
    v_and_b32 v83, 0xffff0000, v165
    v_pk_fma_f32 v[82:83], v[82:83], v[92:93], v[94:95]
    v_cvt_pk_bf16_f32 v165, v82, v83
    v_lshlrev_b32 v84, 16, v166
    v_and_b32 v85, 0xffff0000, v166
    v_pk_fma_f32 v[84:85], v[84:85], v[92:93], v[94:95]
    v_cvt_pk_bf16_f32 v166, v84, v85
    v_lshlrev_b32 v86, 16, v167
    v_and_b32 v87, 0xffff0000, v167
    v_pk_fma_f32 v[86:87], v[86:87], v[92:93], v[94:95]
    v_cvt_pk_bf16_f32 v167, v86, v87
    v_lshlrev_b32 v80, 16, v168
    v_and_b32 v81, 0xffff0000, v168
    v_pk_fma_f32 v[80:81], v[80:81], v[88:89], v[90:91]
    v_cvt_pk_bf16_f32 v168, v80, v81
    v_lshlrev_b32 v82, 16, v169
    v_and_b32 v83, 0xffff0000, v169
    v_pk_fma_f32 v[82:83], v[82:83], v[88:89], v[90:91]
    v_cvt_pk_bf16_f32 v169, v82, v83
    v_lshlrev_b32 v84, 16, v170
    v_and_b32 v85, 0xffff0000, v170
    v_pk_fma_f32 v[84:85], v[84:85], v[88:89], v[90:91]
    v_cvt_pk_bf16_f32 v170, v84, v85
    v_lshlrev_b32 v86, 16, v171
    v_and_b32 v87, 0xffff0000, v171
    v_pk_fma_f32 v[86:87], v[86:87], v[88:89], v[90:91]
    v_cvt_pk_bf16_f32 v171, v86, v87
    v_lshlrev_b32 v80, 16, v172
    v_and_b32 v81, 0xffff0000, v172
    v_pk_fma_f32 v[80:81], v[80:81], v[92:93], v[94:95]
    v_cvt_pk_bf16_f32 v172, v80, v81
    v_lshlrev_b32 v82, 16, v173
    v_and_b32 v83, 0xffff0000, v173
    v_pk_fma_f32 v[82:83], v[82:83], v[92:93], v[94:95]
    v_cvt_pk_bf16_f32 v173, v82, v83
    v_lshlrev_b32 v84, 16, v174
    v_and_b32 v85, 0xffff0000, v174
    v_pk_fma_f32 v[84:85], v[84:85], v[92:93], v[94:95]
    v_cvt_pk_bf16_f32 v174, v84, v85
    v_lshlrev_b32 v86, 16, v175
    v_and_b32 v87, 0xffff0000, v175
    v_pk_fma_f32 v[86:87], v[86:87], v[92:93], v[94:95]
    v_cvt_pk_bf16_f32 v175, v86, v87
    v_lshlrev_b32 v80, 16, v176
    v_and_b32 v81, 0xffff0000, v176
    v_pk_fma_f32 v[80:81], v[80:81], v[88:89], v[90:91]
    v_cvt_pk_bf16_f32 v176, v80, v81
    v_lshlrev_b32 v82, 16, v177
    v_and_b32 v83, 0xffff0000, v177
    v_pk_fma_f32 v[82:83], v[82:83], v[88:89], v[90:91]
    v_cvt_pk_bf16_f32 v177, v82, v83
    v_lshlrev_b32 v84, 16, v178
    v_and_b32 v85, 0xffff0000, v178
    v_pk_fma_f32 v[84:85], v[84:85], v[88:89], v[90:91]
    v_cvt_pk_bf16_f32 v178, v84, v85
    v_lshlrev_b32 v86, 16, v179
    v_and_b32 v87, 0xffff0000, v179
    v_pk_fma_f32 v[86:87], v[86:87], v[88:89], v[90:91]
    v_cvt_pk_bf16_f32 v179, v86, v87
    v_lshlrev_b32 v80, 16, v180
    v_and_b32 v81, 0xffff0000, v180
    v_pk_fma_f32 v[80:81], v[80:81], v[92:93], v[94:95]
    v_cvt_pk_bf16_f32 v180, v80, v81
    v_lshlrev_b32 v82, 16, v181
    v_and_b32 v83, 0xffff0000, v181
    v_pk_fma_f32 v[82:83], v[82:83], v[92:93], v[94:95]
    v_cvt_pk_bf16_f32 v181, v82, v83
    v_lshlrev_b32 v84, 16, v182
    v_and_b32 v85, 0xffff0000, v182
    v_pk_fma_f32 v[84:85], v[84:85], v[92:93], v[94:95]
    v_cvt_pk_bf16_f32 v182, v84, v85
    v_lshlrev_b32 v86, 16, v183
    v_and_b32 v87, 0xffff0000, v183
    v_pk_fma_f32 v[86:87], v[86:87], v[92:93], v[94:95]
    v_cvt_pk_bf16_f32 v183, v86, v87
    v_lshlrev_b32 v80, 16, v184
    v_and_b32 v81, 0xffff0000, v184
    v_pk_fma_f32 v[80:81], v[80:81], v[88:89], v[90:91]
    v_cvt_pk_bf16_f32 v184, v80, v81
    v_lshlrev_b32 v82, 16, v185
    v_and_b32 v83, 0xffff0000, v185
    v_pk_fma_f32 v[82:83], v[82:83], v[88:89], v[90:91]
    v_cvt_pk_bf16_f32 v185, v82, v83
    v_lshlrev_b32 v84, 16, v186
    v_and_b32 v85, 0xffff0000, v186
    v_pk_fma_f32 v[84:85], v[84:85], v[88:89], v[90:91]
    v_cvt_pk_bf16_f32 v186, v84, v85
    v_lshlrev_b32 v86, 16, v187
    v_and_b32 v87, 0xffff0000, v187
    v_pk_fma_f32 v[86:87], v[86:87], v[88:89], v[90:91]
    v_cvt_pk_bf16_f32 v187, v86, v87
    v_lshlrev_b32 v80, 16, v188
    v_and_b32 v81, 0xffff0000, v188
    v_pk_fma_f32 v[80:81], v[80:81], v[92:93], v[94:95]
    v_cvt_pk_bf16_f32 v188, v80, v81
    v_lshlrev_b32 v82, 16, v189
    v_and_b32 v83, 0xffff0000, v189
    v_pk_fma_f32 v[82:83], v[82:83], v[92:93], v[94:95]
    v_cvt_pk_bf16_f32 v189, v82, v83
    v_lshlrev_b32 v84, 16, v190
    v_and_b32 v85, 0xffff0000, v190
    v_pk_fma_f32 v[84:85], v[84:85], v[92:93], v[94:95]
    v_cvt_pk_bf16_f32 v190, v84, v85
    v_lshlrev_b32 v86, 16, v191
    v_and_b32 v87, 0xffff0000, v191
    v_pk_fma_f32 v[86:87], v[86:87], v[92:93], v[94:95]
    v_cvt_pk_bf16_f32 v191, v86, v87
    v_lshlrev_b32 v80, 16, v192
    v_and_b32 v81, 0xffff0000, v192
    v_pk_fma_f32 v[80:81], v[80:81], v[88:89], v[90:91]
    v_cvt_pk_bf16_f32 v192, v80, v81
    v_lshlrev_b32 v82, 16, v193
    v_and_b32 v83, 0xffff0000, v193
    v_pk_fma_f32 v[82:83], v[82:83], v[88:89], v[90:91]
    v_cvt_pk_bf16_f32 v193, v82, v83
    v_lshlrev_b32 v84, 16, v194
    v_and_b32 v85, 0xffff0000, v194
    v_pk_fma_f32 v[84:85], v[84:85], v[88:89], v[90:91]
    v_cvt_pk_bf16_f32 v194, v84, v85
    v_lshlrev_b32 v86, 16, v195
    v_and_b32 v87, 0xffff0000, v195
    v_pk_fma_f32 v[86:87], v[86:87], v[88:89], v[90:91]
    v_cvt_pk_bf16_f32 v195, v86, v87
    v_lshlrev_b32 v80, 16, v196
    v_and_b32 v81, 0xffff0000, v196
    v_pk_fma_f32 v[80:81], v[80:81], v[92:93], v[94:95]
    v_cvt_pk_bf16_f32 v196, v80, v81
    v_lshlrev_b32 v82, 16, v197
    v_and_b32 v83, 0xffff0000, v197
    v_pk_fma_f32 v[82:83], v[82:83], v[92:93], v[94:95]
    v_cvt_pk_bf16_f32 v197, v82, v83
    v_lshlrev_b32 v84, 16, v198
    v_and_b32 v85, 0xffff0000, v198
    v_pk_fma_f32 v[84:85], v[84:85], v[92:93], v[94:95]
    v_cvt_pk_bf16_f32 v198, v84, v85
    v_lshlrev_b32 v86, 16, v199
    v_and_b32 v87, 0xffff0000, v199
    v_pk_fma_f32 v[86:87], v[86:87], v[92:93], v[94:95]
    v_cvt_pk_bf16_f32 v199, v86, v87
    v_lshlrev_b32 v80, 16, v200
    v_and_b32 v81, 0xffff0000, v200
    v_pk_fma_f32 v[80:81], v[80:81], v[88:89], v[90:91]
    v_cvt_pk_bf16_f32 v200, v80, v81
    v_lshlrev_b32 v82, 16, v201
    v_and_b32 v83, 0xffff0000, v201
    v_pk_fma_f32 v[82:83], v[82:83], v[88:89], v[90:91]
    v_cvt_pk_bf16_f32 v201, v82, v83
    v_lshlrev_b32 v84, 16, v202
    v_and_b32 v85, 0xffff0000, v202
    v_pk_fma_f32 v[84:85], v[84:85], v[88:89], v[90:91]
    v_cvt_pk_bf16_f32 v202, v84, v85
    v_lshlrev_b32 v86, 16, v203
    v_and_b32 v87, 0xffff0000, v203
    v_pk_fma_f32 v[86:87], v[86:87], v[88:89], v[90:91]
    v_cvt_pk_bf16_f32 v203, v86, v87
    v_lshlrev_b32 v80, 16, v204
    v_and_b32 v81, 0xffff0000, v204
    v_pk_fma_f32 v[80:81], v[80:81], v[92:93], v[94:95]
    v_cvt_pk_bf16_f32 v204, v80, v81
    v_lshlrev_b32 v82, 16, v205
    v_and_b32 v83, 0xffff0000, v205
    v_pk_fma_f32 v[82:83], v[82:83], v[92:93], v[94:95]
    v_cvt_pk_bf16_f32 v205, v82, v83
    v_lshlrev_b32 v84, 16, v206
    v_and_b32 v85, 0xffff0000, v206
    v_pk_fma_f32 v[84:85], v[84:85], v[92:93], v[94:95]
    v_cvt_pk_bf16_f32 v206, v84, v85
    v_lshlrev_b32 v86, 16, v207
    v_and_b32 v87, 0xffff0000, v207
    v_pk_fma_f32 v[86:87], v[86:87], v[92:93], v[94:95]
    v_cvt_pk_bf16_f32 v207, v86, v87
    v_lshlrev_b32 v80, 16, v208
    v_and_b32 v81, 0xffff0000, v208
    v_pk_fma_f32 v[80:81], v[80:81], v[88:89], v[90:91]
    v_cvt_pk_bf16_f32 v208, v80, v81
    v_lshlrev_b32 v82, 16, v209
    v_and_b32 v83, 0xffff0000, v209
    v_pk_fma_f32 v[82:83], v[82:83], v[88:89], v[90:91]
    v_cvt_pk_bf16_f32 v209, v82, v83
    v_lshlrev_b32 v84, 16, v210
    v_and_b32 v85, 0xffff0000, v210
    v_pk_fma_f32 v[84:85], v[84:85], v[88:89], v[90:91]
    v_cvt_pk_bf16_f32 v210, v84, v85
    v_lshlrev_b32 v86, 16, v211
    v_and_b32 v87, 0xffff0000, v211
    v_pk_fma_f32 v[86:87], v[86:87], v[88:89], v[90:91]
    v_cvt_pk_bf16_f32 v211, v86, v87
    v_lshlrev_b32 v80, 16, v212
    v_and_b32 v81, 0xffff0000, v212
    v_pk_fma_f32 v[80:81], v[80:81], v[92:93], v[94:95]
    v_cvt_pk_bf16_f32 v212, v80, v81
    v_lshlrev_b32 v82, 16, v213
    v_and_b32 v83, 0xffff0000, v213
    v_pk_fma_f32 v[82:83], v[82:83], v[92:93], v[94:95]
    v_cvt_pk_bf16_f32 v213, v82, v83
    v_lshlrev_b32 v84, 16, v214
    v_and_b32 v85, 0xffff0000, v214
    v_pk_fma_f32 v[84:85], v[84:85], v[92:93], v[94:95]
    v_cvt_pk_bf16_f32 v214, v84, v85
    v_lshlrev_b32 v86, 16, v215
    v_and_b32 v87, 0xffff0000, v215
    v_pk_fma_f32 v[86:87], v[86:87], v[92:93], v[94:95]
    v_cvt_pk_bf16_f32 v215, v86, v87
    v_lshlrev_b32 v80, 16, v216
    v_and_b32 v81, 0xffff0000, v216
    v_pk_fma_f32 v[80:81], v[80:81], v[88:89], v[90:91]
    v_cvt_pk_bf16_f32 v216, v80, v81
    v_lshlrev_b32 v82, 16, v217
    v_and_b32 v83, 0xffff0000, v217
    v_pk_fma_f32 v[82:83], v[82:83], v[88:89], v[90:91]
    v_cvt_pk_bf16_f32 v217, v82, v83
    v_lshlrev_b32 v84, 16, v218
    v_and_b32 v85, 0xffff0000, v218
    v_pk_fma_f32 v[84:85], v[84:85], v[88:89], v[90:91]
    v_cvt_pk_bf16_f32 v218, v84, v85
    v_lshlrev_b32 v86, 16, v219
    v_and_b32 v87, 0xffff0000, v219
    v_pk_fma_f32 v[86:87], v[86:87], v[88:89], v[90:91]
    v_cvt_pk_bf16_f32 v219, v86, v87
    v_lshlrev_b32 v80, 16, v220
    v_and_b32 v81, 0xffff0000, v220
    v_pk_fma_f32 v[80:81], v[80:81], v[92:93], v[94:95]
    v_cvt_pk_bf16_f32 v220, v80, v81
    v_lshlrev_b32 v82, 16, v221
    v_and_b32 v83, 0xffff0000, v221
    v_pk_fma_f32 v[82:83], v[82:83], v[92:93], v[94:95]
    v_cvt_pk_bf16_f32 v221, v82, v83
    v_lshlrev_b32 v84, 16, v222
    v_and_b32 v85, 0xffff0000, v222
    v_pk_fma_f32 v[84:85], v[84:85], v[92:93], v[94:95]
    v_cvt_pk_bf16_f32 v222, v84, v85
    v_lshlrev_b32 v86, 16, v223
    v_and_b32 v87, 0xffff0000, v223
    v_pk_fma_f32 v[86:87], v[86:87], v[92:93], v[94:95]
    v_cvt_pk_bf16_f32 v223, v86, v87
    v_lshlrev_b32 v80, 16, v224
    v_and_b32 v81, 0xffff0000, v224
    v_pk_fma_f32 v[80:81], v[80:81], v[88:89], v[90:91]
    v_cvt_pk_bf16_f32 v224, v80, v81
    v_lshlrev_b32 v82, 16, v225
    v_and_b32 v83, 0xffff0000, v225
    v_pk_fma_f32 v[82:83], v[82:83], v[88:89], v[90:91]
    v_cvt_pk_bf16_f32 v225, v82, v83
    v_lshlrev_b32 v84, 16, v226
    v_and_b32 v85, 0xffff0000, v226
    v_pk_fma_f32 v[84:85], v[84:85], v[88:89], v[90:91]
    v_cvt_pk_bf16_f32 v226, v84, v85
    v_lshlrev_b32 v86, 16, v227
    v_and_b32 v87, 0xffff0000, v227
    v_pk_fma_f32 v[86:87], v[86:87], v[88:89], v[90:91]
    v_cvt_pk_bf16_f32 v227, v86, v87
    v_lshlrev_b32 v80, 16, v228
    v_and_b32 v81, 0xffff0000, v228
    v_pk_fma_f32 v[80:81], v[80:81], v[92:93], v[94:95]
    v_cvt_pk_bf16_f32 v228, v80, v81
    v_lshlrev_b32 v82, 16, v229
    v_and_b32 v83, 0xffff0000, v229
    v_pk_fma_f32 v[82:83], v[82:83], v[92:93], v[94:95]
    v_cvt_pk_bf16_f32 v229, v82, v83
    v_lshlrev_b32 v84, 16, v230
    v_and_b32 v85, 0xffff0000, v230
    v_pk_fma_f32 v[84:85], v[84:85], v[92:93], v[94:95]
    v_cvt_pk_bf16_f32 v230, v84, v85
    v_lshlrev_b32 v86, 16, v231
    v_and_b32 v87, 0xffff0000, v231
    v_pk_fma_f32 v[86:87], v[86:87], v[92:93], v[94:95]
    v_cvt_pk_bf16_f32 v231, v86, v87
    v_lshlrev_b32 v80, 16, v232
    v_and_b32 v81, 0xffff0000, v232
    v_pk_fma_f32 v[80:81], v[80:81], v[88:89], v[90:91]
    v_cvt_pk_bf16_f32 v232, v80, v81
    v_lshlrev_b32 v82, 16, v233
    v_and_b32 v83, 0xffff0000, v233
    v_pk_fma_f32 v[82:83], v[82:83], v[88:89], v[90:91]
    v_cvt_pk_bf16_f32 v233, v82, v83
    v_lshlrev_b32 v84, 16, v234
    v_and_b32 v85, 0xffff0000, v234
    v_pk_fma_f32 v[84:85], v[84:85], v[88:89], v[90:91]
    v_cvt_pk_bf16_f32 v234, v84, v85
    v_lshlrev_b32 v86, 16, v235
    v_and_b32 v87, 0xffff0000, v235
    v_pk_fma_f32 v[86:87], v[86:87], v[88:89], v[90:91]
    v_cvt_pk_bf16_f32 v235, v86, v87
    v_lshlrev_b32 v80, 16, v236
    v_and_b32 v81, 0xffff0000, v236
    v_pk_fma_f32 v[80:81], v[80:81], v[92:93], v[94:95]
    v_cvt_pk_bf16_f32 v236, v80, v81
    v_lshlrev_b32 v82, 16, v237
    v_and_b32 v83, 0xffff0000, v237
    v_pk_fma_f32 v[82:83], v[82:83], v[92:93], v[94:95]
    v_cvt_pk_bf16_f32 v237, v82, v83
    v_lshlrev_b32 v84, 16, v238
    v_and_b32 v85, 0xffff0000, v238
    v_pk_fma_f32 v[84:85], v[84:85], v[92:93], v[94:95]
    v_cvt_pk_bf16_f32 v238, v84, v85
    v_lshlrev_b32 v86, 16, v239
    v_and_b32 v87, 0xffff0000, v239
    v_pk_fma_f32 v[86:87], v[86:87], v[92:93], v[94:95]
    v_cvt_pk_bf16_f32 v239, v86, v87
    s_cmp_lg_u32 s30, 0
    s_cbranch_scc1 NOCW
    s_waitcnt vmcnt(0)
    v_lshlrev_b32 v6, 2, v2
    v_cmp_eq_u32 vcc, 3, v2
    v_mov_b32 v7, 0x01010101
    v_mov_b32 v32, 0x0101
    v_cndmask_b32 v7, v7, v32, vcc
POLL:
    buffer_load_dword v32, v6, s[56:59], 0 offen sc0 sc1
    s_waitcnt vmcnt(0)
    v_and_b32 v32, v32, v7
    v_cmp_eq_u32 vcc, v32, v7
    s_nop 3
    s_and_b32 s3, vcc_lo, 15
    s_cmp_eq_u32 s3, 15
    s_cbranch_scc1 POLLOK
    s_sleep 1
    s_branch POLL
POLLOK:
    v_lshlrev_b32 v6, 4, v2
    buffer_load_dwordx4 v[64:67], v6, s[24:27], 0 offen offset:0 sc0 sc1
    buffer_load_dwordx4 v[68:71], v6, s[24:27], 0 offen offset:1024 sc0 sc1
    buffer_load_dwordx4 v[72:75], v6, s[24:27], 0 offen offset:2048 sc0 sc1
    buffer_load_dwordx4 v[76:79], v6, s[24:27], 0 offen offset:3072 sc0 sc1
    s_waitcnt vmcnt(0)
    ds_write_b128 v6, v[64:67] offset:0
    ds_write_b128 v6, v[68:71] offset:1024
    ds_write_b128 v6, v[72:75] offset:2048
    ds_write_b128 v6, v[76:79] offset:3072
NOCW:
    s_waitcnt lgkmcnt(0) vmcnt(0)
    s_barrier
    v_lshlrev_b32 v6, 5, v3
    ds_read_b128 v[48:51], v6 offset:1792
    ds_read_b128 v[52:55], v6 offset:1808
    ds_read_b128 v[56:59], v6 offset:0
    ds_read_b128 v[60:63], v6 offset:16
    s_waitcnt lgkmcnt(0)
    v_lshlrev_b32 v80, 16, v128
    v_and_b32 v81, 0xffff0000, v128
    v_fma_f32 v80, v80, v48, v56
    v_fma_f32 v81, v81, v49, v57
    v_cvt_pk_bf16_f32 v128, v80, v81
    v_lshlrev_b32 v82, 16, v129
    v_and_b32 v83, 0xffff0000, v129
    v_fma_f32 v82, v82, v50, v58
    v_fma_f32 v83, v83, v51, v59
    v_cvt_pk_bf16_f32 v129, v82, v83
    v_lshlrev_b32 v84, 16, v130
    v_and_b32 v85, 0xffff0000, v130
    v_fma_f32 v84, v84, v52, v60
    v_fma_f32 v85, v85, v53, v61
    v_cvt_pk_bf16_f32 v130, v84, v85
    v_lshlrev_b32 v86, 16, v131
    v_and_b32 v87, 0xffff0000, v131
    v_fma_f32 v86, v86, v54, v62
    v_fma_f32 v87, v87, v55, v63
    v_cvt_pk_bf16_f32 v131, v86, v87
    v_lshlrev_b32 v80, 16, v132
    v_and_b32 v81, 0xffff0000, v132
    v_fma_f32 v80, v80, v48, v56
    v_fma_f32 v81, v81, v49, v57
    v_cvt_pk_bf16_f32 v132, v80, v81
    v_lshlrev_b32 v82, 16, v133
    v_and_b32 v83, 0xffff0000, v133
    v_fma_f32 v82, v82, v50, v58
    v_fma_f32 v83, v83, v51, v59
    v_cvt_pk_bf16_f32 v133, v82, v83
    v_lshlrev_b32 v84, 16, v134
    v_and_b32 v85, 0xffff0000, v134
    v_fma_f32 v84, v84, v52, v60
    v_fma_f32 v85, v85, v53, v61
    v_cvt_pk_bf16_f32 v134, v84, v85
    v_lshlrev_b32 v86, 16, v135
    v_and_b32 v87, 0xffff0000, v135
    v_fma_f32 v86, v86, v54, v62
    v_fma_f32 v87, v87, v55, v63
    v_cvt_pk_bf16_f32 v135, v86, v87
    s_add_u32 s33, s33, 32768
    ds_read_b64_tr_b16 a[192:193], v104 offset:32768
    ds_read_b64_tr_b16 a[194:195], v104 offset:36864
    ds_read_b64_tr_b16 a[196:197], v105 offset:32768
    ds_read_b64_tr_b16 a[198:199], v105 offset:36864
    ds_read_b64_tr_b16 a[200:201], v106 offset:32768
    ds_read_b64_tr_b16 a[202:203], v106 offset:36864
    ds_read_b64_tr_b16 a[204:205], v107 offset:32768
    ds_read_b64_tr_b16 a[206:207], v107 offset:36864
    ds_read_b64_tr_b16 a[208:209], v108 offset:32768
    ds_read_b64_tr_b16 a[210:211], v108 offset:36864
    ds_read_b64_tr_b16 a[212:213], v109 offset:32768
    ds_read_b64_tr_b16 a[214:215], v109 offset:36864
    ds_read_b64_tr_b16 a[216:217], v110 offset:32768
    ds_read_b64_tr_b16 a[218:219], v110 offset:36864
    ds_read_b64_tr_b16 a[220:221], v111 offset:32768
    ds_read_b128 v[48:51], v6 offset:1920
    s_waitcnt lgkmcnt(8)
    v_mfma_f32_16x16x32_bf16 a[0:3], a[192:195], v[128:131], 0
    ds_read_b64_tr_b16 a[222:223], v111 offset:36864
    ds_read_b128 v[52:55], v6 offset:1936
    v_mfma_f32_16x16x32_bf16 a[4:7], a[192:195], v[132:135], 0
    ds_read_b64_tr_b16 a[224:225], v104 offset:33024
    ds_read_b128 v[56:59], v6 offset:128
    v_mfma_f32_16x16x32_bf16 a[12:15], a[196:199], v[132:135], 0
    ds_read_b64_tr_b16 a[226:227], v104 offset:37120
    ds_read_b128 v[60:63], v6 offset:144
    v_mfma_f32_16x16x32_bf16 a[8:11], a[196:199], v[128:131], 0
    ds_read_b64_tr_b16 a[228:229], v105 offset:33024
    v_mfma_f32_16x16x32_bf16 a[16:19], a[200:203], v[128:131], 0
    ds_read_b64_tr_b16 a[230:231], v105 offset:37120
    v_mfma_f32_16x16x32_bf16 a[20:23], a[200:203], v[132:135], 0
    ds_read_b64_tr_b16 a[232:233], v106 offset:33024
    v_mfma_f32_16x16x32_bf16 a[28:31], a[204:207], v[132:135], 0
    ds_read_b64_tr_b16 a[234:235], v106 offset:37120
    v_mfma_f32_16x16x32_bf16 a[24:27], a[204:207], v[128:131], 0
    ds_read_b64_tr_b16 a[236:237], v107 offset:33024
    s_waitcnt lgkmcnt(5)
    v_mfma_f32_16x16x32_bf16 a[32:35], a[208:211], v[128:131], 0
    ds_read_b64_tr_b16 a[238:239], v107 offset:37120
    v_lshlrev_b32 v80, 16, v136
    v_and_b32 v81, 0xffff0000, v136
    v_mfma_f32_16x16x32_bf16 a[36:39], a[208:211], v[132:135], 0
    ds_read_b64_tr_b16 a[240:241], v108 offset:33024
    v_fma_f32 v80, v80, v48, v56
    v_fma_f32 v81, v81, v49, v57
    s_waitcnt vmcnt(16)
    s_barrier
    v_mfma_f32_16x16x32_bf16 a[44:47], a[212:215], v[132:135], 0
    ds_read_b64_tr_b16 a[242:243], v108 offset:37120
    v_cvt_pk_bf16_f32 v136, v80, v81
    v_lshlrev_b32 v82, 16, v137
    v_mfma_f32_16x16x32_bf16 a[40:43], a[212:215], v[128:131], 0
    ds_read_b64_tr_b16 a[244:245], v109 offset:33024
    v_and_b32 v83, 0xffff0000, v137
    v_fma_f32 v82, v82, v50, v58
    v_mfma_f32_16x16x32_bf16 a[48:51], a[216:219], v[128:131], 0
    ds_read_b64_tr_b16 a[246:247], v109 offset:37120
    v_fma_f32 v83, v83, v51, v59
    v_cvt_pk_bf16_f32 v137, v82, v83
    v_mfma_f32_16x16x32_bf16 a[52:55], a[216:219], v[132:135], 0
    ds_read_b64_tr_b16 a[248:249], v110 offset:33024
    v_lshlrev_b32 v84, 16, v138
    v_mfma_f32_16x16x32_bf16 a[60:63], a[220:223], v[132:135], 0
    ds_read_b64_tr_b16 a[250:251], v110 offset:37120
    v_and_b32 v85, 0xffff0000, v138
    v_fma_f32 v84, v84, v52, v60
    v_mfma_f32_16x16x32_bf16 a[56:59], a[220:223], v[128:131], 0
    ds_read_b64_tr_b16 a[252:253], v111 offset:33024
    v_fma_f32 v85, v85, v53, v61
    v_cvt_pk_bf16_f32 v138, v84, v85
    s_waitcnt lgkmcnt(7)
    v_mfma_f32_16x16x32_bf16 a[64:67], a[224:227], v[128:131], 0
    ds_read_b64_tr_b16 a[254:255], v111 offset:37120
    v_lshlrev_b32 v86, 16, v139
    v_and_b32 v87, 0xffff0000, v139
    v_mfma_f32_16x16x32_bf16 a[68:71], a[224:227], v[132:135], 0
    ds_read_b64_tr_b16 a[192:193], v104 offset:0
    v_fma_f32 v86, v86, v54, v62
    v_fma_f32 v87, v87, v55, v63
    v_mfma_f32_16x16x32_bf16 a[76:79], a[228:231], v[132:135], 0
    ds_read_b64_tr_b16 a[194:195], v104 offset:4096
    v_cvt_pk_bf16_f32 v139, v86, v87
    v_mfma_f32_16x16x32_bf16 a[72:75], a[228:231], v[128:131], 0
    ds_read_b64_tr_b16 a[196:197], v105 offset:0
    v_lshlrev_b32 v80, 16, v140
    v_and_b32 v81, 0xffff0000, v140
    v_mfma_f32_16x16x32_bf16 a[80:83], a[232:235], v[128:131], 0
    ds_read_b64_tr_b16 a[198:199], v105 offset:4096
    v_fma_f32 v80, v80, v48, v56
    v_fma_f32 v81, v81, v49, v57
    v_mfma_f32_16x16x32_bf16 a[84:87], a[232:235], v[132:135], 0
    ds_read_b64_tr_b16 a[200:201], v106 offset:0
    v_cvt_pk_bf16_f32 v140, v80, v81
    v_lshlrev_b32 v82, 16, v141
    v_mfma_f32_16x16x32_bf16 a[92:95], a[236:239], v[132:135], 0
    ds_read_b64_tr_b16 a[202:203], v106 offset:4096
    v_and_b32 v83, 0xffff0000, v141
    v_fma_f32 v82, v82, v50, v58
    v_mfma_f32_16x16x32_bf16 a[88:91], a[236:239], v[128:131], 0
    ds_read_b64_tr_b16 a[204:205], v107 offset:0
    v_fma_f32 v83, v83, v51, v59
    v_cvt_pk_bf16_f32 v141, v82, v83
    s_waitcnt lgkmcnt(7)
    v_mfma_f32_16x16x32_bf16 a[96:99], a[240:243], v[128:131], 0
    ds_read_b64_tr_b16 a[206:207], v107 offset:4096
    v_lshlrev_b32 v84, 16, v142
    v_mfma_f32_16x16x32_bf16 a[100:103], a[240:243], v[132:135], 0
    ds_read_b64_tr_b16 a[208:209], v108 offset:0
    v_and_b32 v85, 0xffff0000, v142
    v_fma_f32 v84, v84, v52, v60
    v_mfma_f32_16x16x32_bf16 a[108:111], a[244:247], v[132:135], 0
    ds_read_b64_tr_b16 a[210:211], v108 offset:4096
    v_fma_f32 v85, v85, v53, v61
    v_cvt_pk_bf16_f32 v142, v84, v85
    v_mfma_f32_16x16x32_bf16 a[104:107], a[244:247], v[128:131], 0
    ds_read_b64_tr_b16 a[212:213], v109 offset:0
    v_lshlrev_b32 v86, 16, v143
    v_and_b32 v87, 0xffff0000, v143
    v_mfma_f32_16x16x32_bf16 a[112:115], a[248:251], v[128:131], 0
    ds_read_b64_tr_b16 a[214:215], v109 offset:4096
    v_fma_f32 v86, v86, v54, v62
    v_fma_f32 v87, v87, v55, v63
    v_mfma_f32_16x16x32_bf16 a[116:119], a[248:251], v[132:135], 0
    ds_read_b64_tr_b16 a[216:217], v110 offset:0
    v_cvt_pk_bf16_f32 v143, v86, v87
    v_mfma_f32_16x16x32_bf16 a[124:127], a[252:255], v[132:135], 0
    ds_read_b64_tr_b16 a[218:219], v110 offset:4096
    v_mfma_f32_16x16x32_bf16 a[120:123], a[252:255], v[128:131], 0
    ds_read_b64_tr_b16 a[220:221], v111 offset:0
    ds_read_b128 v[48:51], v6 offset:2048
    s_waitcnt lgkmcnt(8)
    v_mfma_f32_16x16x32_bf16 a[0:3], a[192:195], v[136:139], a[0:3]
    ds_read_b64_tr_b16 a[222:223], v111 offset:4096
    ds_read_b128 v[52:55], v6 offset:2064
    v_mfma_f32_16x16x32_bf16 a[4:7], a[192:195], v[140:143], a[4:7]
    ds_read_b64_tr_b16 a[224:225], v104 offset:256
    ds_read_b128 v[56:59], v6 offset:256
    v_mfma_f32_16x16x32_bf16 a[12:15], a[196:199], v[140:143], a[12:15]
    ds_read_b64_tr_b16 a[226:227], v104 offset:4352
    ds_read_b128 v[60:63], v6 offset:272
    v_mfma_f32_16x16x32_bf16 a[8:11], a[196:199], v[136:139], a[8:11]
    ds_read_b64_tr_b16 a[228:229], v105 offset:256
    v_mfma_f32_16x16x32_bf16 a[16:19], a[200:203], v[136:139], a[16:19]
    ds_read_b64_tr_b16 a[230:231], v105 offset:4352
    v_mfma_f32_16x16x32_bf16 a[20:23], a[200:203], v[140:143], a[20:23]
    ds_read_b64_tr_b16 a[232:233], v106 offset:256
    v_mfma_f32_16x16x32_bf16 a[28:31], a[204:207], v[140:143], a[28:31]
    ds_read_b64_tr_b16 a[234:235], v106 offset:4352
    v_mfma_f32_16x16x32_bf16 a[24:27], a[204:207], v[136:139], a[24:27]
    ds_read_b64_tr_b16 a[236:237], v107 offset:256
    s_waitcnt lgkmcnt(5)
    v_mfma_f32_16x16x32_bf16 a[32:35], a[208:211], v[136:139], a[32:35]
    ds_read_b64_tr_b16 a[238:239], v107 offset:4352
    v_lshlrev_b32 v80, 16, v144
    v_and_b32 v81, 0xffff0000, v144
    v_mfma_f32_16x16x32_bf16 a[36:39], a[208:211], v[140:143], a[36:39]
    ds_read_b64_tr_b16 a[240:241], v108 offset:256
    v_fma_f32 v80, v80, v48, v56
    v_fma_f32 v81, v81, v49, v57
    s_waitcnt vmcnt(8)
    s_barrier
    v_mfma_f32_16x16x32_bf16 a[44:47], a[212:215], v[140:143], a[44:47]
    ds_read_b64_tr_b16 a[242:243], v108 offset:4352
    v_cvt_pk_bf16_f32 v144, v80, v81
    v_lshlrev_b32 v82, 16, v145
    v_mfma_f32_16x16x32_bf16 a[40:43], a[212:215], v[136:139], a[40:43]
    ds_read_b64_tr_b16 a[244:245], v109 offset:256
    v_and_b32 v83, 0xffff0000, v145
    v_fma_f32 v82, v82, v50, v58
    s_add_u32 m0, s44, 131072
    s_add_u32 s38, s37, 32768
    v_mfma_f32_16x16x32_bf16 a[48:51], a[216:219], v[136:139], a[48:51]
    ds_read_b64_tr_b16 a[246:247], v109 offset:4352
    v_fma_f32 v83, v83, v51, v59
    v_cvt_pk_bf16_f32 v145, v82, v83
    buffer_load_dwordx4 v24, s[16:19], s37 offen offset:0 lds
    v_mfma_f32_16x16x32_bf16 a[52:55], a[216:219], v[140:143], a[52:55]
    ds_read_b64_tr_b16 a[248:249], v110 offset:256
    v_lshlrev_b32 v84, 16, v146
    v_mfma_f32_16x16x32_bf16 a[60:63], a[220:223], v[140:143], a[60:63]
    ds_read_b64_tr_b16 a[250:251], v110 offset:4352
    v_and_b32 v85, 0xffff0000, v146
    v_fma_f32 v84, v84, v52, v60
    buffer_load_dwordx4 v25, s[16:19], s37 offen offset:1024 lds
    v_mfma_f32_16x16x32_bf16 a[56:59], a[220:223], v[136:139], a[56:59]
    ds_read_b64_tr_b16 a[252:253], v111 offset:256
    v_fma_f32 v85, v85, v53, v61
    v_cvt_pk_bf16_f32 v146, v84, v85
    s_waitcnt lgkmcnt(7)
    v_mfma_f32_16x16x32_bf16 a[64:67], a[224:227], v[136:139], a[64:67]
    ds_read_b64_tr_b16 a[254:255], v111 offset:4352
    v_lshlrev_b32 v86, 16, v147
    v_and_b32 v87, 0xffff0000, v147
    buffer_load_dwordx4 v26, s[16:19], s37 offen offset:2048 lds
    v_mfma_f32_16x16x32_bf16 a[68:71], a[224:227], v[140:143], a[68:71]
    ds_read_b64_tr_b16 a[192:193], v96 offset:0
    v_fma_f32 v86, v86, v54, v62
    v_fma_f32 v87, v87, v55, v63
    v_mfma_f32_16x16x32_bf16 a[76:79], a[228:231], v[140:143], a[76:79]
    ds_read_b64_tr_b16 a[194:195], v96 offset:4096
    v_cvt_pk_bf16_f32 v147, v86, v87
    buffer_load_dwordx4 v27, s[16:19], s37 offen offset:3072 lds
    v_mfma_f32_16x16x32_bf16 a[72:75], a[228:231], v[136:139], a[72:75]
    ds_read_b64_tr_b16 a[196:197], v97 offset:0
    v_lshlrev_b32 v80, 16, v148
    v_and_b32 v81, 0xffff0000, v148
    v_mfma_f32_16x16x32_bf16 a[80:83], a[232:235], v[136:139], a[80:83]
    ds_read_b64_tr_b16 a[198:199], v97 offset:4096
    v_fma_f32 v80, v80, v48, v56
    v_fma_f32 v81, v81, v49, v57
    s_add_u32 m0, s44, 135168
    s_add_u32 s37, s37, 262144
    v_mfma_f32_16x16x32_bf16 a[84:87], a[232:235], v[140:143], a[84:87]
    ds_read_b64_tr_b16 a[200:201], v98 offset:0
    v_cvt_pk_bf16_f32 v148, v80, v81
    v_lshlrev_b32 v82, 16, v149
    buffer_load_dwordx4 v24, s[16:19], s38 offen offset:0 lds
    v_mfma_f32_16x16x32_bf16 a[92:95], a[236:239], v[140:143], a[92:95]
    ds_read_b64_tr_b16 a[202:203], v98 offset:4096
    v_and_b32 v83, 0xffff0000, v149
    v_fma_f32 v82, v82, v50, v58
    v_mfma_f32_16x16x32_bf16 a[88:91], a[236:239], v[136:139], a[88:91]
    ds_read_b64_tr_b16 a[204:205], v99 offset:0
    v_fma_f32 v83, v83, v51, v59
    v_cvt_pk_bf16_f32 v149, v82, v83
    buffer_load_dwordx4 v25, s[16:19], s38 offen offset:1024 lds
    s_waitcnt lgkmcnt(7)
    v_mfma_f32_16x16x32_bf16 a[96:99], a[240:243], v[136:139], a[96:99]
    ds_read_b64_tr_b16 a[206:207], v99 offset:4096
    v_lshlrev_b32 v84, 16, v150
    v_mfma_f32_16x16x32_bf16 a[100:103], a[240:243], v[140:143], a[100:103]
    ds_read_b64_tr_b16 a[208:209], v100 offset:0
    v_and_b32 v85, 0xffff0000, v150
    v_fma_f32 v84, v84, v52, v60
    buffer_load_dwordx4 v26, s[16:19], s38 offen offset:2048 lds
    v_mfma_f32_16x16x32_bf16 a[108:111], a[244:247], v[140:143], a[108:111]
    ds_read_b64_tr_b16 a[210:211], v100 offset:4096
    v_fma_f32 v85, v85, v53, v61
    v_cvt_pk_bf16_f32 v150, v84, v85
    v_mfma_f32_16x16x32_bf16 a[104:107], a[244:247], v[136:139], a[104:107]
    ds_read_b64_tr_b16 a[212:213], v101 offset:0
    v_lshlrev_b32 v86, 16, v151
    v_and_b32 v87, 0xffff0000, v151
    buffer_load_dwordx4 v27, s[16:19], s38 offen offset:3072 lds
    v_mfma_f32_16x16x32_bf16 a[112:115], a[248:251], v[136:139], a[112:115]
    ds_read_b64_tr_b16 a[214:215], v101 offset:4096
    v_fma_f32 v86, v86, v54, v62
    v_fma_f32 v87, v87, v55, v63
    v_mfma_f32_16x16x32_bf16 a[116:119], a[248:251], v[140:143], a[116:119]
    ds_read_b64_tr_b16 a[216:217], v102 offset:0
    v_cvt_pk_bf16_f32 v151, v86, v87
    v_mfma_f32_16x16x32_bf16 a[124:127], a[252:255], v[140:143], a[124:127]
    ds_read_b64_tr_b16 a[218:219], v102 offset:4096
    v_mfma_f32_16x16x32_bf16 a[120:123], a[252:255], v[136:139], a[120:123]
    ds_read_b64_tr_b16 a[220:221], v103 offset:0
    ds_read_b128 v[48:51], v6 offset:2176
    s_waitcnt lgkmcnt(8)
    v_mfma_f32_16x16x32_bf16 a[0:3], a[192:195], v[144:147], a[0:3]
    ds_read_b64_tr_b16 a[222:223], v103 offset:4096
    ds_read_b128 v[52:55], v6 offset:2192
    v_mfma_f32_16x16x32_bf16 a[4:7], a[192:195], v[148:151], a[4:7]
    ds_read_b64_tr_b16 a[224:225], v96 offset:256
    ds_read_b128 v[56:59], v6 offset:384
    v_mfma_f32_16x16x32_bf16 a[12:15], a[196:199], v[148:151], a[12:15]
    ds_read_b64_tr_b16 a[226:227], v96 offset:4352
    ds_read_b128 v[60:63], v6 offset:400
    v_mfma_f32_16x16x32_bf16 a[8:11], a[196:199], v[144:147], a[8:11]
    ds_read_b64_tr_b16 a[228:229], v97 offset:256
    v_mfma_f32_16x16x32_bf16 a[16:19], a[200:203], v[144:147], a[16:19]
    ds_read_b64_tr_b16 a[230:231], v97 offset:4352
    v_mfma_f32_16x16x32_bf16 a[20:23], a[200:203], v[148:151], a[20:23]
    ds_read_b64_tr_b16 a[232:233], v98 offset:256
    v_mfma_f32_16x16x32_bf16 a[28:31], a[204:207], v[148:151], a[28:31]
    ds_read_b64_tr_b16 a[234:235], v98 offset:4352
    v_mfma_f32_16x16x32_bf16 a[24:27], a[204:207], v[144:147], a[24:27]
    ds_read_b64_tr_b16 a[236:237], v99 offset:256
    s_waitcnt lgkmcnt(5)
    v_mfma_f32_16x16x32_bf16 a[32:35], a[208:211], v[144:147], a[32:35]
    ds_read_b64_tr_b16 a[238:239], v99 offset:4352
    v_lshlrev_b32 v80, 16, v152
    v_and_b32 v81, 0xffff0000, v152
    v_mfma_f32_16x16x32_bf16 a[36:39], a[208:211], v[148:151], a[36:39]
    ds_read_b64_tr_b16 a[240:241], v100 offset:256
    v_fma_f32 v80, v80, v48, v56
    v_fma_f32 v81, v81, v49, v57
    s_waitcnt vmcnt(8)
    s_barrier
    v_mfma_f32_16x16x32_bf16 a[44:47], a[212:215], v[148:151], a[44:47]
    ds_read_b64_tr_b16 a[242:243], v100 offset:4352
    v_cvt_pk_bf16_f32 v152, v80, v81
    v_lshlrev_b32 v82, 16, v153
    v_mfma_f32_16x16x32_bf16 a[40:43], a[212:215], v[144:147], a[40:43]
    ds_read_b64_tr_b16 a[244:245], v101 offset:256
    v_and_b32 v83, 0xffff0000, v153
    v_fma_f32 v82, v82, v50, v58
    s_add_u32 m0, s44, 98304
    s_add_u32 s38, s37, 32768
    v_mfma_f32_16x16x32_bf16 a[48:51], a[216:219], v[144:147], a[48:51]
    ds_read_b64_tr_b16 a[246:247], v101 offset:4352
    v_fma_f32 v83, v83, v51, v59
    v_cvt_pk_bf16_f32 v153, v82, v83
    buffer_load_dwordx4 v24, s[16:19], s37 offen offset:0 lds
    v_mfma_f32_16x16x32_bf16 a[52:55], a[216:219], v[148:151], a[52:55]
    ds_read_b64_tr_b16 a[248:249], v102 offset:256
    v_lshlrev_b32 v84, 16, v154
    v_mfma_f32_16x16x32_bf16 a[60:63], a[220:223], v[148:151], a[60:63]
    ds_read_b64_tr_b16 a[250:251], v102 offset:4352
    v_and_b32 v85, 0xffff0000, v154
    v_fma_f32 v84, v84, v52, v60
    buffer_load_dwordx4 v25, s[16:19], s37 offen offset:1024 lds
    v_mfma_f32_16x16x32_bf16 a[56:59], a[220:223], v[144:147], a[56:59]
    ds_read_b64_tr_b16 a[252:253], v103 offset:256
    v_fma_f32 v85, v85, v53, v61
    v_cvt_pk_bf16_f32 v154, v84, v85
    s_waitcnt lgkmcnt(7)
    v_mfma_f32_16x16x32_bf16 a[64:67], a[224:227], v[144:147], a[64:67]
    ds_read_b64_tr_b16 a[254:255], v103 offset:4352
    v_lshlrev_b32 v86, 16, v155
    v_and_b32 v87, 0xffff0000, v155
    buffer_load_dwordx4 v26, s[16:19], s37 offen offset:2048 lds
    v_mfma_f32_16x16x32_bf16 a[68:71], a[224:227], v[148:151], a[68:71]
    ds_read_b64_tr_b16 a[192:193], v96 offset:32768
    v_fma_f32 v86, v86, v54, v62
    v_fma_f32 v87, v87, v55, v63
    v_mfma_f32_16x16x32_bf16 a[76:79], a[228:231], v[148:151], a[76:79]
    ds_read_b64_tr_b16 a[194:195], v96 offset:36864
    v_cvt_pk_bf16_f32 v155, v86, v87
    buffer_load_dwordx4 v27, s[16:19], s37 offen offset:3072 lds
    v_mfma_f32_16x16x32_bf16 a[72:75], a[228:231], v[144:147], a[72:75]
    ds_read_b64_tr_b16 a[196:197], v97 offset:32768
    v_lshlrev_b32 v80, 16, v156
    v_and_b32 v81, 0xffff0000, v156
    v_mfma_f32_16x16x32_bf16 a[80:83], a[232:235], v[144:147], a[80:83]
    ds_read_b64_tr_b16 a[198:199], v97 offset:36864
    v_fma_f32 v80, v80, v48, v56
    v_fma_f32 v81, v81, v49, v57
    s_add_u32 m0, s44, 102400
    s_add_u32 s37, s37, 262144
    v_mfma_f32_16x16x32_bf16 a[84:87], a[232:235], v[148:151], a[84:87]
    ds_read_b64_tr_b16 a[200:201], v98 offset:32768
    v_cvt_pk_bf16_f32 v156, v80, v81
    v_lshlrev_b32 v82, 16, v157
    buffer_load_dwordx4 v24, s[16:19], s38 offen offset:0 lds
    v_mfma_f32_16x16x32_bf16 a[92:95], a[236:239], v[148:151], a[92:95]
    ds_read_b64_tr_b16 a[202:203], v98 offset:36864
    v_and_b32 v83, 0xffff0000, v157
    v_fma_f32 v82, v82, v50, v58
    v_mfma_f32_16x16x32_bf16 a[88:91], a[236:239], v[144:147], a[88:91]
    ds_read_b64_tr_b16 a[204:205], v99 offset:32768
    v_fma_f32 v83, v83, v51, v59
    v_cvt_pk_bf16_f32 v157, v82, v83
    buffer_load_dwordx4 v25, s[16:19], s38 offen offset:1024 lds
    s_waitcnt lgkmcnt(7)
    v_mfma_f32_16x16x32_bf16 a[96:99], a[240:243], v[144:147], a[96:99]
    ds_read_b64_tr_b16 a[206:207], v99 offset:36864
    v_lshlrev_b32 v84, 16, v158
    v_mfma_f32_16x16x32_bf16 a[100:103], a[240:243], v[148:151], a[100:103]
    ds_read_b64_tr_b16 a[208:209], v100 offset:32768
    v_and_b32 v85, 0xffff0000, v158
    v_fma_f32 v84, v84, v52, v60
    buffer_load_dwordx4 v26, s[16:19], s38 offen offset:2048 lds
    v_mfma_f32_16x16x32_bf16 a[108:111], a[244:247], v[148:151], a[108:111]
    ds_read_b64_tr_b16 a[210:211], v100 offset:36864
    v_fma_f32 v85, v85, v53, v61
    v_cvt_pk_bf16_f32 v158, v84, v85
    v_mfma_f32_16x16x32_bf16 a[104:107], a[244:247], v[144:147], a[104:107]
    ds_read_b64_tr_b16 a[212:213], v101 offset:32768
    v_lshlrev_b32 v86, 16, v159
    v_and_b32 v87, 0xffff0000, v159
    buffer_load_dwordx4 v27, s[16:19], s38 offen offset:3072 lds
    v_mfma_f32_16x16x32_bf16 a[112:115], a[248:251], v[144:147], a[112:115]
    ds_read_b64_tr_b16 a[214:215], v101 offset:36864
    v_fma_f32 v86, v86, v54, v62
    v_fma_f32 v87, v87, v55, v63
    v_mfma_f32_16x16x32_bf16 a[116:119], a[248:251], v[148:151], a[116:119]
    ds_read_b64_tr_b16 a[216:217], v102 offset:32768
    v_cvt_pk_bf16_f32 v159, v86, v87
    v_mfma_f32_16x16x32_bf16 a[124:127], a[252:255], v[148:151], a[124:127]
    ds_read_b64_tr_b16 a[218:219], v102 offset:36864
    v_mfma_f32_16x16x32_bf16 a[120:123], a[252:255], v[144:147], a[120:123]
    ds_read_b64_tr_b16 a[220:221], v103 offset:32768
    ds_read_b128 v[48:51], v6 offset:2304
    s_waitcnt lgkmcnt(8)
    v_mfma_f32_16x16x32_bf16 a[0:3], a[192:195], v[152:155], a[0:3]
    ds_read_b64_tr_b16 a[222:223], v103 offset:36864
    ds_read_b128 v[52:55], v6 offset:2320
    v_mfma_f32_16x16x32_bf16 a[4:7], a[192:195], v[156:159], a[4:7]
    ds_read_b64_tr_b16 a[224:225], v96 offset:33024
    ds_read_b128 v[56:59], v6 offset:512
    v_mfma_f32_16x16x32_bf16 a[12:15], a[196:199], v[156:159], a[12:15]
    ds_read_b64_tr_b16 a[226:227], v96 offset:37120
    ds_read_b128 v[60:63], v6 offset:528
    v_mfma_f32_16x16x32_bf16 a[8:11], a[196:199], v[152:155], a[8:11]
    ds_read_b64_tr_b16 a[228:229], v97 offset:33024
    v_mfma_f32_16x16x32_bf16 a[16:19], a[200:203], v[152:155], a[16:19]
    ds_read_b64_tr_b16 a[230:231], v97 offset:37120
    v_mfma_f32_16x16x32_bf16 a[20:23], a[200:203], v[156:159], a[20:23]
    ds_read_b64_tr_b16 a[232:233], v98 offset:33024
    v_mfma_f32_16x16x32_bf16 a[28:31], a[204:207], v[156:159], a[28:31]
    ds_read_b64_tr_b16 a[234:235], v98 offset:37120
    v_mfma_f32_16x16x32_bf16 a[24:27], a[204:207], v[152:155], a[24:27]
    ds_read_b64_tr_b16 a[236:237], v99 offset:33024
    s_waitcnt lgkmcnt(5)
    v_mfma_f32_16x16x32_bf16 a[32:35], a[208:211], v[152:155], a[32:35]
    ds_read_b64_tr_b16 a[238:239], v99 offset:37120
    v_lshlrev_b32 v80, 16, v160
    v_and_b32 v81, 0xffff0000, v160
    v_mfma_f32_16x16x32_bf16 a[36:39], a[208:211], v[156:159], a[36:39]
    ds_read_b64_tr_b16 a[240:241], v100 offset:33024
    v_fma_f32 v80, v80, v48, v56
    v_fma_f32 v81, v81, v49, v57
    s_waitcnt vmcnt(8)
    s_barrier
    v_mfma_f32_16x16x32_bf16 a[44:47], a[212:215], v[156:159], a[44:47]
    ds_read_b64_tr_b16 a[242:243], v100 offset:37120
    v_cvt_pk_bf16_f32 v160, v80, v81
    v_lshlrev_b32 v82, 16, v161
    v_mfma_f32_16x16x32_bf16 a[40:43], a[212:215], v[152:155], a[40:43]
    ds_read_b64_tr_b16 a[244:245], v101 offset:33024
    v_and_b32 v83, 0xffff0000, v161
    v_fma_f32 v82, v82, v50, v58
    s_add_u32 m0, s44, 32768
    s_add_u32 s38, s37, 32768
    v_mfma_f32_16x16x32_bf16 a[48:51], a[216:219], v[152:155], a[48:51]
    ds_read_b64_tr_b16 a[246:247], v101 offset:37120
    v_fma_f32 v83, v83, v51, v59
    v_cvt_pk_bf16_f32 v161, v82, v83
    buffer_load_dwordx4 v24, s[16:19], s37 offen offset:0 lds
    v_mfma_f32_16x16x32_bf16 a[52:55], a[216:219], v[156:159], a[52:55]
    ds_read_b64_tr_b16 a[248:249], v102 offset:33024
    v_lshlrev_b32 v84, 16, v162
    v_mfma_f32_16x16x32_bf16 a[60:63], a[220:223], v[156:159], a[60:63]
    ds_read_b64_tr_b16 a[250:251], v102 offset:37120
    v_and_b32 v85, 0xffff0000, v162
    v_fma_f32 v84, v84, v52, v60
    buffer_load_dwordx4 v25, s[16:19], s37 offen offset:1024 lds
    v_mfma_f32_16x16x32_bf16 a[56:59], a[220:223], v[152:155], a[56:59]
    ds_read_b64_tr_b16 a[252:253], v103 offset:33024
    v_fma_f32 v85, v85, v53, v61
    v_cvt_pk_bf16_f32 v162, v84, v85
    s_waitcnt lgkmcnt(7)
    v_mfma_f32_16x16x32_bf16 a[64:67], a[224:227], v[152:155], a[64:67]
    ds_read_b64_tr_b16 a[254:255], v103 offset:37120
    v_lshlrev_b32 v86, 16, v163
    v_and_b32 v87, 0xffff0000, v163
    buffer_load_dwordx4 v26, s[16:19], s37 offen offset:2048 lds
    v_mfma_f32_16x16x32_bf16 a[68:71], a[224:227], v[156:159], a[68:71]
    ds_read_b64_tr_b16 a[192:193], v104 offset:32768
    v_fma_f32 v86, v86, v54, v62
    v_fma_f32 v87, v87, v55, v63
    v_mfma_f32_16x16x32_bf16 a[76:79], a[228:231], v[156:159], a[76:79]
    ds_read_b64_tr_b16 a[194:195], v104 offset:36864
    v_cvt_pk_bf16_f32 v163, v86, v87
    buffer_load_dwordx4 v27, s[16:19], s37 offen offset:3072 lds
    v_mfma_f32_16x16x32_bf16 a[72:75], a[228:231], v[152:155], a[72:75]
    ds_read_b64_tr_b16 a[196:197], v105 offset:32768
    v_lshlrev_b32 v80, 16, v164
    v_and_b32 v81, 0xffff0000, v164
    v_mfma_f32_16x16x32_bf16 a[80:83], a[232:235], v[152:155], a[80:83]
    ds_read_b64_tr_b16 a[198:199], v105 offset:36864
    v_fma_f32 v80, v80, v48, v56
    v_fma_f32 v81, v81, v49, v57
    s_add_u32 m0, s44, 36864
    s_add_u32 s37, s37, 262144
    v_mfma_f32_16x16x32_bf16 a[84:87], a[232:235], v[156:159], a[84:87]
    ds_read_b64_tr_b16 a[200:201], v106 offset:32768
    v_cvt_pk_bf16_f32 v164, v80, v81
    v_lshlrev_b32 v82, 16, v165
    buffer_load_dwordx4 v24, s[16:19], s38 offen offset:0 lds
    v_mfma_f32_16x16x32_bf16 a[92:95], a[236:239], v[156:159], a[92:95]
    ds_read_b64_tr_b16 a[202:203], v106 offset:36864
    v_and_b32 v83, 0xffff0000, v165
    v_fma_f32 v82, v82, v50, v58
    v_mfma_f32_16x16x32_bf16 a[88:91], a[236:239], v[152:155], a[88:91]
    ds_read_b64_tr_b16 a[204:205], v107 offset:32768
    v_fma_f32 v83, v83, v51, v59
    v_cvt_pk_bf16_f32 v165, v82, v83
    buffer_load_dwordx4 v25, s[16:19], s38 offen offset:1024 lds
    s_waitcnt lgkmcnt(7)
    v_mfma_f32_16x16x32_bf16 a[96:99], a[240:243], v[152:155], a[96:99]
    ds_read_b64_tr_b16 a[206:207], v107 offset:36864
    v_lshlrev_b32 v84, 16, v166
    v_mfma_f32_16x16x32_bf16 a[100:103], a[240:243], v[156:159], a[100:103]
    ds_read_b64_tr_b16 a[208:209], v108 offset:32768
    v_and_b32 v85, 0xffff0000, v166
    v_fma_f32 v84, v84, v52, v60
    buffer_load_dwordx4 v26, s[16:19], s38 offen offset:2048 lds
    v_mfma_f32_16x16x32_bf16 a[108:111], a[244:247], v[156:159], a[108:111]
    ds_read_b64_tr_b16 a[210:211], v108 offset:36864
    v_fma_f32 v85, v85, v53, v61
    v_cvt_pk_bf16_f32 v166, v84, v85
    v_mfma_f32_16x16x32_bf16 a[104:107], a[244:247], v[152:155], a[104:107]
    ds_read_b64_tr_b16 a[212:213], v109 offset:32768
    v_lshlrev_b32 v86, 16, v167
    v_and_b32 v87, 0xffff0000, v167
    buffer_load_dwordx4 v27, s[16:19], s38 offen offset:3072 lds
    v_mfma_f32_16x16x32_bf16 a[112:115], a[248:251], v[152:155], a[112:115]
    ds_read_b64_tr_b16 a[214:215], v109 offset:36864
    v_fma_f32 v86, v86, v54, v62
    v_fma_f32 v87, v87, v55, v63
    v_mfma_f32_16x16x32_bf16 a[116:119], a[248:251], v[156:159], a[116:119]
    ds_read_b64_tr_b16 a[216:217], v110 offset:32768
    v_cvt_pk_bf16_f32 v167, v86, v87
    v_mfma_f32_16x16x32_bf16 a[124:127], a[252:255], v[156:159], a[124:127]
    ds_read_b64_tr_b16 a[218:219], v110 offset:36864
    v_mfma_f32_16x16x32_bf16 a[120:123], a[252:255], v[152:155], a[120:123]
    ds_read_b64_tr_b16 a[220:221], v111 offset:32768
    ds_read_b128 v[48:51], v6 offset:2432
    s_waitcnt lgkmcnt(8)
    v_mfma_f32_16x16x32_bf16 a[0:3], a[192:195], v[160:163], a[0:3]
    ds_read_b64_tr_b16 a[222:223], v111 offset:36864
    ds_read_b128 v[52:55], v6 offset:2448
    v_mfma_f32_16x16x32_bf16 a[4:7], a[192:195], v[164:167], a[4:7]
    ds_read_b64_tr_b16 a[224:225], v104 offset:33024
    ds_read_b128 v[56:59], v6 offset:640
    v_mfma_f32_16x16x32_bf16 a[12:15], a[196:199], v[164:167], a[12:15]
    ds_read_b64_tr_b16 a[226:227], v104 offset:37120
    ds_read_b128 v[60:63], v6 offset:656
    v_mfma_f32_16x16x32_bf16 a[8:11], a[196:199], v[160:163], a[8:11]
    ds_read_b64_tr_b16 a[228:229], v105 offset:33024
    v_mfma_f32_16x16x32_bf16 a[16:19], a[200:203], v[160:163], a[16:19]
    ds_read_b64_tr_b16 a[230:231], v105 offset:37120
    v_mfma_f32_16x16x32_bf16 a[20:23], a[200:203], v[164:167], a[20:23]
    ds_read_b64_tr_b16 a[232:233], v106 offset:33024
    v_mfma_f32_16x16x32_bf16 a[28:31], a[204:207], v[164:167], a[28:31]
    ds_read_b64_tr_b16 a[234:235], v106 offset:37120
    v_mfma_f32_16x16x32_bf16 a[24:27], a[204:207], v[160:163], a[24:27]
    ds_read_b64_tr_b16 a[236:237], v107 offset:33024
    s_waitcnt lgkmcnt(5)
    v_mfma_f32_16x16x32_bf16 a[32:35], a[208:211], v[160:163], a[32:35]
    ds_read_b64_tr_b16 a[238:239], v107 offset:37120
    v_lshlrev_b32 v80, 16, v168
    v_and_b32 v81, 0xffff0000, v168
    v_mfma_f32_16x16x32_bf16 a[36:39], a[208:211], v[164:167], a[36:39]
    ds_read_b64_tr_b16 a[240:241], v108 offset:33024
    v_fma_f32 v80, v80, v48, v56
    v_fma_f32 v81, v81, v49, v57
    s_waitcnt vmcnt(8)
    s_barrier
    v_mfma_f32_16x16x32_bf16 a[44:47], a[212:215], v[164:167], a[44:47]
    ds_read_b64_tr_b16 a[242:243], v108 offset:37120
    v_cvt_pk_bf16_f32 v168, v80, v81
    v_lshlrev_b32 v82, 16, v169
    v_mfma_f32_16x16x32_bf16 a[40:43], a[212:215], v[160:163], a[40:43]
    ds_read_b64_tr_b16 a[244:245], v109 offset:33024
    v_and_b32 v83, 0xffff0000, v169
    v_fma_f32 v82, v82, v50, v58
    s_add_u32 m0, s44, 65536
    s_add_u32 s38, s37, 32768
    v_mfma_f32_16x16x32_bf16 a[48:51], a[216:219], v[160:163], a[48:51]
    ds_read_b64_tr_b16 a[246:247], v109 offset:37120
    v_fma_f32 v83, v83, v51, v59
    v_cvt_pk_bf16_f32 v169, v82, v83
    buffer_load_dwordx4 v24, s[16:19], s37 offen offset:0 lds
    v_mfma_f32_16x16x32_bf16 a[52:55], a[216:219], v[164:167], a[52:55]
    ds_read_b64_tr_b16 a[248:249], v110 offset:33024
    v_lshlrev_b32 v84, 16, v170
    v_mfma_f32_16x16x32_bf16 a[60:63], a[220:223], v[164:167], a[60:63]
    ds_read_b64_tr_b16 a[250:251], v110 offset:37120
    v_and_b32 v85, 0xffff0000, v170
    v_fma_f32 v84, v84, v52, v60
    buffer_load_dwordx4 v25, s[16:19], s37 offen offset:1024 lds
    v_mfma_f32_16x16x32_bf16 a[56:59], a[220:223], v[160:163], a[56:59]
    ds_read_b64_tr_b16 a[252:253], v111 offset:33024
    v_fma_f32 v85, v85, v53, v61
    v_cvt_pk_bf16_f32 v170, v84, v85
    s_waitcnt lgkmcnt(7)
    v_mfma_f32_16x16x32_bf16 a[64:67], a[224:227], v[160:163], a[64:67]
    ds_read_b64_tr_b16 a[254:255], v111 offset:37120
    v_lshlrev_b32 v86, 16, v171
    v_and_b32 v87, 0xffff0000, v171
    buffer_load_dwordx4 v26, s[16:19], s37 offen offset:2048 lds
    v_mfma_f32_16x16x32_bf16 a[68:71], a[224:227], v[164:167], a[68:71]
    ds_read_b64_tr_b16 a[192:193], v104 offset:0
    v_fma_f32 v86, v86, v54, v62
    v_fma_f32 v87, v87, v55, v63
    v_mfma_f32_16x16x32_bf16 a[76:79], a[228:231], v[164:167], a[76:79]
    ds_read_b64_tr_b16 a[194:195], v104 offset:4096
    v_cvt_pk_bf16_f32 v171, v86, v87
    buffer_load_dwordx4 v27, s[16:19], s37 offen offset:3072 lds
    v_mfma_f32_16x16x32_bf16 a[72:75], a[228:231], v[160:163], a[72:75]
    ds_read_b64_tr_b16 a[196:197], v105 offset:0
    v_lshlrev_b32 v80, 16, v172
    v_and_b32 v81, 0xffff0000, v172
    v_mfma_f32_16x16x32_bf16 a[80:83], a[232:235], v[160:163], a[80:83]
    ds_read_b64_tr_b16 a[198:199], v105 offset:4096
    v_fma_f32 v80, v80, v48, v56
    v_fma_f32 v81, v81, v49, v57
    s_add_u32 m0, s44, 69632
    s_add_u32 s37, s37, 262144
    v_mfma_f32_16x16x32_bf16 a[84:87], a[232:235], v[164:167], a[84:87]
    ds_read_b64_tr_b16 a[200:201], v106 offset:0
    v_cvt_pk_bf16_f32 v172, v80, v81
    v_lshlrev_b32 v82, 16, v173
    buffer_load_dwordx4 v24, s[16:19], s38 offen offset:0 lds
    v_mfma_f32_16x16x32_bf16 a[92:95], a[236:239], v[164:167], a[92:95]
    ds_read_b64_tr_b16 a[202:203], v106 offset:4096
    v_and_b32 v83, 0xffff0000, v173
    v_fma_f32 v82, v82, v50, v58
    v_mfma_f32_16x16x32_bf16 a[88:91], a[236:239], v[160:163], a[88:91]
    ds_read_b64_tr_b16 a[204:205], v107 offset:0
    v_fma_f32 v83, v83, v51, v59
    v_cvt_pk_bf16_f32 v173, v82, v83
    buffer_load_dwordx4 v25, s[16:19], s38 offen offset:1024 lds
    s_waitcnt lgkmcnt(7)
    v_mfma_f32_16x16x32_bf16 a[96:99], a[240:243], v[160:163], a[96:99]
    ds_read_b64_tr_b16 a[206:207], v107 offset:4096
    v_lshlrev_b32 v84, 16, v174
    v_mfma_f32_16x16x32_bf16 a[100:103], a[240:243], v[164:167], a[100:103]
    ds_read_b64_tr_b16 a[208:209], v108 offset:0
    v_and_b32 v85, 0xffff0000, v174
    v_fma_f32 v84, v84, v52, v60
    buffer_load_dwordx4 v26, s[16:19], s38 offen offset:2048 lds
    v_mfma_f32_16x16x32_bf16 a[108:111], a[244:247], v[164:167], a[108:111]
    ds_read_b64_tr_b16 a[210:211], v108 offset:4096
    v_fma_f32 v85, v85, v53, v61
    v_cvt_pk_bf16_f32 v174, v84, v85
    v_mfma_f32_16x16x32_bf16 a[104:107], a[244:247], v[160:163], a[104:107]
    ds_read_b64_tr_b16 a[212:213], v109 offset:0
    v_lshlrev_b32 v86, 16, v175
    v_and_b32 v87, 0xffff0000, v175
    buffer_load_dwordx4 v27, s[16:19], s38 offen offset:3072 lds
    v_mfma_f32_16x16x32_bf16 a[112:115], a[248:251], v[160:163], a[112:115]
    ds_read_b64_tr_b16 a[214:215], v109 offset:4096
    v_fma_f32 v86, v86, v54, v62
    v_fma_f32 v87, v87, v55, v63
    v_mfma_f32_16x16x32_bf16 a[116:119], a[248:251], v[164:167], a[116:119]
    ds_read_b64_tr_b16 a[216:217], v110 offset:0
    v_cvt_pk_bf16_f32 v175, v86, v87
    v_mfma_f32_16x16x32_bf16 a[124:127], a[252:255], v[164:167], a[124:127]
    ds_read_b64_tr_b16 a[218:219], v110 offset:4096
    v_mfma_f32_16x16x32_bf16 a[120:123], a[252:255], v[160:163], a[120:123]
    ds_read_b64_tr_b16 a[220:221], v111 offset:0
    ds_read_b128 v[48:51], v6 offset:2560
    s_waitcnt lgkmcnt(8)
    v_mfma_f32_16x16x32_bf16 a[0:3], a[192:195], v[168:171], a[0:3]
    ds_read_b64_tr_b16 a[222:223], v111 offset:4096
    ds_read_b128 v[52:55], v6 offset:2576
    v_mfma_f32_16x16x32_bf16 a[4:7], a[192:195], v[172:175], a[4:7]
    ds_read_b64_tr_b16 a[224:225], v104 offset:256
    ds_read_b128 v[56:59], v6 offset:768
    v_mfma_f32_16x16x32_bf16 a[12:15], a[196:199], v[172:175], a[12:15]
    ds_read_b64_tr_b16 a[226:227], v104 offset:4352
    ds_read_b128 v[60:63], v6 offset:784
    v_mfma_f32_16x16x32_bf16 a[8:11], a[196:199], v[168:171], a[8:11]
    ds_read_b64_tr_b16 a[228:229], v105 offset:256
    v_mfma_f32_16x16x32_bf16 a[16:19], a[200:203], v[168:171], a[16:19]
    ds_read_b64_tr_b16 a[230:231], v105 offset:4352
    v_mfma_f32_16x16x32_bf16 a[20:23], a[200:203], v[172:175], a[20:23]
    ds_read_b64_tr_b16 a[232:233], v106 offset:256
    v_mfma_f32_16x16x32_bf16 a[28:31], a[204:207], v[172:175], a[28:31]
    ds_read_b64_tr_b16 a[234:235], v106 offset:4352
    v_mfma_f32_16x16x32_bf16 a[24:27], a[204:207], v[168:171], a[24:27]
    ds_read_b64_tr_b16 a[236:237], v107 offset:256
    s_waitcnt lgkmcnt(5)
    v_mfma_f32_16x16x32_bf16 a[32:35], a[208:211], v[168:171], a[32:35]
    ds_read_b64_tr_b16 a[238:239], v107 offset:4352
    v_lshlrev_b32 v80, 16, v176
    v_and_b32 v81, 0xffff0000, v176
    v_mfma_f32_16x16x32_bf16 a[36:39], a[208:211], v[172:175], a[36:39]
    ds_read_b64_tr_b16 a[240:241], v108 offset:256
    v_fma_f32 v80, v80, v48, v56
    v_fma_f32 v81, v81, v49, v57
    s_waitcnt vmcnt(8)
    s_barrier
    v_mfma_f32_16x16x32_bf16 a[44:47], a[212:215], v[172:175], a[44:47]
    ds_read_b64_tr_b16 a[242:243], v108 offset:4352
    v_cvt_pk_bf16_f32 v176, v80, v81
    v_lshlrev_b32 v82, 16, v177
    v_mfma_f32_16x16x32_bf16 a[40:43], a[212:215], v[168:171], a[40:43]
    ds_read_b64_tr_b16 a[244:245], v109 offset:256
    v_and_b32 v83, 0xffff0000, v177
    v_fma_f32 v82, v82, v50, v58
    s_add_u32 m0, s44, 131072
    s_add_u32 s38, s37, 32768
    v_mfma_f32_16x16x32_bf16 a[48:51], a[216:219], v[168:171], a[48:51]
    ds_read_b64_tr_b16 a[246:247], v109 offset:4352
    v_fma_f32 v83, v83, v51, v59
    v_cvt_pk_bf16_f32 v177, v82, v83
    buffer_load_dwordx4 v24, s[16:19], s37 offen offset:0 lds
    v_mfma_f32_16x16x32_bf16 a[52:55], a[216:219], v[172:175], a[52:55]
    ds_read_b64_tr_b16 a[248:249], v110 offset:256
    v_lshlrev_b32 v84, 16, v178
    v_mfma_f32_16x16x32_bf16 a[60:63], a[220:223], v[172:175], a[60:63]
    ds_read_b64_tr_b16 a[250:251], v110 offset:4352
    v_and_b32 v85, 0xffff0000, v178
    v_fma_f32 v84, v84, v52, v60
    buffer_load_dwordx4 v25, s[16:19], s37 offen offset:1024 lds
    v_mfma_f32_16x16x32_bf16 a[56:59], a[220:223], v[168:171], a[56:59]
    ds_read_b64_tr_b16 a[252:253], v111 offset:256
    v_fma_f32 v85, v85, v53, v61
    v_cvt_pk_bf16_f32 v178, v84, v85
    s_waitcnt lgkmcnt(7)
    v_mfma_f32_16x16x32_bf16 a[64:67], a[224:227], v[168:171], a[64:67]
    ds_read_b64_tr_b16 a[254:255], v111 offset:4352
    v_lshlrev_b32 v86, 16, v179
    v_and_b32 v87, 0xffff0000, v179
    buffer_load_dwordx4 v26, s[16:19], s37 offen offset:2048 lds
    v_mfma_f32_16x16x32_bf16 a[68:71], a[224:227], v[172:175], a[68:71]
    ds_read_b64_tr_b16 a[192:193], v96 offset:0
    v_fma_f32 v86, v86, v54, v62
    v_fma_f32 v87, v87, v55, v63
    v_mfma_f32_16x16x32_bf16 a[76:79], a[228:231], v[172:175], a[76:79]
    ds_read_b64_tr_b16 a[194:195], v96 offset:4096
    v_cvt_pk_bf16_f32 v179, v86, v87
    buffer_load_dwordx4 v27, s[16:19], s37 offen offset:3072 lds
    v_mfma_f32_16x16x32_bf16 a[72:75], a[228:231], v[168:171], a[72:75]
    ds_read_b64_tr_b16 a[196:197], v97 offset:0
    v_lshlrev_b32 v80, 16, v180
    v_and_b32 v81, 0xffff0000, v180
    v_mfma_f32_16x16x32_bf16 a[80:83], a[232:235], v[168:171], a[80:83]
    ds_read_b64_tr_b16 a[198:199], v97 offset:4096
    v_fma_f32 v80, v80, v48, v56
    v_fma_f32 v81, v81, v49, v57
    s_add_u32 m0, s44, 135168
    s_add_u32 s37, s37, 262144
    v_mfma_f32_16x16x32_bf16 a[84:87], a[232:235], v[172:175], a[84:87]
    ds_read_b64_tr_b16 a[200:201], v98 offset:0
    v_cvt_pk_bf16_f32 v180, v80, v81
    v_lshlrev_b32 v82, 16, v181
    buffer_load_dwordx4 v24, s[16:19], s38 offen offset:0 lds
    v_mfma_f32_16x16x32_bf16 a[92:95], a[236:239], v[172:175], a[92:95]
    ds_read_b64_tr_b16 a[202:203], v98 offset:4096
    v_and_b32 v83, 0xffff0000, v181
    v_fma_f32 v82, v82, v50, v58
    v_mfma_f32_16x16x32_bf16 a[88:91], a[236:239], v[168:171], a[88:91]
    ds_read_b64_tr_b16 a[204:205], v99 offset:0
    v_fma_f32 v83, v83, v51, v59
    v_cvt_pk_bf16_f32 v181, v82, v83
    buffer_load_dwordx4 v25, s[16:19], s38 offen offset:1024 lds
    s_waitcnt lgkmcnt(7)
    v_mfma_f32_16x16x32_bf16 a[96:99], a[240:243], v[168:171], a[96:99]
    ds_read_b64_tr_b16 a[206:207], v99 offset:4096
    v_lshlrev_b32 v84, 16, v182
    v_mfma_f32_16x16x32_bf16 a[100:103], a[240:243], v[172:175], a[100:103]
    ds_read_b64_tr_b16 a[208:209], v100 offset:0
    v_and_b32 v85, 0xffff0000, v182
    v_fma_f32 v84, v84, v52, v60
    buffer_load_dwordx4 v26, s[16:19], s38 offen offset:2048 lds
    v_mfma_f32_16x16x32_bf16 a[108:111], a[244:247], v[172:175], a[108:111]
    ds_read_b64_tr_b16 a[210:211], v100 offset:4096
    v_fma_f32 v85, v85, v53, v61
    v_cvt_pk_bf16_f32 v182, v84, v85
    v_mfma_f32_16x16x32_bf16 a[104:107], a[244:247], v[168:171], a[104:107]
    ds_read_b64_tr_b16 a[212:213], v101 offset:0
    v_lshlrev_b32 v86, 16, v183
    v_and_b32 v87, 0xffff0000, v183
    buffer_load_dwordx4 v27, s[16:19], s38 offen offset:3072 lds
    v_mfma_f32_16x16x32_bf16 a[112:115], a[248:251], v[168:171], a[112:115]
    ds_read_b64_tr_b16 a[214:215], v101 offset:4096
    v_fma_f32 v86, v86, v54, v62
    v_fma_f32 v87, v87, v55, v63
    v_mfma_f32_16x16x32_bf16 a[116:119], a[248:251], v[172:175], a[116:119]
    ds_read_b64_tr_b16 a[216:217], v102 offset:0
    v_cvt_pk_bf16_f32 v183, v86, v87
    v_mfma_f32_16x16x32_bf16 a[124:127], a[252:255], v[172:175], a[124:127]
    ds_read_b64_tr_b16 a[218:219], v102 offset:4096
    v_mfma_f32_16x16x32_bf16 a[120:123], a[252:255], v[168:171], a[120:123]
    ds_read_b64_tr_b16 a[220:221], v103 offset:0
    ds_read_b128 v[48:51], v6 offset:2688
    s_waitcnt lgkmcnt(8)
    v_mfma_f32_16x16x32_bf16 a[0:3], a[192:195], v[176:179], a[0:3]
    ds_read_b64_tr_b16 a[222:223], v103 offset:4096
    ds_read_b128 v[52:55], v6 offset:2704
    v_mfma_f32_16x16x32_bf16 a[4:7], a[192:195], v[180:183], a[4:7]
    ds_read_b64_tr_b16 a[224:225], v96 offset:256
    ds_read_b128 v[56:59], v6 offset:896
    v_mfma_f32_16x16x32_bf16 a[12:15], a[196:199], v[180:183], a[12:15]
    ds_read_b64_tr_b16 a[226:227], v96 offset:4352
    ds_read_b128 v[60:63], v6 offset:912
    v_mfma_f32_16x16x32_bf16 a[8:11], a[196:199], v[176:179], a[8:11]
    ds_read_b64_tr_b16 a[228:229], v97 offset:256
    v_mfma_f32_16x16x32_bf16 a[16:19], a[200:203], v[176:179], a[16:19]
    ds_read_b64_tr_b16 a[230:231], v97 offset:4352
    v_mfma_f32_16x16x32_bf16 a[20:23], a[200:203], v[180:183], a[20:23]
    ds_read_b64_tr_b16 a[232:233], v98 offset:256
    v_mfma_f32_16x16x32_bf16 a[28:31], a[204:207], v[180:183], a[28:31]
    ds_read_b64_tr_b16 a[234:235], v98 offset:4352
    v_mfma_f32_16x16x32_bf16 a[24:27], a[204:207], v[176:179], a[24:27]
    ds_read_b64_tr_b16 a[236:237], v99 offset:256
    s_waitcnt lgkmcnt(5)
    v_mfma_f32_16x16x32_bf16 a[32:35], a[208:211], v[176:179], a[32:35]
    ds_read_b64_tr_b16 a[238:239], v99 offset:4352
    v_lshlrev_b32 v80, 16, v184
    v_and_b32 v81, 0xffff0000, v184
    v_mfma_f32_16x16x32_bf16 a[36:39], a[208:211], v[180:183], a[36:39]
    ds_read_b64_tr_b16 a[240:241], v100 offset:256
    v_fma_f32 v80, v80, v48, v56
    v_fma_f32 v81, v81, v49, v57
    s_waitcnt vmcnt(8)
    s_barrier
    v_mfma_f32_16x16x32_bf16 a[44:47], a[212:215], v[180:183], a[44:47]
    ds_read_b64_tr_b16 a[242:243], v100 offset:4352
    v_cvt_pk_bf16_f32 v184, v80, v81
    v_lshlrev_b32 v82, 16, v185
    v_mfma_f32_16x16x32_bf16 a[40:43], a[212:215], v[176:179], a[40:43]
    ds_read_b64_tr_b16 a[244:245], v101 offset:256
    v_and_b32 v83, 0xffff0000, v185
    v_fma_f32 v82, v82, v50, v58
    s_add_u32 m0, s44, 98304
    s_add_u32 s38, s37, 32768
    v_mfma_f32_16x16x32_bf16 a[48:51], a[216:219], v[176:179], a[48:51]
    ds_read_b64_tr_b16 a[246:247], v101 offset:4352
    v_fma_f32 v83, v83, v51, v59
    v_cvt_pk_bf16_f32 v185, v82, v83
    buffer_load_dwordx4 v24, s[16:19], s37 offen offset:0 lds
    v_mfma_f32_16x16x32_bf16 a[52:55], a[216:219], v[180:183], a[52:55]
    ds_read_b64_tr_b16 a[248:249], v102 offset:256
    v_lshlrev_b32 v84, 16, v186
    v_mfma_f32_16x16x32_bf16 a[60:63], a[220:223], v[180:183], a[60:63]
    ds_read_b64_tr_b16 a[250:251], v102 offset:4352
    v_and_b32 v85, 0xffff0000, v186
    v_fma_f32 v84, v84, v52, v60
    buffer_load_dwordx4 v25, s[16:19], s37 offen offset:1024 lds
    v_mfma_f32_16x16x32_bf16 a[56:59], a[220:223], v[176:179], a[56:59]
    ds_read_b64_tr_b16 a[252:253], v103 offset:256
    v_fma_f32 v85, v85, v53, v61
    v_cvt_pk_bf16_f32 v186, v84, v85
    s_waitcnt lgkmcnt(7)
    v_mfma_f32_16x16x32_bf16 a[64:67], a[224:227], v[176:179], a[64:67]
    ds_read_b64_tr_b16 a[254:255], v103 offset:4352
    v_lshlrev_b32 v86, 16, v187
    v_and_b32 v87, 0xffff0000, v187
    buffer_load_dwordx4 v26, s[16:19], s37 offen offset:2048 lds
    v_mfma_f32_16x16x32_bf16 a[68:71], a[224:227], v[180:183], a[68:71]
    ds_read_b64_tr_b16 a[192:193], v96 offset:32768
    v_fma_f32 v86, v86, v54, v62
    v_fma_f32 v87, v87, v55, v63
    v_mfma_f32_16x16x32_bf16 a[76:79], a[228:231], v[180:183], a[76:79]
    ds_read_b64_tr_b16 a[194:195], v96 offset:36864
    v_cvt_pk_bf16_f32 v187, v86, v87
    buffer_load_dwordx4 v27, s[16:19], s37 offen offset:3072 lds
    v_mfma_f32_16x16x32_bf16 a[72:75], a[228:231], v[176:179], a[72:75]
    ds_read_b64_tr_b16 a[196:197], v97 offset:32768
    v_lshlrev_b32 v80, 16, v188
    v_and_b32 v81, 0xffff0000, v188
    v_mfma_f32_16x16x32_bf16 a[80:83], a[232:235], v[176:179], a[80:83]
    ds_read_b64_tr_b16 a[198:199], v97 offset:36864
    v_fma_f32 v80, v80, v48, v56
    v_fma_f32 v81, v81, v49, v57
    s_add_u32 m0, s44, 102400
    s_add_u32 s37, s37, 262144
    v_mfma_f32_16x16x32_bf16 a[84:87], a[232:235], v[180:183], a[84:87]
    ds_read_b64_tr_b16 a[200:201], v98 offset:32768
    v_cvt_pk_bf16_f32 v188, v80, v81
    v_lshlrev_b32 v82, 16, v189
    buffer_load_dwordx4 v24, s[16:19], s38 offen offset:0 lds
    v_mfma_f32_16x16x32_bf16 a[92:95], a[236:239], v[180:183], a[92:95]
    ds_read_b64_tr_b16 a[202:203], v98 offset:36864
    v_and_b32 v83, 0xffff0000, v189
    v_fma_f32 v82, v82, v50, v58
    v_mfma_f32_16x16x32_bf16 a[88:91], a[236:239], v[176:179], a[88:91]
    ds_read_b64_tr_b16 a[204:205], v99 offset:32768
    v_fma_f32 v83, v83, v51, v59
    v_cvt_pk_bf16_f32 v189, v82, v83
    buffer_load_dwordx4 v25, s[16:19], s38 offen offset:1024 lds
    s_waitcnt lgkmcnt(7)
    v_mfma_f32_16x16x32_bf16 a[96:99], a[240:243], v[176:179], a[96:99]
    ds_read_b64_tr_b16 a[206:207], v99 offset:36864
    v_lshlrev_b32 v84, 16, v190
    v_mfma_f32_16x16x32_bf16 a[100:103], a[240:243], v[180:183], a[100:103]
    ds_read_b64_tr_b16 a[208:209], v100 offset:32768
    v_and_b32 v85, 0xffff0000, v190
    v_fma_f32 v84, v84, v52, v60
    buffer_load_dwordx4 v26, s[16:19], s38 offen offset:2048 lds
    v_mfma_f32_16x16x32_bf16 a[108:111], a[244:247], v[180:183], a[108:111]
    ds_read_b64_tr_b16 a[210:211], v100 offset:36864
    v_fma_f32 v85, v85, v53, v61
    v_cvt_pk_bf16_f32 v190, v84, v85
    v_mfma_f32_16x16x32_bf16 a[104:107], a[244:247], v[176:179], a[104:107]
    ds_read_b64_tr_b16 a[212:213], v101 offset:32768
    v_lshlrev_b32 v86, 16, v191
    v_and_b32 v87, 0xffff0000, v191
    buffer_load_dwordx4 v27, s[16:19], s38 offen offset:3072 lds
    v_mfma_f32_16x16x32_bf16 a[112:115], a[248:251], v[176:179], a[112:115]
    ds_read_b64_tr_b16 a[214:215], v101 offset:36864
    v_fma_f32 v86, v86, v54, v62
    v_fma_f32 v87, v87, v55, v63
    v_mfma_f32_16x16x32_bf16 a[116:119], a[248:251], v[180:183], a[116:119]
    ds_read_b64_tr_b16 a[216:217], v102 offset:32768
    v_cvt_pk_bf16_f32 v191, v86, v87
    v_mfma_f32_16x16x32_bf16 a[124:127], a[252:255], v[180:183], a[124:127]
    ds_read_b64_tr_b16 a[218:219], v102 offset:36864
    v_mfma_f32_16x16x32_bf16 a[120:123], a[252:255], v[176:179], a[120:123]
    ds_read_b64_tr_b16 a[220:221], v103 offset:32768
    ds_read_b128 v[48:51], v6 offset:2816
    s_waitcnt lgkmcnt(8)
    v_mfma_f32_16x16x32_bf16 a[0:3], a[192:195], v[184:187], a[0:3]
    ds_read_b64_tr_b16 a[222:223], v103 offset:36864
    ds_read_b128 v[52:55], v6 offset:2832
    v_mfma_f32_16x16x32_bf16 a[4:7], a[192:195], v[188:191], a[4:7]
    ds_read_b64_tr_b16 a[224:225], v96 offset:33024
    ds_read_b128 v[56:59], v6 offset:1024
    v_mfma_f32_16x16x32_bf16 a[12:15], a[196:199], v[188:191], a[12:15]
    ds_read_b64_tr_b16 a[226:227], v96 offset:37120
    ds_read_b128 v[60:63], v6 offset:1040
    v_mfma_f32_16x16x32_bf16 a[8:11], a[196:199], v[184:187], a[8:11]
    ds_read_b64_tr_b16 a[228:229], v97 offset:33024
    v_mfma_f32_16x16x32_bf16 a[16:19], a[200:203], v[184:187], a[16:19]
    ds_read_b64_tr_b16 a[230:231], v97 offset:37120
    v_mfma_f32_16x16x32_bf16 a[20:23], a[200:203], v[188:191], a[20:23]
    ds_read_b64_tr_b16 a[232:233], v98 offset:33024
    v_mfma_f32_16x16x32_bf16 a[28:31], a[204:207], v[188:191], a[28:31]
    ds_read_b64_tr_b16 a[234:235], v98 offset:37120
    v_mfma_f32_16x16x32_bf16 a[24:27], a[204:207], v[184:187], a[24:27]
    ds_read_b64_tr_b16 a[236:237], v99 offset:33024
    s_waitcnt lgkmcnt(5)
    v_mfma_f32_16x16x32_bf16 a[32:35], a[208:211], v[184:187], a[32:35]
    ds_read_b64_tr_b16 a[238:239], v99 offset:37120
    v_lshlrev_b32 v80, 16, v192
    v_and_b32 v81, 0xffff0000, v192
    v_mfma_f32_16x16x32_bf16 a[36:39], a[208:211], v[188:191], a[36:39]
    ds_read_b64_tr_b16 a[240:241], v100 offset:33024
    v_fma_f32 v80, v80, v48, v56
    v_fma_f32 v81, v81, v49, v57
    s_waitcnt vmcnt(8)
    s_barrier
    v_mfma_f32_16x16x32_bf16 a[44:47], a[212:215], v[188:191], a[44:47]
    ds_read_b64_tr_b16 a[242:243], v100 offset:37120
    v_cvt_pk_bf16_f32 v192, v80, v81
    v_lshlrev_b32 v82, 16, v193
    v_mfma_f32_16x16x32_bf16 a[40:43], a[212:215], v[184:187], a[40:43]
    ds_read_b64_tr_b16 a[244:245], v101 offset:33024
    v_and_b32 v83, 0xffff0000, v193
    v_fma_f32 v82, v82, v50, v58
    s_add_u32 m0, s44, 32768
    s_add_u32 s38, s37, 32768
    v_mfma_f32_16x16x32_bf16 a[48:51], a[216:219], v[184:187], a[48:51]
    ds_read_b64_tr_b16 a[246:247], v101 offset:37120
    v_fma_f32 v83, v83, v51, v59
    v_cvt_pk_bf16_f32 v193, v82, v83
    buffer_load_dwordx4 v24, s[16:19], s37 offen offset:0 lds
    v_mfma_f32_16x16x32_bf16 a[52:55], a[216:219], v[188:191], a[52:55]
    ds_read_b64_tr_b16 a[248:249], v102 offset:33024
    v_lshlrev_b32 v84, 16, v194
    v_mfma_f32_16x16x32_bf16 a[60:63], a[220:223], v[188:191], a[60:63]
    ds_read_b64_tr_b16 a[250:251], v102 offset:37120
    v_and_b32 v85, 0xffff0000, v194
    v_fma_f32 v84, v84, v52, v60
    buffer_load_dwordx4 v25, s[16:19], s37 offen offset:1024 lds
    v_mfma_f32_16x16x32_bf16 a[56:59], a[220:223], v[184:187], a[56:59]
    ds_read_b64_tr_b16 a[252:253], v103 offset:33024
    v_fma_f32 v85, v85, v53, v61
    v_cvt_pk_bf16_f32 v194, v84, v85
    s_waitcnt lgkmcnt(7)
    v_mfma_f32_16x16x32_bf16 a[64:67], a[224:227], v[184:187], a[64:67]
    ds_read_b64_tr_b16 a[254:255], v103 offset:37120
    v_lshlrev_b32 v86, 16, v195
    v_and_b32 v87, 0xffff0000, v195
    buffer_load_dwordx4 v26, s[16:19], s37 offen offset:2048 lds
    v_mfma_f32_16x16x32_bf16 a[68:71], a[224:227], v[188:191], a[68:71]
    ds_read_b64_tr_b16 a[192:193], v104 offset:32768
    v_fma_f32 v86, v86, v54, v62
    v_fma_f32 v87, v87, v55, v63
    v_mfma_f32_16x16x32_bf16 a[76:79], a[228:231], v[188:191], a[76:79]
    ds_read_b64_tr_b16 a[194:195], v104 offset:36864
    v_cvt_pk_bf16_f32 v195, v86, v87
    buffer_load_dwordx4 v27, s[16:19], s37 offen offset:3072 lds
    v_mfma_f32_16x16x32_bf16 a[72:75], a[228:231], v[184:187], a[72:75]
    ds_read_b64_tr_b16 a[196:197], v105 offset:32768
    v_lshlrev_b32 v80, 16, v196
    v_and_b32 v81, 0xffff0000, v196
    v_mfma_f32_16x16x32_bf16 a[80:83], a[232:235], v[184:187], a[80:83]
    ds_read_b64_tr_b16 a[198:199], v105 offset:36864
    v_fma_f32 v80, v80, v48, v56
    v_fma_f32 v81, v81, v49, v57
    s_add_u32 m0, s44, 36864
    s_add_u32 s37, s37, 262144
    v_mfma_f32_16x16x32_bf16 a[84:87], a[232:235], v[188:191], a[84:87]
    ds_read_b64_tr_b16 a[200:201], v106 offset:32768
    v_cvt_pk_bf16_f32 v196, v80, v81
    v_lshlrev_b32 v82, 16, v197
    buffer_load_dwordx4 v24, s[16:19], s38 offen offset:0 lds
    v_mfma_f32_16x16x32_bf16 a[92:95], a[236:239], v[188:191], a[92:95]
    ds_read_b64_tr_b16 a[202:203], v106 offset:36864
    v_and_b32 v83, 0xffff0000, v197
    v_fma_f32 v82, v82, v50, v58
    v_mfma_f32_16x16x32_bf16 a[88:91], a[236:239], v[184:187], a[88:91]
    ds_read_b64_tr_b16 a[204:205], v107 offset:32768
    v_fma_f32 v83, v83, v51, v59
    v_cvt_pk_bf16_f32 v197, v82, v83
    buffer_load_dwordx4 v25, s[16:19], s38 offen offset:1024 lds
    s_waitcnt lgkmcnt(7)
    v_mfma_f32_16x16x32_bf16 a[96:99], a[240:243], v[184:187], a[96:99]
    ds_read_b64_tr_b16 a[206:207], v107 offset:36864
    v_lshlrev_b32 v84, 16, v198
    v_mfma_f32_16x16x32_bf16 a[100:103], a[240:243], v[188:191], a[100:103]
    ds_read_b64_tr_b16 a[208:209], v108 offset:32768
    v_and_b32 v85, 0xffff0000, v198
    v_fma_f32 v84, v84, v52, v60
    buffer_load_dwordx4 v26, s[16:19], s38 offen offset:2048 lds
    v_mfma_f32_16x16x32_bf16 a[108:111], a[244:247], v[188:191], a[108:111]
    ds_read_b64_tr_b16 a[210:211], v108 offset:36864
    v_fma_f32 v85, v85, v53, v61
    v_cvt_pk_bf16_f32 v198, v84, v85
    v_mfma_f32_16x16x32_bf16 a[104:107], a[244:247], v[184:187], a[104:107]
    ds_read_b64_tr_b16 a[212:213], v109 offset:32768
    v_lshlrev_b32 v86, 16, v199
    v_and_b32 v87, 0xffff0000, v199
    buffer_load_dwordx4 v27, s[16:19], s38 offen offset:3072 lds
    v_mfma_f32_16x16x32_bf16 a[112:115], a[248:251], v[184:187], a[112:115]
    ds_read_b64_tr_b16 a[214:215], v109 offset:36864
    v_fma_f32 v86, v86, v54, v62
    v_fma_f32 v87, v87, v55, v63
    v_mfma_f32_16x16x32_bf16 a[116:119], a[248:251], v[188:191], a[116:119]
    ds_read_b64_tr_b16 a[216:217], v110 offset:32768
    v_cvt_pk_bf16_f32 v199, v86, v87
    v_mfma_f32_16x16x32_bf16 a[124:127], a[252:255], v[188:191], a[124:127]
    ds_read_b64_tr_b16 a[218:219], v110 offset:36864
    v_mfma_f32_16x16x32_bf16 a[120:123], a[252:255], v[184:187], a[120:123]
    ds_read_b64_tr_b16 a[220:221], v111 offset:32768
    ds_read_b128 v[48:51], v6 offset:2944
    s_waitcnt lgkmcnt(8)
    v_mfma_f32_16x16x32_bf16 a[0:3], a[192:195], v[192:195], a[0:3]
    ds_read_b64_tr_b16 a[222:223], v111 offset:36864
    ds_read_b128 v[52:55], v6 offset:2960
    v_mfma_f32_16x16x32_bf16 a[4:7], a[192:195], v[196:199], a[4:7]
    ds_read_b64_tr_b16 a[224:225], v104 offset:33024
    ds_read_b128 v[56:59], v6 offset:1152
    v_mfma_f32_16x16x32_bf16 a[12:15], a[196:199], v[196:199], a[12:15]
    ds_read_b64_tr_b16 a[226:227], v104 offset:37120
    ds_read_b128 v[60:63], v6 offset:1168
    v_mfma_f32_16x16x32_bf16 a[8:11], a[196:199], v[192:195], a[8:11]
    ds_read_b64_tr_b16 a[228:229], v105 offset:33024
    v_mfma_f32_16x16x32_bf16 a[16:19], a[200:203], v[192:195], a[16:19]
    ds_read_b64_tr_b16 a[230:231], v105 offset:37120
    v_mfma_f32_16x16x32_bf16 a[20:23], a[200:203], v[196:199], a[20:23]
    ds_read_b64_tr_b16 a[232:233], v106 offset:33024
    v_mfma_f32_16x16x32_bf16 a[28:31], a[204:207], v[196:199], a[28:31]
    ds_read_b64_tr_b16 a[234:235], v106 offset:37120
    v_mfma_f32_16x16x32_bf16 a[24:27], a[204:207], v[192:195], a[24:27]
    ds_read_b64_tr_b16 a[236:237], v107 offset:33024
    s_waitcnt lgkmcnt(5)
    v_mfma_f32_16x16x32_bf16 a[32:35], a[208:211], v[192:195], a[32:35]
    ds_read_b64_tr_b16 a[238:239], v107 offset:37120
    v_lshlrev_b32 v80, 16, v200
    v_and_b32 v81, 0xffff0000, v200
    v_mfma_f32_16x16x32_bf16 a[36:39], a[208:211], v[196:199], a[36:39]
    ds_read_b64_tr_b16 a[240:241], v108 offset:33024
    v_fma_f32 v80, v80, v48, v56
    v_fma_f32 v81, v81, v49, v57
    s_waitcnt vmcnt(8)
    s_barrier
    v_mfma_f32_16x16x32_bf16 a[44:47], a[212:215], v[196:199], a[44:47]
    ds_read_b64_tr_b16 a[242:243], v108 offset:37120
    v_cvt_pk_bf16_f32 v200, v80, v81
    v_lshlrev_b32 v82, 16, v201
    v_mfma_f32_16x16x32_bf16 a[40:43], a[212:215], v[192:195], a[40:43]
    ds_read_b64_tr_b16 a[244:245], v109 offset:33024
    v_and_b32 v83, 0xffff0000, v201
    v_fma_f32 v82, v82, v50, v58
    s_add_u32 m0, s44, 65536
    s_add_u32 s38, s37, 32768
    v_mfma_f32_16x16x32_bf16 a[48:51], a[216:219], v[192:195], a[48:51]
    ds_read_b64_tr_b16 a[246:247], v109 offset:37120
    v_fma_f32 v83, v83, v51, v59
    v_cvt_pk_bf16_f32 v201, v82, v83
    buffer_load_dwordx4 v24, s[16:19], s37 offen offset:0 lds
    v_mfma_f32_16x16x32_bf16 a[52:55], a[216:219], v[196:199], a[52:55]
    ds_read_b64_tr_b16 a[248:249], v110 offset:33024
    v_lshlrev_b32 v84, 16, v202
    v_mfma_f32_16x16x32_bf16 a[60:63], a[220:223], v[196:199], a[60:63]
    ds_read_b64_tr_b16 a[250:251], v110 offset:37120
    v_and_b32 v85, 0xffff0000, v202
    v_fma_f32 v84, v84, v52, v60
    buffer_load_dwordx4 v25, s[16:19], s37 offen offset:1024 lds
    v_mfma_f32_16x16x32_bf16 a[56:59], a[220:223], v[192:195], a[56:59]
    ds_read_b64_tr_b16 a[252:253], v111 offset:33024
    v_fma_f32 v85, v85, v53, v61
    v_cvt_pk_bf16_f32 v202, v84, v85
    s_waitcnt lgkmcnt(7)
    v_mfma_f32_16x16x32_bf16 a[64:67], a[224:227], v[192:195], a[64:67]
    ds_read_b64_tr_b16 a[254:255], v111 offset:37120
    v_lshlrev_b32 v86, 16, v203
    v_and_b32 v87, 0xffff0000, v203
    buffer_load_dwordx4 v26, s[16:19], s37 offen offset:2048 lds
    v_mfma_f32_16x16x32_bf16 a[68:71], a[224:227], v[196:199], a[68:71]
    ds_read_b64_tr_b16 a[192:193], v104 offset:0
    v_fma_f32 v86, v86, v54, v62
    v_fma_f32 v87, v87, v55, v63
    v_mfma_f32_16x16x32_bf16 a[76:79], a[228:231], v[196:199], a[76:79]
    ds_read_b64_tr_b16 a[194:195], v104 offset:4096
    v_cvt_pk_bf16_f32 v203, v86, v87
    buffer_load_dwordx4 v27, s[16:19], s37 offen offset:3072 lds
    v_mfma_f32_16x16x32_bf16 a[72:75], a[228:231], v[192:195], a[72:75]
    ds_read_b64_tr_b16 a[196:197], v105 offset:0
    v_lshlrev_b32 v80, 16, v204
    v_and_b32 v81, 0xffff0000, v204
    v_mfma_f32_16x16x32_bf16 a[80:83], a[232:235], v[192:195], a[80:83]
    ds_read_b64_tr_b16 a[198:199], v105 offset:4096
    v_fma_f32 v80, v80, v48, v56
    v_fma_f32 v81, v81, v49, v57
    s_add_u32 m0, s44, 69632
    s_add_u32 s37, s37, 262144
    v_mfma_f32_16x16x32_bf16 a[84:87], a[232:235], v[196:199], a[84:87]
    ds_read_b64_tr_b16 a[200:201], v106 offset:0
    v_cvt_pk_bf16_f32 v204, v80, v81
    v_lshlrev_b32 v82, 16, v205
    buffer_load_dwordx4 v24, s[16:19], s38 offen offset:0 lds
    v_mfma_f32_16x16x32_bf16 a[92:95], a[236:239], v[196:199], a[92:95]
    ds_read_b64_tr_b16 a[202:203], v106 offset:4096
    v_and_b32 v83, 0xffff0000, v205
    v_fma_f32 v82, v82, v50, v58
    v_mfma_f32_16x16x32_bf16 a[88:91], a[236:239], v[192:195], a[88:91]
    ds_read_b64_tr_b16 a[204:205], v107 offset:0
    v_fma_f32 v83, v83, v51, v59
    v_cvt_pk_bf16_f32 v205, v82, v83
    buffer_load_dwordx4 v25, s[16:19], s38 offen offset:1024 lds
    s_waitcnt lgkmcnt(7)
    v_mfma_f32_16x16x32_bf16 a[96:99], a[240:243], v[192:195], a[96:99]
    ds_read_b64_tr_b16 a[206:207], v107 offset:4096
    v_lshlrev_b32 v84, 16, v206
    v_mfma_f32_16x16x32_bf16 a[100:103], a[240:243], v[196:199], a[100:103]
    ds_read_b64_tr_b16 a[208:209], v108 offset:0
    v_and_b32 v85, 0xffff0000, v206
    v_fma_f32 v84, v84, v52, v60
    buffer_load_dwordx4 v26, s[16:19], s38 offen offset:2048 lds
    v_mfma_f32_16x16x32_bf16 a[108:111], a[244:247], v[196:199], a[108:111]
    ds_read_b64_tr_b16 a[210:211], v108 offset:4096
    v_fma_f32 v85, v85, v53, v61
    v_cvt_pk_bf16_f32 v206, v84, v85
    v_mfma_f32_16x16x32_bf16 a[104:107], a[244:247], v[192:195], a[104:107]
    ds_read_b64_tr_b16 a[212:213], v109 offset:0
    v_lshlrev_b32 v86, 16, v207
    v_and_b32 v87, 0xffff0000, v207
    buffer_load_dwordx4 v27, s[16:19], s38 offen offset:3072 lds
    v_mfma_f32_16x16x32_bf16 a[112:115], a[248:251], v[192:195], a[112:115]
    ds_read_b64_tr_b16 a[214:215], v109 offset:4096
    v_fma_f32 v86, v86, v54, v62
    v_fma_f32 v87, v87, v55, v63
    v_mfma_f32_16x16x32_bf16 a[116:119], a[248:251], v[196:199], a[116:119]
    ds_read_b64_tr_b16 a[216:217], v110 offset:0
    v_cvt_pk_bf16_f32 v207, v86, v87
    v_mfma_f32_16x16x32_bf16 a[124:127], a[252:255], v[196:199], a[124:127]
    ds_read_b64_tr_b16 a[218:219], v110 offset:4096
    v_mfma_f32_16x16x32_bf16 a[120:123], a[252:255], v[192:195], a[120:123]
    ds_read_b64_tr_b16 a[220:221], v111 offset:0
    ds_read_b128 v[48:51], v6 offset:3072
    s_waitcnt lgkmcnt(8)
    v_mfma_f32_16x16x32_bf16 a[0:3], a[192:195], v[200:203], a[0:3]
    ds_read_b64_tr_b16 a[222:223], v111 offset:4096
    ds_read_b128 v[52:55], v6 offset:3088
    v_mfma_f32_16x16x32_bf16 a[4:7], a[192:195], v[204:207], a[4:7]
    ds_read_b64_tr_b16 a[224:225], v104 offset:256
    ds_read_b128 v[56:59], v6 offset:1280
    v_mfma_f32_16x16x32_bf16 a[12:15], a[196:199], v[204:207], a[12:15]
    ds_read_b64_tr_b16 a[226:227], v104 offset:4352
    ds_read_b128 v[60:63], v6 offset:1296
    v_mfma_f32_16x16x32_bf16 a[8:11], a[196:199], v[200:203], a[8:11]
    ds_read_b64_tr_b16 a[228:229], v105 offset:256
    v_mfma_f32_16x16x32_bf16 a[16:19], a[200:203], v[200:203], a[16:19]
    ds_read_b64_tr_b16 a[230:231], v105 offset:4352
    v_mfma_f32_16x16x32_bf16 a[20:23], a[200:203], v[204:207], a[20:23]
    ds_read_b64_tr_b16 a[232:233], v106 offset:256
    v_mfma_f32_16x16x32_bf16 a[28:31], a[204:207], v[204:207], a[28:31]
    ds_read_b64_tr_b16 a[234:235], v106 offset:4352
    v_mfma_f32_16x16x32_bf16 a[24:27], a[204:207], v[200:203], a[24:27]
    ds_read_b64_tr_b16 a[236:237], v107 offset:256
    s_waitcnt lgkmcnt(5)
    v_mfma_f32_16x16x32_bf16 a[32:35], a[208:211], v[200:203], a[32:35]
    ds_read_b64_tr_b16 a[238:239], v107 offset:4352
    v_lshlrev_b32 v80, 16, v208
    v_and_b32 v81, 0xffff0000, v208
    v_mfma_f32_16x16x32_bf16 a[36:39], a[208:211], v[204:207], a[36:39]
    ds_read_b64_tr_b16 a[240:241], v108 offset:256
    v_fma_f32 v80, v80, v48, v56
    v_fma_f32 v81, v81, v49, v57
    s_waitcnt vmcnt(8)
    s_barrier
    v_mfma_f32_16x16x32_bf16 a[44:47], a[212:215], v[204:207], a[44:47]
    ds_read_b64_tr_b16 a[242:243], v108 offset:4352
    v_cvt_pk_bf16_f32 v208, v80, v81
    v_lshlrev_b32 v82, 16, v209
    v_mfma_f32_16x16x32_bf16 a[40:43], a[212:215], v[200:203], a[40:43]
    ds_read_b64_tr_b16 a[244:245], v109 offset:256
    v_and_b32 v83, 0xffff0000, v209
    v_fma_f32 v82, v82, v50, v58
    s_add_u32 m0, s44, 131072
    s_add_u32 s38, s37, 32768
    v_mfma_f32_16x16x32_bf16 a[48:51], a[216:219], v[200:203], a[48:51]
    ds_read_b64_tr_b16 a[246:247], v109 offset:4352
    v_fma_f32 v83, v83, v51, v59
    v_cvt_pk_bf16_f32 v209, v82, v83
    buffer_load_dwordx4 v24, s[16:19], s37 offen offset:0 lds
    v_mfma_f32_16x16x32_bf16 a[52:55], a[216:219], v[204:207], a[52:55]
    ds_read_b64_tr_b16 a[248:249], v110 offset:256
    v_lshlrev_b32 v84, 16, v210
    v_mfma_f32_16x16x32_bf16 a[60:63], a[220:223], v[204:207], a[60:63]
    ds_read_b64_tr_b16 a[250:251], v110 offset:4352
    v_and_b32 v85, 0xffff0000, v210
    v_fma_f32 v84, v84, v52, v60
    buffer_load_dwordx4 v25, s[16:19], s37 offen offset:1024 lds
    v_mfma_f32_16x16x32_bf16 a[56:59], a[220:223], v[200:203], a[56:59]
    ds_read_b64_tr_b16 a[252:253], v111 offset:256
    v_fma_f32 v85, v85, v53, v61
    v_cvt_pk_bf16_f32 v210, v84, v85
    s_waitcnt lgkmcnt(7)
    v_mfma_f32_16x16x32_bf16 a[64:67], a[224:227], v[200:203], a[64:67]
    ds_read_b64_tr_b16 a[254:255], v111 offset:4352
    v_lshlrev_b32 v86, 16, v211
    v_and_b32 v87, 0xffff0000, v211
    buffer_load_dwordx4 v26, s[16:19], s37 offen offset:2048 lds
    v_mfma_f32_16x16x32_bf16 a[68:71], a[224:227], v[204:207], a[68:71]
    ds_read_b64_tr_b16 a[192:193], v96 offset:0
    v_fma_f32 v86, v86, v54, v62
    v_fma_f32 v87, v87, v55, v63
    v_mfma_f32_16x16x32_bf16 a[76:79], a[228:231], v[204:207], a[76:79]
    ds_read_b64_tr_b16 a[194:195], v96 offset:4096
    v_cvt_pk_bf16_f32 v211, v86, v87
    buffer_load_dwordx4 v27, s[16:19], s37 offen offset:3072 lds
    v_mfma_f32_16x16x32_bf16 a[72:75], a[228:231], v[200:203], a[72:75]
    ds_read_b64_tr_b16 a[196:197], v97 offset:0
    v_lshlrev_b32 v80, 16, v212
    v_and_b32 v81, 0xffff0000, v212
    v_mfma_f32_16x16x32_bf16 a[80:83], a[232:235], v[200:203], a[80:83]
    ds_read_b64_tr_b16 a[198:199], v97 offset:4096
    v_fma_f32 v80, v80, v48, v56
    v_fma_f32 v81, v81, v49, v57
    s_add_u32 m0, s44, 135168
    s_add_u32 s37, s37, 262144
    v_mfma_f32_16x16x32_bf16 a[84:87], a[232:235], v[204:207], a[84:87]
    ds_read_b64_tr_b16 a[200:201], v98 offset:0
    v_cvt_pk_bf16_f32 v212, v80, v81
    v_lshlrev_b32 v82, 16, v213
    buffer_load_dwordx4 v24, s[16:19], s38 offen offset:0 lds
    v_mfma_f32_16x16x32_bf16 a[92:95], a[236:239], v[204:207], a[92:95]
    ds_read_b64_tr_b16 a[202:203], v98 offset:4096
    v_and_b32 v83, 0xffff0000, v213
    v_fma_f32 v82, v82, v50, v58
    v_mfma_f32_16x16x32_bf16 a[88:91], a[236:239], v[200:203], a[88:91]
    ds_read_b64_tr_b16 a[204:205], v99 offset:0
    v_fma_f32 v83, v83, v51, v59
    v_cvt_pk_bf16_f32 v213, v82, v83
    buffer_load_dwordx4 v25, s[16:19], s38 offen offset:1024 lds
    s_waitcnt lgkmcnt(7)
    v_mfma_f32_16x16x32_bf16 a[96:99], a[240:243], v[200:203], a[96:99]
    ds_read_b64_tr_b16 a[206:207], v99 offset:4096
    v_lshlrev_b32 v84, 16, v214
    v_mfma_f32_16x16x32_bf16 a[100:103], a[240:243], v[204:207], a[100:103]
    ds_read_b64_tr_b16 a[208:209], v100 offset:0
    v_and_b32 v85, 0xffff0000, v214
    v_fma_f32 v84, v84, v52, v60
    buffer_load_dwordx4 v26, s[16:19], s38 offen offset:2048 lds
    v_mfma_f32_16x16x32_bf16 a[108:111], a[244:247], v[204:207], a[108:111]
    ds_read_b64_tr_b16 a[210:211], v100 offset:4096
    v_fma_f32 v85, v85, v53, v61
    v_cvt_pk_bf16_f32 v214, v84, v85
    v_mfma_f32_16x16x32_bf16 a[104:107], a[244:247], v[200:203], a[104:107]
    ds_read_b64_tr_b16 a[212:213], v101 offset:0
    v_lshlrev_b32 v86, 16, v215
    v_and_b32 v87, 0xffff0000, v215
    buffer_load_dwordx4 v27, s[16:19], s38 offen offset:3072 lds
    v_mfma_f32_16x16x32_bf16 a[112:115], a[248:251], v[200:203], a[112:115]
    ds_read_b64_tr_b16 a[214:215], v101 offset:4096
    v_fma_f32 v86, v86, v54, v62
    v_fma_f32 v87, v87, v55, v63
    v_mfma_f32_16x16x32_bf16 a[116:119], a[248:251], v[204:207], a[116:119]
    ds_read_b64_tr_b16 a[216:217], v102 offset:0
    v_cvt_pk_bf16_f32 v215, v86, v87
    v_mfma_f32_16x16x32_bf16 a[124:127], a[252:255], v[204:207], a[124:127]
    ds_read_b64_tr_b16 a[218:219], v102 offset:4096
    v_mfma_f32_16x16x32_bf16 a[120:123], a[252:255], v[200:203], a[120:123]
    ds_read_b64_tr_b16 a[220:221], v103 offset:0
    ds_read_b128 v[48:51], v6 offset:3200
    s_waitcnt lgkmcnt(8)
    v_mfma_f32_16x16x32_bf16 a[0:3], a[192:195], v[208:211], a[0:3]
    ds_read_b64_tr_b16 a[222:223], v103 offset:4096
    ds_read_b128 v[52:55], v6 offset:3216
    v_mfma_f32_16x16x32_bf16 a[4:7], a[192:195], v[212:215], a[4:7]
    ds_read_b64_tr_b16 a[224:225], v96 offset:256
    ds_read_b128 v[56:59], v6 offset:1408
    v_mfma_f32_16x16x32_bf16 a[12:15], a[196:199], v[212:215], a[12:15]
    ds_read_b64_tr_b16 a[226:227], v96 offset:4352
    ds_read_b128 v[60:63], v6 offset:1424
    v_mfma_f32_16x16x32_bf16 a[8:11], a[196:199], v[208:211], a[8:11]
    ds_read_b64_tr_b16 a[228:229], v97 offset:256
    v_mfma_f32_16x16x32_bf16 a[16:19], a[200:203], v[208:211], a[16:19]
    ds_read_b64_tr_b16 a[230:231], v97 offset:4352
    v_mfma_f32_16x16x32_bf16 a[20:23], a[200:203], v[212:215], a[20:23]
    ds_read_b64_tr_b16 a[232:233], v98 offset:256
    v_mfma_f32_16x16x32_bf16 a[28:31], a[204:207], v[212:215], a[28:31]
    ds_read_b64_tr_b16 a[234:235], v98 offset:4352
    v_mfma_f32_16x16x32_bf16 a[24:27], a[204:207], v[208:211], a[24:27]
    ds_read_b64_tr_b16 a[236:237], v99 offset:256
    s_waitcnt lgkmcnt(5)
    v_mfma_f32_16x16x32_bf16 a[32:35], a[208:211], v[208:211], a[32:35]
    ds_read_b64_tr_b16 a[238:239], v99 offset:4352
    v_lshlrev_b32 v80, 16, v216
    v_and_b32 v81, 0xffff0000, v216
    v_mfma_f32_16x16x32_bf16 a[36:39], a[208:211], v[212:215], a[36:39]
    ds_read_b64_tr_b16 a[240:241], v100 offset:256
    v_fma_f32 v80, v80, v48, v56
    v_fma_f32 v81, v81, v49, v57
    s_waitcnt vmcnt(8)
    s_barrier
    v_mfma_f32_16x16x32_bf16 a[44:47], a[212:215], v[212:215], a[44:47]
    ds_read_b64_tr_b16 a[242:243], v100 offset:4352
    v_cvt_pk_bf16_f32 v216, v80, v81
    v_lshlrev_b32 v82, 16, v217
    v_mfma_f32_16x16x32_bf16 a[40:43], a[212:215], v[208:211], a[40:43]
    ds_read_b64_tr_b16 a[244:245], v101 offset:256
    v_and_b32 v83, 0xffff0000, v217
    v_fma_f32 v82, v82, v50, v58
    s_add_u32 m0, s44, 98304
    s_add_u32 s38, s37, 32768
    v_mfma_f32_16x16x32_bf16 a[48:51], a[216:219], v[208:211], a[48:51]
    ds_read_b64_tr_b16 a[246:247], v101 offset:4352
    v_fma_f32 v83, v83, v51, v59
    v_cvt_pk_bf16_f32 v217, v82, v83
    buffer_load_dwordx4 v24, s[16:19], s37 offen offset:0 lds
    v_mfma_f32_16x16x32_bf16 a[52:55], a[216:219], v[212:215], a[52:55]
    ds_read_b64_tr_b16 a[248:249], v102 offset:256
    v_lshlrev_b32 v84, 16, v218
    v_mfma_f32_16x16x32_bf16 a[60:63], a[220:223], v[212:215], a[60:63]
    ds_read_b64_tr_b16 a[250:251], v102 offset:4352
    v_and_b32 v85, 0xffff0000, v218
    v_fma_f32 v84, v84, v52, v60
    buffer_load_dwordx4 v25, s[16:19], s37 offen offset:1024 lds
    v_mfma_f32_16x16x32_bf16 a[56:59], a[220:223], v[208:211], a[56:59]
    ds_read_b64_tr_b16 a[252:253], v103 offset:256
    v_fma_f32 v85, v85, v53, v61
    v_cvt_pk_bf16_f32 v218, v84, v85
    s_waitcnt lgkmcnt(7)
    v_mfma_f32_16x16x32_bf16 a[64:67], a[224:227], v[208:211], a[64:67]
    ds_read_b64_tr_b16 a[254:255], v103 offset:4352
    v_lshlrev_b32 v86, 16, v219
    v_and_b32 v87, 0xffff0000, v219
    buffer_load_dwordx4 v26, s[16:19], s37 offen offset:2048 lds
    v_mfma_f32_16x16x32_bf16 a[68:71], a[224:227], v[212:215], a[68:71]
    ds_read_b64_tr_b16 a[192:193], v96 offset:32768
    v_fma_f32 v86, v86, v54, v62
    v_fma_f32 v87, v87, v55, v63
    v_mfma_f32_16x16x32_bf16 a[76:79], a[228:231], v[212:215], a[76:79]
    ds_read_b64_tr_b16 a[194:195], v96 offset:36864
    v_cvt_pk_bf16_f32 v219, v86, v87
    buffer_load_dwordx4 v27, s[16:19], s37 offen offset:3072 lds
    v_mfma_f32_16x16x32_bf16 a[72:75], a[228:231], v[208:211], a[72:75]
    ds_read_b64_tr_b16 a[196:197], v97 offset:32768
    v_lshlrev_b32 v80, 16, v220
    v_and_b32 v81, 0xffff0000, v220
    v_mfma_f32_16x16x32_bf16 a[80:83], a[232:235], v[208:211], a[80:83]
    ds_read_b64_tr_b16 a[198:199], v97 offset:36864
    v_fma_f32 v80, v80, v48, v56
    v_fma_f32 v81, v81, v49, v57
    s_add_u32 m0, s44, 102400
    s_add_u32 s37, s37, 262144
    v_mfma_f32_16x16x32_bf16 a[84:87], a[232:235], v[212:215], a[84:87]
    ds_read_b64_tr_b16 a[200:201], v98 offset:32768
    v_cvt_pk_bf16_f32 v220, v80, v81
    v_lshlrev_b32 v82, 16, v221
    buffer_load_dwordx4 v24, s[16:19], s38 offen offset:0 lds
    v_mfma_f32_16x16x32_bf16 a[92:95], a[236:239], v[212:215], a[92:95]
    ds_read_b64_tr_b16 a[202:203], v98 offset:36864
    v_and_b32 v83, 0xffff0000, v221
    v_fma_f32 v82, v82, v50, v58
    v_mfma_f32_16x16x32_bf16 a[88:91], a[236:239], v[208:211], a[88:91]
    ds_read_b64_tr_b16 a[204:205], v99 offset:32768
    v_fma_f32 v83, v83, v51, v59
    v_cvt_pk_bf16_f32 v221, v82, v83
    buffer_load_dwordx4 v25, s[16:19], s38 offen offset:1024 lds
    s_waitcnt lgkmcnt(7)
    v_mfma_f32_16x16x32_bf16 a[96:99], a[240:243], v[208:211], a[96:99]
    ds_read_b64_tr_b16 a[206:207], v99 offset:36864
    v_lshlrev_b32 v84, 16, v222
    v_mfma_f32_16x16x32_bf16 a[100:103], a[240:243], v[212:215], a[100:103]
    ds_read_b64_tr_b16 a[208:209], v100 offset:32768
    v_and_b32 v85, 0xffff0000, v222
    v_fma_f32 v84, v84, v52, v60
    buffer_load_dwordx4 v26, s[16:19], s38 offen offset:2048 lds
    v_mfma_f32_16x16x32_bf16 a[108:111], a[244:247], v[212:215], a[108:111]
    ds_read_b64_tr_b16 a[210:211], v100 offset:36864
    v_fma_f32 v85, v85, v53, v61
    v_cvt_pk_bf16_f32 v222, v84, v85
    v_mfma_f32_16x16x32_bf16 a[104:107], a[244:247], v[208:211], a[104:107]
    ds_read_b64_tr_b16 a[212:213], v101 offset:32768
    v_lshlrev_b32 v86, 16, v223
    v_and_b32 v87, 0xffff0000, v223
    buffer_load_dwordx4 v27, s[16:19], s38 offen offset:3072 lds
    v_mfma_f32_16x16x32_bf16 a[112:115], a[248:251], v[208:211], a[112:115]
    ds_read_b64_tr_b16 a[214:215], v101 offset:36864
    v_fma_f32 v86, v86, v54, v62
    v_fma_f32 v87, v87, v55, v63
    v_mfma_f32_16x16x32_bf16 a[116:119], a[248:251], v[212:215], a[116:119]
    ds_read_b64_tr_b16 a[216:217], v102 offset:32768
    v_cvt_pk_bf16_f32 v223, v86, v87
    v_mfma_f32_16x16x32_bf16 a[124:127], a[252:255], v[212:215], a[124:127]
    ds_read_b64_tr_b16 a[218:219], v102 offset:36864
    v_mfma_f32_16x16x32_bf16 a[120:123], a[252:255], v[208:211], a[120:123]
    ds_read_b64_tr_b16 a[220:221], v103 offset:32768
    ds_read_b128 v[48:51], v6 offset:3328
    s_waitcnt lgkmcnt(8)
    v_mfma_f32_16x16x32_bf16 a[0:3], a[192:195], v[216:219], a[0:3]
    ds_read_b64_tr_b16 a[222:223], v103 offset:36864
    ds_read_b128 v[52:55], v6 offset:3344
    v_mfma_f32_16x16x32_bf16 a[4:7], a[192:195], v[220:223], a[4:7]
    ds_read_b64_tr_b16 a[224:225], v96 offset:33024
    ds_read_b128 v[56:59], v6 offset:1536
    v_mfma_f32_16x16x32_bf16 a[12:15], a[196:199], v[220:223], a[12:15]
    ds_read_b64_tr_b16 a[226:227], v96 offset:37120
    ds_read_b128 v[60:63], v6 offset:1552
    v_mfma_f32_16x16x32_bf16 a[8:11], a[196:199], v[216:219], a[8:11]
    ds_read_b64_tr_b16 a[228:229], v97 offset:33024
    v_mfma_f32_16x16x32_bf16 a[16:19], a[200:203], v[216:219], a[16:19]
    ds_read_b64_tr_b16 a[230:231], v97 offset:37120
    v_mfma_f32_16x16x32_bf16 a[20:23], a[200:203], v[220:223], a[20:23]
    ds_read_b64_tr_b16 a[232:233], v98 offset:33024
    v_mfma_f32_16x16x32_bf16 a[28:31], a[204:207], v[220:223], a[28:31]
    ds_read_b64_tr_b16 a[234:235], v98 offset:37120
    v_mfma_f32_16x16x32_bf16 a[24:27], a[204:207], v[216:219], a[24:27]
    ds_read_b64_tr_b16 a[236:237], v99 offset:33024
    s_waitcnt lgkmcnt(5)
    v_mfma_f32_16x16x32_bf16 a[32:35], a[208:211], v[216:219], a[32:35]
    ds_read_b64_tr_b16 a[238:239], v99 offset:37120
    v_lshlrev_b32 v80, 16, v224
    v_and_b32 v81, 0xffff0000, v224
    v_mfma_f32_16x16x32_bf16 a[36:39], a[208:211], v[220:223], a[36:39]
    ds_read_b64_tr_b16 a[240:241], v100 offset:33024
    v_fma_f32 v80, v80, v48, v56
    v_fma_f32 v81, v81, v49, v57
    s_waitcnt vmcnt(8)
    s_barrier
    v_mfma_f32_16x16x32_bf16 a[44:47], a[212:215], v[220:223], a[44:47]
    ds_read_b64_tr_b16 a[242:243], v100 offset:37120
    v_cvt_pk_bf16_f32 v224, v80, v81
    v_lshlrev_b32 v82, 16, v225
    v_mfma_f32_16x16x32_bf16 a[40:43], a[212:215], v[216:219], a[40:43]
    ds_read_b64_tr_b16 a[244:245], v101 offset:33024
    v_and_b32 v83, 0xffff0000, v225
    v_fma_f32 v82, v82, v50, v58
    s_add_u32 m0, s44, 32768
    s_add_u32 s35, s33, 4096
    v_mfma_f32_16x16x32_bf16 a[48:51], a[216:219], v[216:219], a[48:51]
    ds_read_b64_tr_b16 a[246:247], v101 offset:37120
    v_fma_f32 v83, v83, v51, v59
    v_cvt_pk_bf16_f32 v225, v82, v83
    buffer_load_dwordx4 v8, s[8:11], s33 offen offset:0 lds
    v_mfma_f32_16x16x32_bf16 a[52:55], a[216:219], v[220:223], a[52:55]
    ds_read_b64_tr_b16 a[248:249], v102 offset:33024
    v_lshlrev_b32 v84, 16, v226
    v_mfma_f32_16x16x32_bf16 a[60:63], a[220:223], v[220:223], a[60:63]
    ds_read_b64_tr_b16 a[250:251], v102 offset:37120
    v_and_b32 v85, 0xffff0000, v226
    v_fma_f32 v84, v84, v52, v60
    buffer_load_dwordx4 v9, s[8:11], s33 offen offset:1024 lds
    v_mfma_f32_16x16x32_bf16 a[56:59], a[220:223], v[216:219], a[56:59]
    ds_read_b64_tr_b16 a[252:253], v103 offset:33024
    v_fma_f32 v85, v85, v53, v61
    v_cvt_pk_bf16_f32 v226, v84, v85
    s_waitcnt lgkmcnt(7)
    v_mfma_f32_16x16x32_bf16 a[64:67], a[224:227], v[216:219], a[64:67]
    ds_read_b64_tr_b16 a[254:255], v103 offset:37120
    v_lshlrev_b32 v86, 16, v227
    v_and_b32 v87, 0xffff0000, v227
    buffer_load_dwordx4 v10, s[8:11], s33 offen offset:2048 lds
    v_mfma_f32_16x16x32_bf16 a[68:71], a[224:227], v[220:223], a[68:71]
    ds_read_b64_tr_b16 a[192:193], v104 offset:32768
    v_fma_f32 v86, v86, v54, v62
    v_fma_f32 v87, v87, v55, v63
    v_mfma_f32_16x16x32_bf16 a[76:79], a[228:231], v[220:223], a[76:79]
    ds_read_b64_tr_b16 a[194:195], v104 offset:36864
    v_cvt_pk_bf16_f32 v227, v86, v87
    buffer_load_dwordx4 v11, s[8:11], s33 offen offset:3072 lds
    v_mfma_f32_16x16x32_bf16 a[72:75], a[228:231], v[216:219], a[72:75]
    ds_read_b64_tr_b16 a[196:197], v105 offset:32768
    v_lshlrev_b32 v80, 16, v228
    v_and_b32 v81, 0xffff0000, v228
    v_mfma_f32_16x16x32_bf16 a[80:83], a[232:235], v[216:219], a[80:83]
    ds_read_b64_tr_b16 a[198:199], v105 offset:36864
    v_fma_f32 v80, v80, v48, v56
    v_fma_f32 v81, v81, v49, v57
    s_add_u32 m0, s44, 36864
    s_add_u32 s33, s33, 32768
    v_mfma_f32_16x16x32_bf16 a[84:87], a[232:235], v[220:223], a[84:87]
    ds_read_b64_tr_b16 a[200:201], v106 offset:32768
    v_cvt_pk_bf16_f32 v228, v80, v81
    v_lshlrev_b32 v82, 16, v229
    buffer_load_dwordx4 v12, s[8:11], s35 offen offset:0 lds
    v_mfma_f32_16x16x32_bf16 a[92:95], a[236:239], v[220:223], a[92:95]
    ds_read_b64_tr_b16 a[202:203], v106 offset:36864
    v_and_b32 v83, 0xffff0000, v229
    v_fma_f32 v82, v82, v50, v58
    v_mfma_f32_16x16x32_bf16 a[88:91], a[236:239], v[216:219], a[88:91]
    ds_read_b64_tr_b16 a[204:205], v107 offset:32768
    v_fma_f32 v83, v83, v51, v59
    v_cvt_pk_bf16_f32 v229, v82, v83
    buffer_load_dwordx4 v13, s[8:11], s35 offen offset:1024 lds
    s_waitcnt lgkmcnt(7)
    v_mfma_f32_16x16x32_bf16 a[96:99], a[240:243], v[216:219], a[96:99]
    ds_read_b64_tr_b16 a[206:207], v107 offset:36864
    v_lshlrev_b32 v84, 16, v230
    v_mfma_f32_16x16x32_bf16 a[100:103], a[240:243], v[220:223], a[100:103]
    ds_read_b64_tr_b16 a[208:209], v108 offset:32768
    v_and_b32 v85, 0xffff0000, v230
    v_fma_f32 v84, v84, v52, v60
    buffer_load_dwordx4 v14, s[8:11], s35 offen offset:2048 lds
    v_mfma_f32_16x16x32_bf16 a[108:111], a[244:247], v[220:223], a[108:111]
    ds_read_b64_tr_b16 a[210:211], v108 offset:36864
    v_fma_f32 v85, v85, v53, v61
    v_cvt_pk_bf16_f32 v230, v84, v85
    v_mfma_f32_16x16x32_bf16 a[104:107], a[244:247], v[216:219], a[104:107]
    ds_read_b64_tr_b16 a[212:213], v109 offset:32768
    v_lshlrev_b32 v86, 16, v231
    v_and_b32 v87, 0xffff0000, v231
    buffer_load_dwordx4 v15, s[8:11], s35 offen offset:3072 lds
    v_mfma_f32_16x16x32_bf16 a[112:115], a[248:251], v[216:219], a[112:115]
    ds_read_b64_tr_b16 a[214:215], v109 offset:36864
    v_fma_f32 v86, v86, v54, v62
    v_fma_f32 v87, v87, v55, v63
    v_mfma_f32_16x16x32_bf16 a[116:119], a[248:251], v[220:223], a[116:119]
    ds_read_b64_tr_b16 a[216:217], v110 offset:32768
    v_cvt_pk_bf16_f32 v231, v86, v87
    v_mfma_f32_16x16x32_bf16 a[124:127], a[252:255], v[220:223], a[124:127]
    ds_read_b64_tr_b16 a[218:219], v110 offset:36864
    v_mfma_f32_16x16x32_bf16 a[120:123], a[252:255], v[216:219], a[120:123]
    ds_read_b64_tr_b16 a[220:221], v111 offset:32768
    ds_read_b128 v[48:51], v6 offset:3456
    s_waitcnt lgkmcnt(8)
    v_mfma_f32_16x16x32_bf16 a[0:3], a[192:195], v[224:227], a[0:3]
    ds_read_b64_tr_b16 a[222:223], v111 offset:36864
    ds_read_b128 v[52:55], v6 offset:3472
    v_mfma_f32_16x16x32_bf16 a[4:7], a[192:195], v[228:231], a[4:7]
    ds_read_b64_tr_b16 a[224:225], v104 offset:33024
    ds_read_b128 v[56:59], v6 offset:1664
    v_mfma_f32_16x16x32_bf16 a[12:15], a[196:199], v[228:231], a[12:15]
    ds_read_b64_tr_b16 a[226:227], v104 offset:37120
    ds_read_b128 v[60:63], v6 offset:1680
    v_mfma_f32_16x16x32_bf16 a[8:11], a[196:199], v[224:227], a[8:11]
    ds_read_b64_tr_b16 a[228:229], v105 offset:33024
    v_mfma_f32_16x16x32_bf16 a[16:19], a[200:203], v[224:227], a[16:19]
    ds_read_b64_tr_b16 a[230:231], v105 offset:37120
    v_mfma_f32_16x16x32_bf16 a[20:23], a[200:203], v[228:231], a[20:23]
    ds_read_b64_tr_b16 a[232:233], v106 offset:33024
    v_mfma_f32_16x16x32_bf16 a[28:31], a[204:207], v[228:231], a[28:31]
    ds_read_b64_tr_b16 a[234:235], v106 offset:37120
    v_mfma_f32_16x16x32_bf16 a[24:27], a[204:207], v[224:227], a[24:27]
    ds_read_b64_tr_b16 a[236:237], v107 offset:33024
    s_waitcnt lgkmcnt(5)
    v_mfma_f32_16x16x32_bf16 a[32:35], a[208:211], v[224:227], a[32:35]
    ds_read_b64_tr_b16 a[238:239], v107 offset:37120
    v_lshlrev_b32 v80, 16, v232
    v_and_b32 v81, 0xffff0000, v232
    v_mfma_f32_16x16x32_bf16 a[36:39], a[208:211], v[228:231], a[36:39]
    ds_read_b64_tr_b16 a[240:241], v108 offset:33024
    v_fma_f32 v80, v80, v48, v56
    v_fma_f32 v81, v81, v49, v57
    s_waitcnt vmcnt(8)
    s_barrier
    v_mfma_f32_16x16x32_bf16 a[44:47], a[212:215], v[228:231], a[44:47]
    ds_read_b64_tr_b16 a[242:243], v108 offset:37120
    v_cvt_pk_bf16_f32 v232, v80, v81
    v_lshlrev_b32 v82, 16, v233
    v_mfma_f32_16x16x32_bf16 a[40:43], a[212:215], v[224:227], a[40:43]
    ds_read_b64_tr_b16 a[244:245], v109 offset:33024
    v_and_b32 v83, 0xffff0000, v233
    v_fma_f32 v82, v82, v50, v58
    s_sub_u32 s33, s33, 65536
    s_add_u32 m0, s44, 0
    s_add_u32 s35, s33, 4096
    buffer_load_dwordx4 v8, s[8:11], s33 offen offset:0 lds
    v_mfma_f32_16x16x32_bf16 a[48:51], a[216:219], v[224:227], a[48:51]
    ds_read_b64_tr_b16 a[246:247], v109 offset:37120
    v_fma_f32 v83, v83, v51, v59
    v_cvt_pk_bf16_f32 v233, v82, v83
    buffer_load_dwordx4 v9, s[8:11], s33 offen offset:1024 lds
    v_mfma_f32_16x16x32_bf16 a[52:55], a[216:219], v[228:231], a[52:55]
    ds_read_b64_tr_b16 a[248:249], v110 offset:33024
    v_lshlrev_b32 v84, 16, v234
    buffer_load_dwordx4 v10, s[8:11], s33 offen offset:2048 lds
    v_mfma_f32_16x16x32_bf16 a[60:63], a[220:223], v[228:231], a[60:63]
    ds_read_b64_tr_b16 a[250:251], v110 offset:37120
    v_and_b32 v85, 0xffff0000, v234
    v_fma_f32 v84, v84, v52, v60
    buffer_load_dwordx4 v11, s[8:11], s33 offen offset:3072 lds
    v_mfma_f32_16x16x32_bf16 a[56:59], a[220:223], v[224:227], a[56:59]
    ds_read_b64_tr_b16 a[252:253], v111 offset:33024
    v_fma_f32 v85, v85, v53, v61
    v_cvt_pk_bf16_f32 v234, v84, v85
    s_add_u32 m0, s44, 4096
    s_waitcnt lgkmcnt(7)
    v_mfma_f32_16x16x32_bf16 a[64:67], a[224:227], v[224:227], a[64:67]
    ds_read_b64_tr_b16 a[254:255], v111 offset:37120
    v_lshlrev_b32 v86, 16, v235
    v_and_b32 v87, 0xffff0000, v235
    s_add_u32 s33, s33, 32768
    buffer_load_dwordx4 v12, s[8:11], s35 offen offset:0 lds
    v_mfma_f32_16x16x32_bf16 a[68:71], a[224:227], v[228:231], a[68:71]
    ds_read_b64_tr_b16 a[192:193], v104 offset:0
    v_fma_f32 v86, v86, v54, v62
    v_fma_f32 v87, v87, v55, v63
    buffer_load_dwordx4 v13, s[8:11], s35 offen offset:1024 lds
    v_mfma_f32_16x16x32_bf16 a[76:79], a[228:231], v[228:231], a[76:79]
    ds_read_b64_tr_b16 a[194:195], v104 offset:4096
    v_cvt_pk_bf16_f32 v235, v86, v87
    buffer_load_dwordx4 v14, s[8:11], s35 offen offset:2048 lds
    v_mfma_f32_16x16x32_bf16 a[72:75], a[228:231], v[224:227], a[72:75]
    ds_read_b64_tr_b16 a[196:197], v105 offset:0
    v_lshlrev_b32 v80, 16, v236
    v_and_b32 v81, 0xffff0000, v236
    buffer_load_dwordx4 v15, s[8:11], s35 offen offset:3072 lds
    v_mfma_f32_16x16x32_bf16 a[80:83], a[232:235], v[224:227], a[80:83]
    ds_read_b64_tr_b16 a[198:199], v105 offset:4096
    v_fma_f32 v80, v80, v48, v56
    v_fma_f32 v81, v81, v49, v57
    s_add_u32 s33, s33, 32768
    s_add_u32 m0, s44, 65536
    v_mfma_f32_16x16x32_bf16 a[84:87], a[232:235], v[228:231], a[84:87]
    ds_read_b64_tr_b16 a[200:201], v106 offset:0
    v_cvt_pk_bf16_f32 v236, v80, v81
    v_lshlrev_b32 v82, 16, v237
    s_add_u32 s36, s34, 4096
    buffer_load_dwordx4 v120, s[12:15], s34 offen offset:0 lds
    v_mfma_f32_16x16x32_bf16 a[92:95], a[236:239], v[228:231], a[92:95]
    ds_read_b64_tr_b16 a[202:203], v106 offset:4096
    v_and_b32 v83, 0xffff0000, v237
    v_fma_f32 v82, v82, v50, v58
    buffer_load_dwordx4 v121, s[12:15], s34 offen offset:1024 lds
    v_mfma_f32_16x16x32_bf16 a[88:91], a[236:239], v[224:227], a[88:91]
    ds_read_b64_tr_b16 a[204:205], v107 offset:0
    v_fma_f32 v83, v83, v51, v59
    v_cvt_pk_bf16_f32 v237, v82, v83
    buffer_load_dwordx4 v122, s[12:15], s34 offen offset:2048 lds
    s_waitcnt lgkmcnt(7)
    v_mfma_f32_16x16x32_bf16 a[96:99], a[240:243], v[224:227], a[96:99]
    ds_read_b64_tr_b16 a[206:207], v107 offset:4096
    v_lshlrev_b32 v84, 16, v238
    buffer_load_dwordx4 v123, s[12:15], s34 offen offset:3072 lds
    v_mfma_f32_16x16x32_bf16 a[100:103], a[240:243], v[228:231], a[100:103]
    ds_read_b64_tr_b16 a[208:209], v108 offset:0
    v_and_b32 v85, 0xffff0000, v238
    v_fma_f32 v84, v84, v52, v60
    s_add_u32 m0, s44, 69632
    s_add_u32 s34, s34, 32768
    buffer_load_dwordx4 v120, s[12:15], s36 offen offset:0 lds
    v_mfma_f32_16x16x32_bf16 a[108:111], a[244:247], v[228:231], a[108:111]
    ds_read_b64_tr_b16 a[210:211], v108 offset:4096
    v_fma_f32 v85, v85, v53, v61
    v_cvt_pk_bf16_f32 v238, v84, v85
    buffer_load_dwordx4 v121, s[12:15], s36 offen offset:1024 lds
    v_mfma_f32_16x16x32_bf16 a[104:107], a[244:247], v[224:227], a[104:107]
    ds_read_b64_tr_b16 a[212:213], v109 offset:0
    v_lshlrev_b32 v86, 16, v239
    v_and_b32 v87, 0xffff0000, v239
    buffer_load_dwordx4 v122, s[12:15], s36 offen offset:2048 lds
    v_mfma_f32_16x16x32_bf16 a[112:115], a[248:251], v[224:227], a[112:115]
    ds_read_b64_tr_b16 a[214:215], v109 offset:4096
    v_fma_f32 v86, v86, v54, v62
    v_fma_f32 v87, v87, v55, v63
    buffer_load_dwordx4 v123, s[12:15], s36 offen offset:3072 lds
    v_mfma_f32_16x16x32_bf16 a[116:119], a[248:251], v[228:231], a[116:119]
    ds_read_b64_tr_b16 a[216:217], v110 offset:0
    v_cvt_pk_bf16_f32 v239, v86, v87
    v_mfma_f32_16x16x32_bf16 a[124:127], a[252:255], v[228:231], a[124:127]
    ds_read_b64_tr_b16 a[218:219], v110 offset:4096
    v_mfma_f32_16x16x32_bf16 a[120:123], a[252:255], v[224:227], a[120:123]
    ds_read_b64_tr_b16 a[220:221], v111 offset:0
    s_waitcnt lgkmcnt(7)
    v_mfma_f32_16x16x32_bf16 a[0:3], a[192:195], v[232:235], a[0:3]
    ds_read_b64_tr_b16 a[222:223], v111 offset:4096
    v_mfma_f32_16x16x32_bf16 a[4:7], a[192:195], v[236:239], a[4:7]
    ds_read_b64_tr_b16 a[224:225], v104 offset:256
    v_mfma_f32_16x16x32_bf16 a[12:15], a[196:199], v[236:239], a[12:15]
    ds_read_b64_tr_b16 a[226:227], v104 offset:4352
    v_mfma_f32_16x16x32_bf16 a[8:11], a[196:199], v[232:235], a[8:11]
    ds_read_b64_tr_b16 a[228:229], v105 offset:256
    v_mfma_f32_16x16x32_bf16 a[16:19], a[200:203], v[232:235], a[16:19]
    ds_read_b64_tr_b16 a[230:231], v105 offset:4352
    v_mfma_f32_16x16x32_bf16 a[20:23], a[200:203], v[236:239], a[20:23]
    ds_read_b64_tr_b16 a[232:233], v106 offset:256
    v_mfma_f32_16x16x32_bf16 a[28:31], a[204:207], v[236:239], a[28:31]
    ds_read_b64_tr_b16 a[234:235], v106 offset:4352
    v_mfma_f32_16x16x32_bf16 a[24:27], a[204:207], v[232:235], a[24:27]
    ds_read_b64_tr_b16 a[236:237], v107 offset:256
    s_waitcnt lgkmcnt(7)
    v_mfma_f32_16x16x32_bf16 a[32:35], a[208:211], v[232:235], a[32:35]
    ds_read_b64_tr_b16 a[238:239], v107 offset:4352
    v_mfma_f32_16x16x32_bf16 a[36:39], a[208:211], v[236:239], a[36:39]
    ds_read_b64_tr_b16 a[240:241], v108 offset:256
    v_mfma_f32_16x16x32_bf16 a[44:47], a[212:215], v[236:239], a[44:47]
    ds_read_b64_tr_b16 a[242:243], v108 offset:4352
    v_mfma_f32_16x16x32_bf16 a[40:43], a[212:215], v[232:235], a[40:43]
    ds_read_b64_tr_b16 a[244:245], v109 offset:256
    v_mfma_f32_16x16x32_bf16 a[48:51], a[216:219], v[232:235], a[48:51]
    ds_read_b64_tr_b16 a[246:247], v109 offset:4352
    v_mfma_f32_16x16x32_bf16 a[52:55], a[216:219], v[236:239], a[52:55]
    ds_read_b64_tr_b16 a[248:249], v110 offset:256
    v_mfma_f32_16x16x32_bf16 a[60:63], a[220:223], v[236:239], a[60:63]
    ds_read_b64_tr_b16 a[250:251], v110 offset:4352
    v_mfma_f32_16x16x32_bf16 a[56:59], a[220:223], v[232:235], a[56:59]
    ds_read_b64_tr_b16 a[252:253], v111 offset:256
    s_waitcnt lgkmcnt(7)
    v_mfma_f32_16x16x32_bf16 a[64:67], a[224:227], v[232:235], a[64:67]
    ds_read_b64_tr_b16 a[254:255], v111 offset:4352
    v_mfma_f32_16x16x32_bf16 a[68:71], a[224:227], v[236:239], a[68:71]
    v_mfma_f32_16x16x32_bf16 a[76:79], a[228:231], v[236:239], a[76:79]
    v_mfma_f32_16x16x32_bf16 a[72:75], a[228:231], v[232:235], a[72:75]
    v_mfma_f32_16x16x32_bf16 a[80:83], a[232:235], v[232:235], a[80:83]
    v_mfma_f32_16x16x32_bf16 a[84:87], a[232:235], v[236:239], a[84:87]
    v_mfma_f32_16x16x32_bf16 a[92:95], a[236:239], v[236:239], a[92:95]
    v_mfma_f32_16x16x32_bf16 a[88:91], a[236:239], v[232:235], a[88:91]
    s_waitcnt lgkmcnt(0)
    v_mfma_f32_16x16x32_bf16 a[96:99], a[240:243], v[232:235], a[96:99]
    v_mfma_f32_16x16x32_bf16 a[100:103], a[240:243], v[236:239], a[100:103]
    v_mfma_f32_16x16x32_bf16 a[108:111], a[244:247], v[236:239], a[108:111]
    v_mfma_f32_16x16x32_bf16 a[104:107], a[244:247], v[232:235], a[104:107]
    v_mfma_f32_16x16x32_bf16 a[112:115], a[248:251], v[232:235], a[112:115]
    v_mfma_f32_16x16x32_bf16 a[116:119], a[248:251], v[236:239], a[116:119]
    v_mfma_f32_16x16x32_bf16 a[124:127], a[252:255], v[236:239], a[124:127]
    v_mfma_f32_16x16x32_bf16 a[120:123], a[252:255], v[232:235], a[120:123]
    s_nop 15
    v_accvgpr_read_b32 v32, a0
    v_accvgpr_read_b32 v33, a1
    v_accvgpr_read_b32 v34, a2
    v_accvgpr_read_b32 v35, a3
    v_accvgpr_read_b32 v36, a8
    v_accvgpr_read_b32 v37, a9
    v_accvgpr_read_b32 v38, a10
    v_accvgpr_read_b32 v39, a11
    v_cvt_pk_bf16_f32 v128, v32, v33
    v_cvt_pk_bf16_f32 v129, v34, v35
    v_cvt_pk_bf16_f32 v130, v36, v37
    v_cvt_pk_bf16_f32 v131, v38, v39
    v_accvgpr_read_b32 v32, a4
    v_accvgpr_read_b32 v33, a5
    v_accvgpr_read_b32 v34, a6
    v_accvgpr_read_b32 v35, a7
    v_accvgpr_read_b32 v36, a12
    v_accvgpr_read_b32 v37, a13
    v_accvgpr_read_b32 v38, a14
    v_accvgpr_read_b32 v39, a15
    v_cvt_pk_bf16_f32 v132, v32, v33
    v_cvt_pk_bf16_f32 v133, v34, v35
    v_cvt_pk_bf16_f32 v134, v36, v37
    v_cvt_pk_bf16_f32 v135, v38, v39
    s_nop 0
    v_permlane32_swap_b32 v128, v130
    v_permlane32_swap_b32 v129, v131
    s_nop 1
    v_permlane16_swap_b32 v128, v130
    v_permlane16_swap_b32 v129, v131
    s_nop 0
    v_permlane32_swap_b32 v132, v134
    v_permlane32_swap_b32 v133, v135
    s_nop 1
    v_permlane16_swap_b32 v132, v134
    v_permlane16_swap_b32 v133, v135
    v_accvgpr_read_b32 v32, a16
    v_accvgpr_read_b32 v33, a17
    v_accvgpr_read_b32 v34, a18
    v_accvgpr_read_b32 v35, a19
    v_accvgpr_read_b32 v36, a24
    v_accvgpr_read_b32 v37, a25
    v_accvgpr_read_b32 v38, a26
    v_accvgpr_read_b32 v39, a27
    v_cvt_pk_bf16_f32 v136, v32, v33
    v_cvt_pk_bf16_f32 v137, v34, v35
    v_cvt_pk_bf16_f32 v138, v36, v37
    v_cvt_pk_bf16_f32 v139, v38, v39
    v_accvgpr_read_b32 v32, a20
    v_accvgpr_read_b32 v33, a21
    v_accvgpr_read_b32 v34, a22
    v_accvgpr_read_b32 v35, a23
    v_accvgpr_read_b32 v36, a28
    v_accvgpr_read_b32 v37, a29
    v_accvgpr_read_b32 v38, a30
    v_accvgpr_read_b32 v39, a31
    v_cvt_pk_bf16_f32 v140, v32, v33
    v_cvt_pk_bf16_f32 v141, v34, v35
    v_cvt_pk_bf16_f32 v142, v36, v37
    v_cvt_pk_bf16_f32 v143, v38, v39
    s_nop 0
    v_permlane32_swap_b32 v136, v138
    v_permlane32_swap_b32 v137, v139
    s_nop 1
    v_permlane16_swap_b32 v136, v138
    v_permlane16_swap_b32 v137, v139
    s_nop 0
    v_permlane32_swap_b32 v140, v142
    v_permlane32_swap_b32 v141, v143
    s_nop 1
    v_permlane16_swap_b32 v140, v142
    v_permlane16_swap_b32 v141, v143
    v_accvgpr_read_b32 v32, a32
    v_accvgpr_read_b32 v33, a33
    v_accvgpr_read_b32 v34, a34
    v_accvgpr_read_b32 v35, a35
    v_accvgpr_read_b32 v36, a40
    v_accvgpr_read_b32 v37, a41
    v_accvgpr_read_b32 v38, a42
    v_accvgpr_read_b32 v39, a43
    v_cvt_pk_bf16_f32 v144, v32, v33
    v_cvt_pk_bf16_f32 v145, v34, v35
    v_cvt_pk_bf16_f32 v146, v36, v37
    v_cvt_pk_bf16_f32 v147, v38, v39
    v_accvgpr_read_b32 v32, a36
    v_accvgpr_read_b32 v33, a37
    v_accvgpr_read_b32 v34, a38
    v_accvgpr_read_b32 v35, a39
    v_accvgpr_read_b32 v36, a44
    v_accvgpr_read_b32 v37, a45
    v_accvgpr_read_b32 v38, a46
    v_accvgpr_read_b32 v39, a47
    v_cvt_pk_bf16_f32 v148, v32, v33
    v_cvt_pk_bf16_f32 v149, v34, v35
    v_cvt_pk_bf16_f32 v150, v36, v37
    v_cvt_pk_bf16_f32 v151, v38, v39
    s_nop 0
    v_permlane32_swap_b32 v144, v146
    v_permlane32_swap_b32 v145, v147
    s_nop 1
    v_permlane16_swap_b32 v144, v146
    v_permlane16_swap_b32 v145, v147
    s_nop 0
    v_permlane32_swap_b32 v148, v150
    v_permlane32_swap_b32 v149, v151
    s_nop 1
    v_permlane16_swap_b32 v148, v150
    v_permlane16_swap_b32 v149, v151
    v_accvgpr_read_b32 v32, a48
    v_accvgpr_read_b32 v33, a49
    v_accvgpr_read_b32 v34, a50
    v_accvgpr_read_b32 v35, a51
    v_accvgpr_read_b32 v36, a56
    v_accvgpr_read_b32 v37, a57
    v_accvgpr_read_b32 v38, a58
    v_accvgpr_read_b32 v39, a59
    v_cvt_pk_bf16_f32 v152, v32, v33
    v_cvt_pk_bf16_f32 v153, v34, v35
    v_cvt_pk_bf16_f32 v154, v36, v37
    v_cvt_pk_bf16_f32 v155, v38, v39
    v_accvgpr_read_b32 v32, a52
    v_accvgpr_read_b32 v33, a53
    v_accvgpr_read_b32 v34, a54
    v_accvgpr_read_b32 v35, a55
    v_accvgpr_read_b32 v36, a60
    v_accvgpr_read_b32 v37, a61
    v_accvgpr_read_b32 v38, a62
    v_accvgpr_read_b32 v39, a63
    v_cvt_pk_bf16_f32 v156, v32, v33
    v_cvt_pk_bf16_f32 v157, v34, v35
    v_cvt_pk_bf16_f32 v158, v36, v37
    v_cvt_pk_bf16_f32 v159, v38, v39
    s_nop 0
    v_permlane32_swap_b32 v152, v154
    v_permlane32_swap_b32 v153, v155
    s_nop 1
    v_permlane16_swap_b32 v152, v154
    v_permlane16_swap_b32 v153, v155
    s_nop 0
    v_permlane32_swap_b32 v156, v158
    v_permlane32_swap_b32 v157, v159
    s_nop 1
    v_permlane16_swap_b32 v156, v158
    v_permlane16_swap_b32 v157, v159
    v_accvgpr_read_b32 v32, a64
    v_accvgpr_read_b32 v33, a65
    v_accvgpr_read_b32 v34, a66
    v_accvgpr_read_b32 v35, a67
    v_accvgpr_read_b32 v36, a72
    v_accvgpr_read_b32 v37, a73
    v_accvgpr_read_b32 v38, a74
    v_accvgpr_read_b32 v39, a75
    v_cvt_pk_bf16_f32 v160, v32, v33
    v_cvt_pk_bf16_f32 v161, v34, v35
    v_cvt_pk_bf16_f32 v162, v36, v37
    v_cvt_pk_bf16_f32 v163, v38, v39
    v_accvgpr_read_b32 v32, a68
    v_accvgpr_read_b32 v33, a69
    v_accvgpr_read_b32 v34, a70
    v_accvgpr_read_b32 v35, a71
    v_accvgpr_read_b32 v36, a76
    v_accvgpr_read_b32 v37, a77
    v_accvgpr_read_b32 v38, a78
    v_accvgpr_read_b32 v39, a79
    v_cvt_pk_bf16_f32 v164, v32, v33
    v_cvt_pk_bf16_f32 v165, v34, v35
    v_cvt_pk_bf16_f32 v166, v36, v37
    v_cvt_pk_bf16_f32 v167, v38, v39
    s_nop 0
    v_permlane32_swap_b32 v160, v162
    v_permlane32_swap_b32 v161, v163
    s_nop 1
    v_permlane16_swap_b32 v160, v162
    v_permlane16_swap_b32 v161, v163
    s_nop 0
    v_permlane32_swap_b32 v164, v166
    v_permlane32_swap_b32 v165, v167
    s_nop 1
    v_permlane16_swap_b32 v164, v166
    v_permlane16_swap_b32 v165, v167
    v_accvgpr_read_b32 v32, a80
    v_accvgpr_read_b32 v33, a81
    v_accvgpr_read_b32 v34, a82
    v_accvgpr_read_b32 v35, a83
    v_accvgpr_read_b32 v36, a88
    v_accvgpr_read_b32 v37, a89
    v_accvgpr_read_b32 v38, a90
    v_accvgpr_read_b32 v39, a91
    v_cvt_pk_bf16_f32 v168, v32, v33
    v_cvt_pk_bf16_f32 v169, v34, v35
    v_cvt_pk_bf16_f32 v170, v36, v37
    v_cvt_pk_bf16_f32 v171, v38, v39
    v_accvgpr_read_b32 v32, a84
    v_accvgpr_read_b32 v33, a85
    v_accvgpr_read_b32 v34, a86
    v_accvgpr_read_b32 v35, a87
    v_accvgpr_read_b32 v36, a92
    v_accvgpr_read_b32 v37, a93
    v_accvgpr_read_b32 v38, a94
    v_accvgpr_read_b32 v39, a95
    v_cvt_pk_bf16_f32 v172, v32, v33
    v_cvt_pk_bf16_f32 v173, v34, v35
    v_cvt_pk_bf16_f32 v174, v36, v37
    v_cvt_pk_bf16_f32 v175, v38, v39
    s_nop 0
    v_permlane32_swap_b32 v168, v170
    v_permlane32_swap_b32 v169, v171
    s_nop 1
    v_permlane16_swap_b32 v168, v170
    v_permlane16_swap_b32 v169, v171
    s_nop 0
    v_permlane32_swap_b32 v172, v174
    v_permlane32_swap_b32 v173, v175
    s_nop 1
    v_permlane16_swap_b32 v172, v174
    v_permlane16_swap_b32 v173, v175
    v_accvgpr_read_b32 v32, a96
    v_accvgpr_read_b32 v33, a97
    v_accvgpr_read_b32 v34, a98
    v_accvgpr_read_b32 v35, a99
    v_accvgpr_read_b32 v36, a104
    v_accvgpr_read_b32 v37, a105
    v_accvgpr_read_b32 v38, a106
    v_accvgpr_read_b32 v39, a107
    v_cvt_pk_bf16_f32 v176, v32, v33
    v_cvt_pk_bf16_f32 v177, v34, v35
    v_cvt_pk_bf16_f32 v178, v36, v37
    v_cvt_pk_bf16_f32 v179, v38, v39
    v_accvgpr_read_b32 v32, a100
    v_accvgpr_read_b32 v33, a101
    v_accvgpr_read_b32 v34, a102
    v_accvgpr_read_b32 v35, a103
    v_accvgpr_read_b32 v36, a108
    v_accvgpr_read_b32 v37, a109
    v_accvgpr_read_b32 v38, a110
    v_accvgpr_read_b32 v39, a111
    v_cvt_pk_bf16_f32 v180, v32, v33
    v_cvt_pk_bf16_f32 v181, v34, v35
    v_cvt_pk_bf16_f32 v182, v36, v37
    v_cvt_pk_bf16_f32 v183, v38, v39
    s_nop 0
    v_permlane32_swap_b32 v176, v178
    v_permlane32_swap_b32 v177, v179
    s_nop 1
    v_permlane16_swap_b32 v176, v178
    v_permlane16_swap_b32 v177, v179
    s_nop 0
    v_permlane32_swap_b32 v180, v182
    v_permlane32_swap_b32 v181, v183
    s_nop 1
    v_permlane16_swap_b32 v180, v182
    v_permlane16_swap_b32 v181, v183
    v_accvgpr_read_b32 v32, a112
    v_accvgpr_read_b32 v33, a113
    v_accvgpr_read_b32 v34, a114
    v_accvgpr_read_b32 v35, a115
    v_accvgpr_read_b32 v36, a120
    v_accvgpr_read_b32 v37, a121
    v_accvgpr_read_b32 v38, a122
    v_accvgpr_read_b32 v39, a123
    v_cvt_pk_bf16_f32 v184, v32, v33
    v_cvt_pk_bf16_f32 v185, v34, v35
    v_cvt_pk_bf16_f32 v186, v36, v37
    v_cvt_pk_bf16_f32 v187, v38, v39
    v_accvgpr_read_b32 v32, a116
    v_accvgpr_read_b32 v33, a117
    v_accvgpr_read_b32 v34, a118
    v_accvgpr_read_b32 v35, a119
    v_accvgpr_read_b32 v36, a124
    v_accvgpr_read_b32 v37, a125
    v_accvgpr_read_b32 v38, a126
    v_accvgpr_read_b32 v39, a127
    v_cvt_pk_bf16_f32 v188, v32, v33
    v_cvt_pk_bf16_f32 v189, v34, v35
    v_cvt_pk_bf16_f32 v190, v36, v37
    v_cvt_pk_bf16_f32 v191, v38, v39
    s_nop 0
    v_permlane32_swap_b32 v184, v186
    v_permlane32_swap_b32 v185, v187
    s_nop 1
    v_permlane16_swap_b32 v184, v186
    v_permlane16_swap_b32 v185, v187
    s_nop 0
    v_permlane32_swap_b32 v188, v190
    v_permlane32_swap_b32 v189, v191
    s_nop 1
    v_permlane16_swap_b32 v188, v190
    v_permlane16_swap_b32 v189, v191
    v_mov_b32 v112, 0
    v_mov_b32 v113, 0
    v_mov_b32 v114, 0
    v_mov_b32 v115, 0
    v_mov_b32 v116, 0
    v_mov_b32 v117, 0
    v_mov_b32 v118, 0
    v_mov_b32 v119, 0
    v_mov_b32 v124, 0
    v_mov_b32 v125, 0
    v_mov_b32 v126, 0
    v_mov_b32 v127, 0
    v_mov_b32 v16, 0
    v_mov_b32 v17, 0
    v_mov_b32 v18, 0
    v_mov_b32 v19, 0
    v_mov_b32 v252, 0x3f803f80
    v_mov_b32 v253, 0x3f803f80
    v_mov_b32 v254, 0x3f803f80
    v_mov_b32 v255, 0x3f803f80
    s_waitcnt vmcnt(8)
    s_barrier
    ds_read_b128 a[192:195], v240 offset:0
    ds_read_b128 a[196:199], v240 offset:8192
    ds_read_b128 a[200:203], v240 offset:16384
    ds_read_b128 a[204:207], v240 offset:24576
    ds_read_b128 a[208:211], v241 offset:0
    ds_read_b128 a[212:215], v241 offset:8192
    ds_read_b128 a[216:219], v241 offset:16384
    ds_read_b128 a[220:223], v241 offset:24576
    v_accvgpr_write_b32 a0, 0
    v_accvgpr_write_b32 a1, 0
    s_waitcnt lgkmcnt(4)
    v_mfma_f32_16x16x32_bf16 v[32:35], a[192:195], v[128:131], v[112:115]
    v_accvgpr_write_b32 a2, 0
    v_accvgpr_write_b32 a3, 0
    v_mfma_f32_16x16x32_bf16 v[36:39], a[192:195], v[132:135], v[116:119]
    ds_read_b128 a[224:227], v242 offset:0
    v_accvgpr_write_b32 a4, 0
    v_accvgpr_write_b32 a5, 0
    v_mfma_f32_16x16x32_bf16 v[44:47], a[196:199], v[132:135], v[116:119]
    v_accvgpr_write_b32 a6, 0
    v_accvgpr_write_b32 a7, 0
    v_mfma_f32_16x16x32_bf16 v[40:43], a[196:199], v[128:131], v[112:115]
    ds_read_b128 a[228:231], v242 offset:8192
    v_accvgpr_write_b32 a8, 0
    v_accvgpr_write_b32 a9, 0
    v_mfma_f32_16x16x32_bf16 v[48:51], a[200:203], v[128:131], v[112:115]
    v_accvgpr_write_b32 a10, 0
    v_accvgpr_write_b32 a11, 0
    v_mfma_f32_16x16x32_bf16 v[52:55], a[200:203], v[132:135], v[116:119]
    ds_read_b128 a[232:235], v242 offset:16384
    v_accvgpr_write_b32 a12, 0
    v_accvgpr_write_b32 a13, 0
    v_mfma_f32_16x16x32_bf16 v[60:63], a[204:207], v[132:135], v[116:119]
    v_accvgpr_write_b32 a14, 0
    v_accvgpr_write_b32 a15, 0
    v_mfma_f32_16x16x32_bf16 v[56:59], a[204:207], v[128:131], v[112:115]
    ds_read_b128 a[236:239], v242 offset:24576
    v_accvgpr_write_b32 a16, 0
    v_accvgpr_write_b32 a17, 0
    s_waitcnt lgkmcnt(4)
    v_mfma_f32_16x16x32_bf16 v[32:35], a[208:211], v[136:139], v[32:35]
    v_accvgpr_write_b32 a18, 0
    v_accvgpr_write_b32 a19, 0
    v_mfma_f32_16x16x32_bf16 v[36:39], a[208:211], v[140:143], v[36:39]
    ds_read_b128 a[240:243], v243 offset:0
    v_accvgpr_write_b32 a20, 0
    v_accvgpr_write_b32 a21, 0
    v_mfma_f32_16x16x32_bf16 v[44:47], a[212:215], v[140:143], v[44:47]
    v_accvgpr_write_b32 a22, 0
    v_accvgpr_write_b32 a23, 0
    v_mfma_f32_16x16x32_bf16 v[40:43], a[212:215], v[136:139], v[40:43]
    ds_read_b128 a[244:247], v243 offset:8192
    v_accvgpr_write_b32 a24, 0
    v_accvgpr_write_b32 a25, 0
    v_mfma_f32_16x16x32_bf16 v[48:51], a[216:219], v[136:139], v[48:51]
    v_accvgpr_write_b32 a26, 0
    v_accvgpr_write_b32 a27, 0
    v_mfma_f32_16x16x32_bf16 v[52:55], a[216:219], v[140:143], v[52:55]
    ds_read_b128 a[248:251], v243 offset:16384
    v_accvgpr_write_b32 a28, 0
    v_accvgpr_write_b32 a29, 0
    v_mfma_f32_16x16x32_bf16 v[60:63], a[220:223], v[140:143], v[60:63]
    v_accvgpr_write_b32 a30, 0
    v_accvgpr_write_b32 a31, 0
    v_mfma_f32_16x16x32_bf16 v[56:59], a[220:223], v[136:139], v[56:59]
    ds_read_b128 a[252:255], v243 offset:24576
    v_accvgpr_write_b32 a32, 0
    v_accvgpr_write_b32 a33, 0
    s_waitcnt lgkmcnt(4)
    v_mfma_f32_16x16x32_bf16 v[32:35], a[224:227], v[144:147], v[32:35]
    v_accvgpr_write_b32 a34, 0
    v_accvgpr_write_b32 a35, 0
    v_mfma_f32_16x16x32_bf16 v[36:39], a[224:227], v[148:151], v[36:39]
    ds_read_b128 a[192:195], v240 offset:256
    v_accvgpr_write_b32 a36, 0
    v_accvgpr_write_b32 a37, 0
    v_mfma_f32_16x16x32_bf16 v[44:47], a[228:231], v[148:151], v[44:47]
    v_accvgpr_write_b32 a38, 0
    v_accvgpr_write_b32 a39, 0
    v_mfma_f32_16x16x32_bf16 v[40:43], a[228:231], v[144:147], v[40:43]
    ds_read_b128 a[196:199], v240 offset:8448
    v_accvgpr_write_b32 a40, 0
    v_accvgpr_write_b32 a41, 0
    v_mfma_f32_16x16x32_bf16 v[48:51], a[232:235], v[144:147], v[48:51]
    v_accvgpr_write_b32 a42, 0
    v_accvgpr_write_b32 a43, 0
    v_mfma_f32_16x16x32_bf16 v[52:55], a[232:235], v[148:151], v[52:55]
    ds_read_b128 a[200:203], v240 offset:16640
    v_accvgpr_write_b32 a44, 0
    v_accvgpr_write_b32 a45, 0
    v_mfma_f32_16x16x32_bf16 v[60:63], a[236:239], v[148:151], v[60:63]
    v_accvgpr_write_b32 a46, 0
    v_accvgpr_write_b32 a47, 0
    v_mfma_f32_16x16x32_bf16 v[56:59], a[236:239], v[144:147], v[56:59]
    ds_read_b128 a[204:207], v240 offset:24832
    v_accvgpr_write_b32 a48, 0
    v_accvgpr_write_b32 a49, 0
    s_waitcnt lgkmcnt(4)
    v_mfma_f32_16x16x32_bf16 v[32:35], a[240:243], v[152:155], v[32:35]
    v_accvgpr_write_b32 a50, 0
    v_accvgpr_write_b32 a51, 0
    v_mfma_f32_16x16x32_bf16 v[36:39], a[240:243], v[156:159], v[36:39]
    ds_read_b128 a[208:211], v241 offset:256
    v_accvgpr_write_b32 a52, 0
    v_accvgpr_write_b32 a53, 0
    v_mfma_f32_16x16x32_bf16 v[44:47], a[244:247], v[156:159], v[44:47]
    v_accvgpr_write_b32 a54, 0
    v_accvgpr_write_b32 a55, 0
    v_mfma_f32_16x16x32_bf16 v[40:43], a[244:247], v[152:155], v[40:43]
    ds_read_b128 a[212:215], v241 offset:8448
    v_accvgpr_write_b32 a56, 0
    v_accvgpr_write_b32 a57, 0
    v_mfma_f32_16x16x32_bf16 v[48:51], a[248:251], v[152:155], v[48:51]
    v_accvgpr_write_b32 a58, 0
    v_accvgpr_write_b32 a59, 0
    v_mfma_f32_16x16x32_bf16 v[52:55], a[248:251], v[156:159], v[52:55]
    ds_read_b128 a[216:219], v241 offset:16640
    v_accvgpr_write_b32 a60, 0
    v_accvgpr_write_b32 a61, 0
    v_mfma_f32_16x16x32_bf16 v[60:63], a[252:255], v[156:159], v[60:63]
    v_accvgpr_write_b32 a62, 0
    v_accvgpr_write_b32 a63, 0
    v_mfma_f32_16x16x32_bf16 v[56:59], a[252:255], v[152:155], v[56:59]
    ds_read_b128 a[220:223], v241 offset:24832
    v_accvgpr_write_b32 a64, 0
    v_accvgpr_write_b32 a65, 0
    s_waitcnt lgkmcnt(4)
    v_mfma_f32_16x16x32_bf16 v[32:35], a[192:195], v[160:163], v[32:35]
    v_accvgpr_write_b32 a66, 0
    v_accvgpr_write_b32 a67, 0
    v_mfma_f32_16x16x32_bf16 v[36:39], a[192:195], v[164:167], v[36:39]
    ds_read_b128 a[224:227], v242 offset:256
    v_accvgpr_write_b32 a68, 0
    v_accvgpr_write_b32 a69, 0
    v_mfma_f32_16x16x32_bf16 v[44:47], a[196:199], v[164:167], v[44:47]
    v_accvgpr_write_b32 a70, 0
    v_accvgpr_write_b32 a71, 0
    v_mfma_f32_16x16x32_bf16 v[40:43], a[196:199], v[160:163], v[40:43]
    ds_read_b128 a[228:231], v242 offset:8448
    v_accvgpr_write_b32 a72, 0
    v_accvgpr_write_b32 a73, 0
    v_mfma_f32_16x16x32_bf16 v[48:51], a[200:203], v[160:163], v[48:51]
    v_accvgpr_write_b32 a74, 0
    v_accvgpr_write_b32 a75, 0
    v_mfma_f32_16x16x32_bf16 v[52:55], a[200:203], v[164:167], v[52:55]
    ds_read_b128 a[232:235], v242 offset:16640
    v_accvgpr_write_b32 a76, 0
    v_accvgpr_write_b32 a77, 0
    v_mfma_f32_16x16x32_bf16 v[60:63], a[204:207], v[164:167], v[60:63]
    v_accvgpr_write_b32 a78, 0
    v_accvgpr_write_b32 a79, 0
    v_mfma_f32_16x16x32_bf16 v[56:59], a[204:207], v[160:163], v[56:59]
    ds_read_b128 a[236:239], v242 offset:24832
    v_accvgpr_write_b32 a80, 0
    v_accvgpr_write_b32 a81, 0
    s_waitcnt lgkmcnt(4)
    v_mfma_f32_16x16x32_bf16 v[32:35], a[208:211], v[168:171], v[32:35]
    v_accvgpr_write_b32 a82, 0
    v_accvgpr_write_b32 a83, 0
    v_mfma_f32_16x16x32_bf16 v[36:39], a[208:211], v[172:175], v[36:39]
    ds_read_b128 a[240:243], v243 offset:256
    v_accvgpr_write_b32 a84, 0
    v_accvgpr_write_b32 a85, 0
    v_mfma_f32_16x16x32_bf16 v[44:47], a[212:215], v[172:175], v[44:47]
    v_accvgpr_write_b32 a86, 0
    v_accvgpr_write_b32 a87, 0
    v_mfma_f32_16x16x32_bf16 v[40:43], a[212:215], v[168:171], v[40:43]
    ds_read_b128 a[244:247], v243 offset:8448
    v_accvgpr_write_b32 a88, 0
    v_accvgpr_write_b32 a89, 0
    v_mfma_f32_16x16x32_bf16 v[48:51], a[216:219], v[168:171], v[48:51]
    v_accvgpr_write_b32 a90, 0
    v_accvgpr_write_b32 a91, 0
    v_mfma_f32_16x16x32_bf16 v[52:55], a[216:219], v[172:175], v[52:55]
    ds_read_b128 a[248:251], v243 offset:16640
    v_accvgpr_write_b32 a92, 0
    v_accvgpr_write_b32 a93, 0
    v_mfma_f32_16x16x32_bf16 v[60:63], a[220:223], v[172:175], v[60:63]
    v_accvgpr_write_b32 a94, 0
    v_accvgpr_write_b32 a95, 0
    v_mfma_f32_16x16x32_bf16 v[56:59], a[220:223], v[168:171], v[56:59]
    ds_read_b128 a[252:255], v243 offset:24832
    v_accvgpr_write_b32 a96, 0
    v_accvgpr_write_b32 a97, 0
    s_waitcnt lgkmcnt(4)
    v_mfma_f32_16x16x32_bf16 v[32:35], a[224:227], v[176:179], v[32:35]
    v_accvgpr_write_b32 a98, 0
    v_accvgpr_write_b32 a99, 0
    v_mfma_f32_16x16x32_bf16 v[36:39], a[224:227], v[180:183], v[36:39]
    ds_read_b128 a[192:195], v240 offset:32768
    v_accvgpr_write_b32 a100, 0
    v_accvgpr_write_b32 a101, 0
    v_mfma_f32_16x16x32_bf16 v[44:47], a[228:231], v[180:183], v[44:47]
    v_accvgpr_write_b32 a102, 0
    v_accvgpr_write_b32 a103, 0
    v_mfma_f32_16x16x32_bf16 v[40:43], a[228:231], v[176:179], v[40:43]
    ds_read_b128 a[196:199], v240 offset:40960
    v_accvgpr_write_b32 a104, 0
    v_accvgpr_write_b32 a105, 0
    v_mfma_f32_16x16x32_bf16 v[48:51], a[232:235], v[176:179], v[48:51]
    v_accvgpr_write_b32 a106, 0
    v_accvgpr_write_b32 a107, 0
    v_mfma_f32_16x16x32_bf16 v[52:55], a[232:235], v[180:183], v[52:55]
    ds_read_b128 a[200:203], v240 offset:49152
    v_accvgpr_write_b32 a108, 0
    v_accvgpr_write_b32 a109, 0
    v_mfma_f32_16x16x32_bf16 v[60:63], a[236:239], v[180:183], v[60:63]
    v_accvgpr_write_b32 a110, 0
    v_accvgpr_write_b32 a111, 0
    v_mfma_f32_16x16x32_bf16 v[56:59], a[236:239], v[176:179], v[56:59]
    ds_read_b128 a[204:207], v240 offset:57344
    v_accvgpr_write_b32 a112, 0
    v_accvgpr_write_b32 a113, 0
    s_waitcnt lgkmcnt(4)
    v_mfma_f32_16x16x32_bf16 v[32:35], a[240:243], v[184:187], v[32:35]
    v_accvgpr_write_b32 a114, 0
    v_accvgpr_write_b32 a115, 0
    v_mfma_f32_16x16x32_bf16 v[36:39], a[240:243], v[188:191], v[36:39]
    ds_read_b128 a[208:211], v241 offset:32768
    v_accvgpr_write_b32 a116, 0
    v_accvgpr_write_b32 a117, 0
    v_mfma_f32_16x16x32_bf16 v[44:47], a[244:247], v[188:191], v[44:47]
    v_accvgpr_write_b32 a118, 0
    v_accvgpr_write_b32 a119, 0
    v_mfma_f32_16x16x32_bf16 v[40:43], a[244:247], v[184:187], v[40:43]
    ds_read_b128 a[212:215], v241 offset:40960
    v_accvgpr_write_b32 a120, 0
    v_accvgpr_write_b32 a121, 0
    v_mfma_f32_16x16x32_bf16 v[48:51], a[248:251], v[184:187], v[48:51]
    v_accvgpr_write_b32 a122, 0
    v_accvgpr_write_b32 a123, 0
    v_mfma_f32_16x16x32_bf16 v[52:55], a[248:251], v[188:191], v[52:55]
    ds_read_b128 a[216:219], v241 offset:49152
    v_accvgpr_write_b32 a124, 0
    v_accvgpr_write_b32 a125, 0
    v_mfma_f32_16x16x32_bf16 v[60:63], a[252:255], v[188:191], v[60:63]
    v_accvgpr_write_b32 a126, 0
    v_accvgpr_write_b32 a127, 0
    v_mfma_f32_16x16x32_bf16 v[56:59], a[252:255], v[184:187], v[56:59]
    s_barrier
    s_add_u32 m0, s44, 0
    s_add_u32 s35, s33, 4096
    buffer_load_dwordx4 v8, s[8:11], s33 offen offset:0 lds
    buffer_load_dwordx4 v9, s[8:11], s33 offen offset:1024 lds
    buffer_load_dwordx4 v10, s[8:11], s33 offen offset:2048 lds
    buffer_load_dwordx4 v11, s[8:11], s33 offen offset:3072 lds
    s_add_u32 m0, s44, 4096
    s_add_u32 s33, s33, 32768
    buffer_load_dwordx4 v12, s[8:11], s35 offen offset:0 lds
    buffer_load_dwordx4 v13, s[8:11], s35 offen offset:1024 lds
    buffer_load_dwordx4 v14, s[8:11], s35 offen offset:2048 lds
    buffer_load_dwordx4 v15, s[8:11], s35 offen offset:3072 lds
    s_nop 7
    v_max3_f32 v22, v32, v33, v34
    v_max3_f32 v23, v36, v37, v38
    v_max3_f32 v22, v22, v35, v40
    v_max3_f32 v23, v23, v39, v44
    v_max3_f32 v22, v22, v41, v42
    v_max3_f32 v23, v23, v45, v46
    v_max3_f32 v22, v22, v43, v48
    v_max3_f32 v23, v23, v47, v52
    v_max3_f32 v22, v22, v49, v50
    v_max3_f32 v23, v23, v53, v54
    v_max3_f32 v22, v22, v51, v56
    v_max3_f32 v23, v23, v55, v60
    v_max3_f32 v22, v22, v57, v58
    v_max3_f32 v23, v23, v61, v62
    v_max_f32 v22, v22, v59
    v_max_f32 v23, v23, v63
    v_max_f32 v24, v22, v23
    s_nop 15
    v_mov_b32 v24, v22
    s_nop 1
    v_permlane32_swap_b32 v22, v24
    s_nop 1
    v_max_f32 v22, v22, v24
    v_mov_b32 v24, v22
    s_nop 1
    v_permlane16_swap_b32 v22, v24
    s_nop 1
    v_max_f32 v22, v22, v24
    v_add_f32 v22, 0x42c00000, v22
    v_mov_b32 v24, v23
    s_nop 1
    v_permlane32_swap_b32 v23, v24
    s_nop 1
    v_max_f32 v23, v23, v24
    v_mov_b32 v24, v23
    s_nop 1
    v_permlane16_swap_b32 v23, v24
    s_nop 1
    v_max_f32 v23, v23, v24
    v_add_f32 v23, 0x42c00000, v23
    v_sub_f32 v32, v32, v22
    v_sub_f32 v33, v33, v22
    v_sub_f32 v34, v34, v22
    v_sub_f32 v35, v35, v22
    v_sub_f32 v36, v36, v23
    v_sub_f32 v37, v37, v23
    v_sub_f32 v38, v38, v23
    v_sub_f32 v39, v39, v23
    v_sub_f32 v40, v40, v22
    v_sub_f32 v41, v41, v22
    v_sub_f32 v42, v42, v22
    v_sub_f32 v43, v43, v22
    v_sub_f32 v44, v44, v23
    v_sub_f32 v45, v45, v23
    v_sub_f32 v46, v46, v23
    v_sub_f32 v47, v47, v23
    v_sub_f32 v48, v48, v22
    v_sub_f32 v49, v49, v22
    v_sub_f32 v50, v50, v22
    v_sub_f32 v51, v51, v22
    v_sub_f32 v52, v52, v23
    v_sub_f32 v53, v53, v23
    v_sub_f32 v54, v54, v23
    v_sub_f32 v55, v55, v23
    v_sub_f32 v56, v56, v22
    v_sub_f32 v57, v57, v22
    v_sub_f32 v58, v58, v22
    v_sub_f32 v59, v59, v22
    v_sub_f32 v60, v60, v23
    v_sub_f32 v61, v61, v23
    v_sub_f32 v62, v62, v23
    v_sub_f32 v63, v63, v23
    v_sub_f32 v112, v112, v22
    v_sub_f32 v113, v113, v22
    v_sub_f32 v114, v114, v22
    v_sub_f32 v115, v115, v22
    v_sub_f32 v116, v116, v23
    v_sub_f32 v117, v117, v23
    v_sub_f32 v118, v118, v23
    v_sub_f32 v119, v119, v23
    s_nop 3
    v_lshlrev_b32 v6, 7, v2
    s_cmp_eq_u32 s30, 3
    s_cbranch_scc0 PG2
    s_mul_i32 s3, s29, 14336
    s_mul_i32 s35, s28, 512*896
    s_add_u32 s3, s3, s35
    buffer_load_dword v30, v6, s[20:23], s3 offen
    s_add_u32 s3, s3, 8192
    buffer_load_dword v31, v6, s[20:23], s3 offen
PG2:
    s_cmp_eq_u32 s30, 2
    s_cbranch_scc0 PG3
    s_load_dwordx2 s[48:49], s[0:1], 56
    s_load_dwordx2 s[52:53], s[0:1], 64
    s_load_dwordx2 s[56:57], s[0:1], 72
    s_waitcnt lgkmcnt(0)
    s_and_b32 s49, s49, 0xffff
    s_mov_b32 s50, 1605632
    s_mov_b32 s51, 0x00020000
    s_and_b32 s53, s53, 0xffff
    s_mov_b32 s54, 1605632
    s_mov_b32 s55, 0x00020000
    s_and_b32 s57, s57, 0xffff
    s_mov_b32 s58, 1605632
    s_mov_b32 s59, 0x00020000
    s_mul_i32 s3, s2, 6272
    buffer_load_dword v29, v6, s[48:51], s3 offen
    buffer_load_dword v30, v6, s[52:55], s3 offen
    buffer_load_dword v31, v6, s[56:59], s3 offen
PG3:
    s_mov_b32 s40, 15
LOOP0:
    ds_read_b128 a[220:223], v241 offset:57344
    s_waitcnt lgkmcnt(4)
    v_mfma_f32_16x16x32_bf16 v[64:67], a[192:195], v[128:131], v[112:115]
    v_exp_f32 v32, v32
    v_mfma_f32_16x16x32_bf16 v[68:71], a[192:195], v[132:135], v[116:119]
    ds_read_b128 a[224:227], v242 offset:32768
    v_mfma_f32_16x16x32_bf16 v[76:79], a[196:199], v[132:135], v[116:119]
    v_exp_f32 v33, v33
    v_mfma_f32_16x16x32_bf16 v[72:75], a[196:199], v[128:131], v[112:115]
    ds_read_b128 a[228:231], v242 offset:40960
    v_mfma_f32_16x16x32_bf16 v[80:83], a[200:203], v[128:131], v[112:115]
    v_exp_f32 v34, v34
    v_mfma_f32_16x16x32_bf16 v[84:87], a[200:203], v[132:135], v[116:119]
    ds_read_b128 a[232:235], v242 offset:49152
    v_cvt_pk_bf16_f32 v96, v32, v33
    v_mfma_f32_16x16x32_bf16 v[92:95], a[204:207], v[132:135], v[116:119]
    v_mfma_f32_16x16x32_bf16 v[88:91], a[204:207], v[128:131], v[112:115]
    ds_read_b128 a[236:239], v242 offset:57344
    s_waitcnt lgkmcnt(4)
    v_mfma_f32_16x16x32_bf16 v[64:67], a[208:211], v[136:139], v[64:67]
    v_exp_f32 v35, v35
    v_mfma_f32_16x16x32_bf16 v[68:71], a[208:211], v[140:143], v[68:71]
    ds_read_b128 a[240:243], v243 offset:32768
    v_mfma_f32_16x16x32_bf16 v[76:79], a[212:215], v[140:143], v[76:79]
    s_waitcnt vmcnt(8)
    s_barrier
    v_mfma_f32_16x16x32_bf16 v[72:75], a[212:215], v[136:139], v[72:75]
    ds_read_b128 a[244:247], v243 offset:40960
    v_exp_f32 v36, v36
    v_mfma_f32_16x16x32_bf16 v[80:83], a[216:219], v[136:139], v[80:83]
    s_add_u32 m0, s44, 98304
    s_add_u32 s36, s34, 4096
    v_cvt_pk_bf16_f32 v97, v34, v35
    v_mfma_f32_16x16x32_bf16 v[84:87], a[216:219], v[140:143], v[84:87]
    ds_read_b128 a[248:251], v243 offset:49152
    buffer_load_dwordx4 v120, s[12:15], s34 offen offset:0 lds
    v_mfma_f32_16x16x32_bf16 v[92:95], a[220:223], v[140:143], v[92:95]
    v_exp_f32 v37, v37
    v_mfma_f32_16x16x32_bf16 v[88:91], a[220:223], v[136:139], v[88:91]
    ds_read_b128 a[252:255], v243 offset:57344
    s_waitcnt lgkmcnt(4)
    v_mfma_f32_16x16x32_bf16 v[64:67], a[224:227], v[144:147], v[64:67]
    v_exp_f32 v38, v38
    v_mfma_f32_16x16x32_bf16 v[68:71], a[224:227], v[148:151], v[68:71]
    ds_read_b128 a[192:195], v240 offset:33024
    v_cvt_pk_bf16_f32 v100, v36, v37
    v_mfma_f32_16x16x32_bf16 v[76:79], a[228:231], v[148:151], v[76:79]
    v_exp_f32 v39, v39
    v_mfma_f32_16x16x32_bf16 v[72:75], a[228:231], v[144:147], v[72:75]
    ds_read_b128 a[196:199], v240 offset:41216
    buffer_load_dwordx4 v121, s[12:15], s34 offen offset:1024 lds
    v_mfma_f32_16x16x32_bf16 v[80:83], a[232:235], v[144:147], v[80:83]
    v_mfma_f32_16x16x32_bf16 v[84:87], a[232:235], v[148:151], v[84:87]
    ds_read_b128 a[200:203], v240 offset:49408
    v_mfma_f32_16x16x32_bf16 v[92:95], a[236:239], v[148:151], v[92:95]
    v_exp_f32 v40, v40
    v_mfma_f32_16x16x32_bf16 v[88:91], a[236:239], v[144:147], v[88:91]
    ds_read_b128 a[204:207], v240 offset:57600
    s_waitcnt lgkmcnt(4)
    v_mfma_f32_16x16x32_bf16 v[64:67], a[240:243], v[152:155], v[64:67]
    v_cvt_pk_bf16_f32 v101, v38, v39
    v_mfma_f32_16x16x32_bf16 v[68:71], a[240:243], v[156:159], v[68:71]
    ds_read_b128 a[208:211], v241 offset:33024
    buffer_load_dwordx4 v122, s[12:15], s34 offen offset:2048 lds
    v_mfma_f32_16x16x32_bf16 v[76:79], a[244:247], v[156:159], v[76:79]
    v_exp_f32 v41, v41
    v_mfma_f32_16x16x32_bf16 v[72:75], a[244:247], v[152:155], v[72:75]
    ds_read_b128 a[212:215], v241 offset:41216
    v_mfma_f32_16x16x32_bf16 v[80:83], a[248:251], v[152:155], v[80:83]
    v_exp_f32 v42, v42
    v_mfma_f32_16x16x32_bf16 v[84:87], a[248:251], v[156:159], v[84:87]
    ds_read_b128 a[216:219], v241 offset:49408
    v_cvt_pk_bf16_f32 v98, v40, v41
    v_mfma_f32_16x16x32_bf16 v[92:95], a[252:255], v[156:159], v[92:95]
    v_exp_f32 v43, v43
    v_mfma_f32_16x16x32_bf16 v[88:91], a[252:255], v[152:155], v[88:91]
    ds_read_b128 a[220:223], v241 offset:57600
    buffer_load_dwordx4 v123, s[12:15], s34 offen offset:3072 lds
    s_waitcnt lgkmcnt(4)
    v_mfma_f32_16x16x32_bf16 v[64:67], a[192:195], v[160:163], v[64:67]
    v_exp_f32 v44, v44
    v_mfma_f32_16x16x32_bf16 v[68:71], a[192:195], v[164:167], v[68:71]
    ds_read_b128 a[224:227], v242 offset:33024
    v_cvt_pk_bf16_f32 v99, v42, v43
    v_mfma_f32_16x16x32_bf16 v[76:79], a[196:199], v[164:167], v[76:79]
    v_exp_f32 v45, v45
    v_mfma_f32_16x16x32_bf16 v[72:75], a[196:199], v[160:163], v[72:75]
    ds_read_b128 a[228:231], v242 offset:41216
    v_mfma_f32_16x16x32_bf16 v[80:83], a[200:203], v[160:163], v[80:83]
    s_add_u32 m0, s44, 102400
    s_add_u32 s34, s34, 32768
    v_mfma_f32_16x16x32_bf16 v[84:87], a[200:203], v[164:167], v[84:87]
    ds_read_b128 a[232:235], v242 offset:49408
    buffer_load_dwordx4 v120, s[12:15], s36 offen offset:0 lds
    v_mfma_f32_16x16x32_bf16 v[92:95], a[204:207], v[164:167], v[92:95]
    v_exp_f32 v46, v46
    v_mfma_f32_16x16x32_bf16 v[88:91], a[204:207], v[160:163], v[88:91]
    ds_read_b128 a[236:239], v242 offset:57600
    s_waitcnt lgkmcnt(4)
    v_mfma_f32_16x16x32_bf16 v[64:67], a[208:211], v[168:171], v[64:67]
    v_cvt_pk_bf16_f32 v102, v44, v45
    v_mfma_f32_16x16x32_bf16 v[68:71], a[208:211], v[172:175], v[68:71]
    ds_read_b128 a[240:243], v243 offset:33024
    v_mfma_f32_16x16x32_bf16 v[76:79], a[212:215], v[172:175], v[76:79]
    v_exp_f32 v47, v47
    v_mfma_f32_16x16x32_bf16 v[72:75], a[212:215], v[168:171], v[72:75]
    ds_read_b128 a[244:247], v243 offset:41216
    buffer_load_dwordx4 v121, s[12:15], s36 offen offset:1024 lds
    v_mfma_f32_16x16x32_bf16 v[80:83], a[216:219], v[168:171], v[80:83]
    v_exp_f32 v48, v48
    v_mfma_f32_16x16x32_bf16 v[84:87], a[216:219], v[172:175], v[84:87]
    ds_read_b128 a[248:251], v243 offset:49408
    v_cvt_pk_bf16_f32 v103, v46, v47
    v_mfma_f32_16x16x32_bf16 v[92:95], a[220:223], v[172:175], v[92:95]
    v_exp_f32 v49, v49
    v_mfma_f32_16x16x32_bf16 v[88:91], a[220:223], v[168:171], v[88:91]
    ds_read_b128 a[252:255], v243 offset:57600
    s_waitcnt lgkmcnt(4)
    v_mfma_f32_16x16x32_bf16 v[64:67], a[224:227], v[176:179], v[64:67]
    v_exp_f32 v50, v50
    v_mfma_f32_16x16x32_bf16 v[68:71], a[224:227], v[180:183], v[68:71]
    ds_read_b64_tr_b16 a[192:193], v244 offset:0
    buffer_load_dwordx4 v122, s[12:15], s36 offen offset:2048 lds
    v_mfma_f32_16x16x32_bf16 v[76:79], a[228:231], v[180:183], v[76:79]
    ds_read_b64_tr_b16 a[194:195], v244 offset:8192
    v_cvt_pk_bf16_f32 v104, v48, v49
    v_mfma_f32_16x16x32_bf16 v[72:75], a[228:231], v[176:179], v[72:75]
    ds_read_b64_tr_b16 a[196:197], v245 offset:0
    v_exp_f32 v51, v51
    v_mfma_f32_16x16x32_bf16 v[80:83], a[232:235], v[176:179], v[80:83]
    ds_read_b64_tr_b16 a[198:199], v245 offset:8192
    v_mfma_f32_16x16x32_bf16 v[84:87], a[232:235], v[180:183], v[84:87]
    ds_read_b64_tr_b16 a[200:201], v246 offset:0
    v_mfma_f32_16x16x32_bf16 v[92:95], a[236:239], v[180:183], v[92:95]
    ds_read_b64_tr_b16 a[202:203], v246 offset:8192
    v_exp_f32 v52, v52
    v_mfma_f32_16x16x32_bf16 v[88:91], a[236:239], v[176:179], v[88:91]
    ds_read_b64_tr_b16 a[204:205], v247 offset:0
    buffer_load_dwordx4 v123, s[12:15], s36 offen offset:3072 lds
    s_waitcnt lgkmcnt(7)
    v_mfma_f32_16x16x32_bf16 v[64:67], a[240:243], v[184:187], v[64:67]
    ds_read_b64_tr_b16 a[206:207], v247 offset:8192
    v_cvt_pk_bf16_f32 v105, v50, v51
    v_mfma_f32_16x16x32_bf16 v[68:71], a[240:243], v[188:191], v[68:71]
    ds_read_b64_tr_b16 a[208:209], v248 offset:0
    v_exp_f32 v53, v53
    v_mfma_f32_16x16x32_bf16 v[76:79], a[244:247], v[188:191], v[76:79]
    ds_read_b64_tr_b16 a[210:211], v248 offset:8192
    v_mfma_f32_16x16x32_bf16 v[72:75], a[244:247], v[184:187], v[72:75]
    ds_read_b64_tr_b16 a[212:213], v249 offset:0
    v_exp_f32 v54, v54
    v_mfma_f32_16x16x32_bf16 v[80:83], a[248:251], v[184:187], v[80:83]
    ds_read_b64_tr_b16 a[214:215], v249 offset:8192
    v_cvt_pk_bf16_f32 v108, v52, v53
    v_mfma_f32_16x16x32_bf16 v[84:87], a[248:251], v[188:191], v[84:87]
    ds_read_b64_tr_b16 a[216:217], v250 offset:0
    v_mfma_f32_16x16x32_bf16 v[92:95], a[252:255], v[188:191], v[92:95]
    ds_read_b64_tr_b16 a[218:219], v250 offset:8192
    v_exp_f32 v55, v55
    v_mfma_f32_16x16x32_bf16 v[88:91], a[252:255], v[184:187], v[88:91]
    ds_read_b64_tr_b16 a[220:221], v251 offset:0
    s_waitcnt lgkmcnt(7)
    v_mfma_f32_16x16x32_bf16 a[0:3], a[192:195], v[96:99], a[0:3]
    ds_read_b64_tr_b16 a[222:223], v251 offset:8192
    v_mfma_f32_16x16x32_bf16 a[4:7], a[192:195], v[100:103], a[4:7]
    ds_read_b64_tr_b16 a[224:225], v244 offset:256
    v_exp_f32 v56, v56
    v_mfma_f32_16x16x32_bf16 a[12:15], a[196:199], v[100:103], a[12:15]
    ds_read_b64_tr_b16 a[226:227], v244 offset:8448
    v_mfma_f32_16x16x32_bf16 v[124:127], v[252:255], v[96:99], v[124:127]
    v_mfma_f32_16x16x32_bf16 a[8:11], a[196:199], v[96:99], a[8:11]
    ds_read_b64_tr_b16 a[228:229], v245 offset:256
    v_cvt_pk_bf16_f32 v109, v54, v55
    v_mfma_f32_16x16x32_bf16 a[16:19], a[200:203], v[96:99], a[16:19]
    ds_read_b64_tr_b16 a[230:231], v245 offset:8448
    v_mfma_f32_16x16x32_bf16 v[16:19], v[252:255], v[100:103], v[16:19]
    v_mfma_f32_16x16x32_bf16 a[20:23], a[200:203], v[100:103], a[20:23]
    ds_read_b64_tr_b16 a[232:233], v246 offset:256
    v_exp_f32 v57, v57
    v_mfma_f32_16x16x32_bf16 a[28:31], a[204:207], v[100:103], a[28:31]
    ds_read_b64_tr_b16 a[234:235], v246 offset:8448
    v_exp_f32 v58, v58
    v_mfma_f32_16x16x32_bf16 a[24:27], a[204:207], v[96:99], a[24:27]
    ds_read_b64_tr_b16 a[236:237], v247 offset:256
    v_cvt_pk_bf16_f32 v106, v56, v57
    s_waitcnt lgkmcnt(7)
    v_mfma_f32_16x16x32_bf16 a[32:35], a[208:211], v[96:99], a[32:35]
    ds_read_b64_tr_b16 a[238:239], v247 offset:8448
    s_waitcnt vmcnt(8)
    s_barrier
    v_mfma_f32_16x16x32_bf16 a[36:39], a[208:211], v[100:103], a[36:39]
    ds_read_b64_tr_b16 a[240:241], v248 offset:256
    v_exp_f32 v59, v59
    v_mfma_f32_16x16x32_bf16 a[44:47], a[212:215], v[100:103], a[44:47]
    ds_read_b64_tr_b16 a[242:243], v248 offset:8448
    s_add_u32 m0, s44, 32768
    s_add_u32 s35, s33, 4096
    v_mfma_f32_16x16x32_bf16 a[40:43], a[212:215], v[96:99], a[40:43]
    ds_read_b64_tr_b16 a[244:245], v249 offset:256
    buffer_load_dwordx4 v8, s[8:11], s33 offen offset:0 lds
    v_mfma_f32_16x16x32_bf16 a[48:51], a[216:219], v[96:99], a[48:51]
    ds_read_b64_tr_b16 a[246:247], v249 offset:8448
    v_exp_f32 v60, v60
    v_mfma_f32_16x16x32_bf16 a[52:55], a[216:219], v[100:103], a[52:55]
    ds_read_b64_tr_b16 a[248:249], v250 offset:256
    v_cvt_pk_bf16_f32 v107, v58, v59
    v_mfma_f32_16x16x32_bf16 a[60:63], a[220:223], v[100:103], a[60:63]
    ds_read_b64_tr_b16 a[250:251], v250 offset:8448
    v_exp_f32 v61, v61
    v_mfma_f32_16x16x32_bf16 a[56:59], a[220:223], v[96:99], a[56:59]
    ds_read_b64_tr_b16 a[252:253], v251 offset:256
    s_waitcnt lgkmcnt(7)
    v_mfma_f32_16x16x32_bf16 a[64:67], a[224:227], v[96:99], a[64:67]
    ds_read_b64_tr_b16 a[254:255], v251 offset:8448
    v_mfma_f32_16x16x32_bf16 a[68:71], a[224:227], v[100:103], a[68:71]
    ds_read_b64_tr_b16 a[192:193], v244 offset:16384
    buffer_load_dwordx4 v9, s[8:11], s33 offen offset:1024 lds
    v_mfma_f32_16x16x32_bf16 a[76:79], a[228:231], v[100:103], a[76:79]
    ds_read_b64_tr_b16 a[194:195], v244 offset:24576
    v_exp_f32 v62, v62
    v_mfma_f32_16x16x32_bf16 a[72:75], a[228:231], v[96:99], a[72:75]
    ds_read_b64_tr_b16 a[196:197], v245 offset:16384
    v_cvt_pk_bf16_f32 v110, v60, v61
    v_mfma_f32_16x16x32_bf16 a[80:83], a[232:235], v[96:99], a[80:83]
    ds_read_b64_tr_b16 a[198:199], v245 offset:24576
    v_exp_f32 v63, v63
    v_mfma_f32_16x16x32_bf16 a[84:87], a[232:235], v[100:103], a[84:87]
    ds_read_b64_tr_b16 a[200:201], v246 offset:16384
    s_nop 0
    v_mfma_f32_16x16x32_bf16 a[92:95], a[236:239], v[100:103], a[92:95]
    ds_read_b64_tr_b16 a[202:203], v246 offset:24576
    v_cvt_pk_bf16_f32 v111, v62, v63
    v_mfma_f32_16x16x32_bf16 a[88:91], a[236:239], v[96:99], a[88:91]
    ds_read_b64_tr_b16 a[204:205], v247 offset:16384
    buffer_load_dwordx4 v10, s[8:11], s33 offen offset:2048 lds
    s_waitcnt lgkmcnt(7)
    v_mfma_f32_16x16x32_bf16 a[96:99], a[240:243], v[96:99], a[96:99]
    ds_read_b64_tr_b16 a[206:207], v247 offset:24576
    v_max3_f32 v22, v64, v65, v66
    v_mfma_f32_16x16x32_bf16 a[100:103], a[240:243], v[100:103], a[100:103]
    ds_read_b64_tr_b16 a[208:209], v248 offset:16384
    v_max3_f32 v23, v68, v69, v70
    v_mfma_f32_16x16x32_bf16 a[108:111], a[244:247], v[100:103], a[108:111]
    ds_read_b64_tr_b16 a[210:211], v248 offset:24576
    v_max3_f32 v22, v22, v67, v72
    v_mfma_f32_16x16x32_bf16 a[104:107], a[244:247], v[96:99], a[104:107]
    ds_read_b64_tr_b16 a[212:213], v249 offset:16384
    v_max3_f32 v23, v23, v71, v76
    v_mfma_f32_16x16x32_bf16 a[112:115], a[248:251], v[96:99], a[112:115]
    ds_read_b64_tr_b16 a[214:215], v249 offset:24576
    v_max3_f32 v22, v22, v73, v74
    v_mfma_f32_16x16x32_bf16 a[116:119], a[248:251], v[100:103], a[116:119]
    ds_read_b64_tr_b16 a[216:217], v250 offset:16384
    buffer_load_dwordx4 v11, s[8:11], s33 offen offset:3072 lds
    v_mfma_f32_16x16x32_bf16 a[124:127], a[252:255], v[100:103], a[124:127]
    ds_read_b64_tr_b16 a[218:219], v250 offset:24576
    v_max3_f32 v23, v23, v77, v78
    v_mfma_f32_16x16x32_bf16 a[120:123], a[252:255], v[96:99], a[120:123]
    ds_read_b64_tr_b16 a[220:221], v251 offset:16384
    s_waitcnt lgkmcnt(7)
    v_mfma_f32_16x16x32_bf16 a[0:3], a[192:195], v[104:107], a[0:3]
    ds_read_b64_tr_b16 a[222:223], v251 offset:24576
    v_max3_f32 v22, v22, v75, v80
    v_mfma_f32_16x16x32_bf16 a[4:7], a[192:195], v[108:111], a[4:7]
    ds_read_b64_tr_b16 a[224:225], v244 offset:16640
    v_max3_f32 v23, v23, v79, v84
    v_max3_f32 v22, v22, v81, v82
    v_max3_f32 v23, v23, v85, v86
    v_max3_f32 v22, v22, v83, v88
    v_mfma_f32_16x16x32_bf16 a[12:15], a[196:199], v[108:111], a[12:15]
    ds_read_b64_tr_b16 a[226:227], v244 offset:24832
    s_add_u32 m0, s44, 36864
    s_add_u32 s33, s33, 32768
    v_mfma_f32_16x16x32_bf16 v[124:127], v[252:255], v[104:107], v[124:127]
    v_mfma_f32_16x16x32_bf16 a[8:11], a[196:199], v[104:107], a[8:11]
    ds_read_b64_tr_b16 a[228:229], v245 offset:16640
    buffer_load_dwordx4 v12, s[8:11], s35 offen offset:0 lds
    v_mfma_f32_16x16x32_bf16 a[16:19], a[200:203], v[104:107], a[16:19]
    ds_read_b64_tr_b16 a[230:231], v245 offset:24832
    v_mfma_f32_16x16x32_bf16 v[16:19], v[252:255], v[108:111], v[16:19]
    v_max3_f32 v23, v23, v87, v92
    v_mfma_f32_16x16x32_bf16 a[20:23], a[200:203], v[108:111], a[20:23]
    ds_read_b64_tr_b16 a[232:233], v246 offset:16640
    v_max3_f32 v22, v22, v89, v90
    v_mfma_f32_16x16x32_bf16 a[28:31], a[204:207], v[108:111], a[28:31]
    ds_read_b64_tr_b16 a[234:235], v246 offset:24832
    v_mfma_f32_16x16x32_bf16 a[24:27], a[204:207], v[104:107], a[24:27]
    ds_read_b64_tr_b16 a[236:237], v247 offset:16640
    s_waitcnt lgkmcnt(7)
    v_mfma_f32_16x16x32_bf16 a[32:35], a[208:211], v[104:107], a[32:35]
    ds_read_b64_tr_b16 a[238:239], v247 offset:24832
    v_max3_f32 v23, v23, v93, v94
    v_mfma_f32_16x16x32_bf16 a[36:39], a[208:211], v[108:111], a[36:39]
    ds_read_b64_tr_b16 a[240:241], v248 offset:16640
    buffer_load_dwordx4 v13, s[8:11], s35 offen offset:1024 lds
    v_mfma_f32_16x16x32_bf16 a[44:47], a[212:215], v[108:111], a[44:47]
    ds_read_b64_tr_b16 a[242:243], v248 offset:24832
    v_max_f32 v22, v22, v91
    v_mfma_f32_16x16x32_bf16 a[40:43], a[212:215], v[104:107], a[40:43]
    ds_read_b64_tr_b16 a[244:245], v249 offset:16640
    v_mfma_f32_16x16x32_bf16 a[48:51], a[216:219], v[104:107], a[48:51]
    ds_read_b64_tr_b16 a[246:247], v249 offset:24832
    v_mfma_f32_16x16x32_bf16 a[52:55], a[216:219], v[108:111], a[52:55]
    ds_read_b64_tr_b16 a[248:249], v250 offset:16640
    v_max_f32 v23, v23, v95
    v_mfma_f32_16x16x32_bf16 a[60:63], a[220:223], v[108:111], a[60:63]
    ds_read_b64_tr_b16 a[250:251], v250 offset:24832
    v_mfma_f32_16x16x32_bf16 a[56:59], a[220:223], v[104:107], a[56:59]
    ds_read_b64_tr_b16 a[252:253], v251 offset:16640
    buffer_load_dwordx4 v14, s[8:11], s35 offen offset:2048 lds
    s_waitcnt lgkmcnt(7)
    v_mfma_f32_16x16x32_bf16 a[64:67], a[224:227], v[104:107], a[64:67]
    ds_read_b64_tr_b16 a[254:255], v251 offset:24832
    v_max_f32 v24, v22, v23
    v_mfma_f32_16x16x32_bf16 a[68:71], a[224:227], v[108:111], a[68:71]
    ds_read_b128 a[192:195], v240 offset:0
    v_mfma_f32_16x16x32_bf16 a[76:79], a[228:231], v[108:111], a[76:79]
    v_cmp_lt_f32 vcc, s41, v24
    v_mfma_f32_16x16x32_bf16 a[72:75], a[228:231], v[104:107], a[72:75]
    ds_read_b128 a[196:199], v240 offset:8192
    v_mfma_f32_16x16x32_bf16 a[80:83], a[232:235], v[104:107], a[80:83]
    v_mfma_f32_16x16x32_bf16 a[84:87], a[232:235], v[108:111], a[84:87]
    ds_read_b128 a[200:203], v240 offset:16384
    buffer_load_dwordx4 v15, s[8:11], s35 offen offset:3072 lds
    v_mfma_f32_16x16x32_bf16 a[92:95], a[236:239], v[108:111], a[92:95]
    v_mfma_f32_16x16x32_bf16 a[88:91], a[236:239], v[104:107], a[88:91]
    ds_read_b128 a[204:207], v240 offset:24576
    s_waitcnt lgkmcnt(4)
    v_mfma_f32_16x16x32_bf16 a[96:99], a[240:243], v[104:107], a[96:99]
    v_mfma_f32_16x16x32_bf16 a[100:103], a[240:243], v[108:111], a[100:103]
    ds_read_b128 a[208:211], v241 offset:0
    v_mfma_f32_16x16x32_bf16 a[108:111], a[244:247], v[108:111], a[108:111]
    v_mfma_f32_16x16x32_bf16 a[104:107], a[244:247], v[104:107], a[104:107]
    ds_read_b128 a[212:215], v241 offset:8192
    v_mfma_f32_16x16x32_bf16 a[112:115], a[248:251], v[104:107], a[112:115]
    v_mfma_f32_16x16x32_bf16 a[116:119], a[248:251], v[108:111], a[116:119]
    ds_read_b128 a[216:219], v241 offset:16384
    v_mfma_f32_16x16x32_bf16 a[124:127], a[252:255], v[108:111], a[124:127]
    v_mfma_f32_16x16x32_bf16 a[120:123], a[252:255], v[104:107], a[120:123]
    s_cbranch_vccnz SLOW_0_0
BACK_0_0:
    ds_read_b128 a[220:223], v241 offset:24576
    s_waitcnt lgkmcnt(4)
    v_mfma_f32_16x16x32_bf16 v[32:35], a[192:195], v[128:131], v[112:115]
    v_exp_f32 v64, v64
    v_mfma_f32_16x16x32_bf16 v[36:39], a[192:195], v[132:135], v[116:119]
    ds_read_b128 a[224:227], v242 offset:0
    v_mfma_f32_16x16x32_bf16 v[44:47], a[196:199], v[132:135], v[116:119]
    v_exp_f32 v65, v65
    v_mfma_f32_16x16x32_bf16 v[40:43], a[196:199], v[128:131], v[112:115]
    ds_read_b128 a[228:231], v242 offset:8192
    v_mfma_f32_16x16x32_bf16 v[48:51], a[200:203], v[128:131], v[112:115]
    v_exp_f32 v66, v66
    v_mfma_f32_16x16x32_bf16 v[52:55], a[200:203], v[132:135], v[116:119]
    ds_read_b128 a[232:235], v242 offset:16384
    v_cvt_pk_bf16_f32 v96, v64, v65
    v_mfma_f32_16x16x32_bf16 v[60:63], a[204:207], v[132:135], v[116:119]
    v_mfma_f32_16x16x32_bf16 v[56:59], a[204:207], v[128:131], v[112:115]
    ds_read_b128 a[236:239], v242 offset:24576
    s_waitcnt lgkmcnt(4)
    v_mfma_f32_16x16x32_bf16 v[32:35], a[208:211], v[136:139], v[32:35]
    v_exp_f32 v67, v67
    v_mfma_f32_16x16x32_bf16 v[36:39], a[208:211], v[140:143], v[36:39]
    ds_read_b128 a[240:243], v243 offset:0
    v_mfma_f32_16x16x32_bf16 v[44:47], a[212:215], v[140:143], v[44:47]
    s_waitcnt vmcnt(8)
    s_barrier
    v_mfma_f32_16x16x32_bf16 v[40:43], a[212:215], v[136:139], v[40:43]
    ds_read_b128 a[244:247], v243 offset:8192
    v_exp_f32 v68, v68
    v_mfma_f32_16x16x32_bf16 v[48:51], a[216:219], v[136:139], v[48:51]
    s_add_u32 m0, s44, 65536
    s_add_u32 s36, s34, 4096
    v_cvt_pk_bf16_f32 v97, v66, v67
    v_mfma_f32_16x16x32_bf16 v[52:55], a[216:219], v[140:143], v[52:55]
    ds_read_b128 a[248:251], v243 offset:16384
    buffer_load_dwordx4 v120, s[12:15], s34 offen offset:0 lds
    v_mfma_f32_16x16x32_bf16 v[60:63], a[220:223], v[140:143], v[60:63]
    v_exp_f32 v69, v69
    v_mfma_f32_16x16x32_bf16 v[56:59], a[220:223], v[136:139], v[56:59]
    ds_read_b128 a[252:255], v243 offset:24576
    s_waitcnt lgkmcnt(4)
    v_mfma_f32_16x16x32_bf16 v[32:35], a[224:227], v[144:147], v[32:35]
    v_exp_f32 v70, v70
    v_mfma_f32_16x16x32_bf16 v[36:39], a[224:227], v[148:151], v[36:39]
    ds_read_b128 a[192:195], v240 offset:256
    v_cvt_pk_bf16_f32 v100, v68, v69
    v_mfma_f32_16x16x32_bf16 v[44:47], a[228:231], v[148:151], v[44:47]
    v_exp_f32 v71, v71
    v_mfma_f32_16x16x32_bf16 v[40:43], a[228:231], v[144:147], v[40:43]
    ds_read_b128 a[196:199], v240 offset:8448
    buffer_load_dwordx4 v121, s[12:15], s34 offen offset:1024 lds
    v_mfma_f32_16x16x32_bf16 v[48:51], a[232:235], v[144:147], v[48:51]
    v_mfma_f32_16x16x32_bf16 v[52:55], a[232:235], v[148:151], v[52:55]
    ds_read_b128 a[200:203], v240 offset:16640
    v_mfma_f32_16x16x32_bf16 v[60:63], a[236:239], v[148:151], v[60:63]
    v_exp_f32 v72, v72
    v_mfma_f32_16x16x32_bf16 v[56:59], a[236:239], v[144:147], v[56:59]
    ds_read_b128 a[204:207], v240 offset:24832
    s_waitcnt lgkmcnt(4)
    v_mfma_f32_16x16x32_bf16 v[32:35], a[240:243], v[152:155], v[32:35]
    v_cvt_pk_bf16_f32 v101, v70, v71
    v_mfma_f32_16x16x32_bf16 v[36:39], a[240:243], v[156:159], v[36:39]
    ds_read_b128 a[208:211], v241 offset:256
    buffer_load_dwordx4 v122, s[12:15], s34 offen offset:2048 lds
    v_mfma_f32_16x16x32_bf16 v[44:47], a[244:247], v[156:159], v[44:47]
    v_exp_f32 v73, v73
    v_mfma_f32_16x16x32_bf16 v[40:43], a[244:247], v[152:155], v[40:43]
    ds_read_b128 a[212:215], v241 offset:8448
    v_mfma_f32_16x16x32_bf16 v[48:51], a[248:251], v[152:155], v[48:51]
    v_exp_f32 v74, v74
    v_mfma_f32_16x16x32_bf16 v[52:55], a[248:251], v[156:159], v[52:55]
    ds_read_b128 a[216:219], v241 offset:16640
    v_cvt_pk_bf16_f32 v98, v72, v73
    v_mfma_f32_16x16x32_bf16 v[60:63], a[252:255], v[156:159], v[60:63]
    v_exp_f32 v75, v75
    v_mfma_f32_16x16x32_bf16 v[56:59], a[252:255], v[152:155], v[56:59]
    ds_read_b128 a[220:223], v241 offset:24832
    buffer_load_dwordx4 v123, s[12:15], s34 offen offset:3072 lds
    s_waitcnt lgkmcnt(4)
    v_mfma_f32_16x16x32_bf16 v[32:35], a[192:195], v[160:163], v[32:35]
    v_exp_f32 v76, v76
    v_mfma_f32_16x16x32_bf16 v[36:39], a[192:195], v[164:167], v[36:39]
    ds_read_b128 a[224:227], v242 offset:256
    v_cvt_pk_bf16_f32 v99, v74, v75
    v_mfma_f32_16x16x32_bf16 v[44:47], a[196:199], v[164:167], v[44:47]
    v_exp_f32 v77, v77
    v_mfma_f32_16x16x32_bf16 v[40:43], a[196:199], v[160:163], v[40:43]
    ds_read_b128 a[228:231], v242 offset:8448
    v_mfma_f32_16x16x32_bf16 v[48:51], a[200:203], v[160:163], v[48:51]
    s_add_u32 m0, s44, 69632
    s_add_u32 s34, s34, 32768
    v_mfma_f32_16x16x32_bf16 v[52:55], a[200:203], v[164:167], v[52:55]
    ds_read_b128 a[232:235], v242 offset:16640
    buffer_load_dwordx4 v120, s[12:15], s36 offen offset:0 lds
    v_mfma_f32_16x16x32_bf16 v[60:63], a[204:207], v[164:167], v[60:63]
    v_exp_f32 v78, v78
    v_mfma_f32_16x16x32_bf16 v[56:59], a[204:207], v[160:163], v[56:59]
    ds_read_b128 a[236:239], v242 offset:24832
    s_waitcnt lgkmcnt(4)
    v_mfma_f32_16x16x32_bf16 v[32:35], a[208:211], v[168:171], v[32:35]
    v_cvt_pk_bf16_f32 v102, v76, v77
    v_mfma_f32_16x16x32_bf16 v[36:39], a[208:211], v[172:175], v[36:39]
    ds_read_b128 a[240:243], v243 offset:256
    v_mfma_f32_16x16x32_bf16 v[44:47], a[212:215], v[172:175], v[44:47]
    v_exp_f32 v79, v79
    v_mfma_f32_16x16x32_bf16 v[40:43], a[212:215], v[168:171], v[40:43]
    ds_read_b128 a[244:247], v243 offset:8448
    buffer_load_dwordx4 v121, s[12:15], s36 offen offset:1024 lds
    v_mfma_f32_16x16x32_bf16 v[48:51], a[216:219], v[168:171], v[48:51]
    v_exp_f32 v80, v80
    v_mfma_f32_16x16x32_bf16 v[52:55], a[216:219], v[172:175], v[52:55]
    ds_read_b128 a[248:251], v243 offset:16640
    v_cvt_pk_bf16_f32 v103, v78, v79
    v_mfma_f32_16x16x32_bf16 v[60:63], a[220:223], v[172:175], v[60:63]
    v_exp_f32 v81, v81
    v_mfma_f32_16x16x32_bf16 v[56:59], a[220:223], v[168:171], v[56:59]
    ds_read_b128 a[252:255], v243 offset:24832
    s_waitcnt lgkmcnt(4)
    v_mfma_f32_16x16x32_bf16 v[32:35], a[224:227], v[176:179], v[32:35]
    v_exp_f32 v82, v82
    v_mfma_f32_16x16x32_bf16 v[36:39], a[224:227], v[180:183], v[36:39]
    ds_read_b64_tr_b16 a[192:193], v244 offset:32768
    buffer_load_dwordx4 v122, s[12:15], s36 offen offset:2048 lds
    v_mfma_f32_16x16x32_bf16 v[44:47], a[228:231], v[180:183], v[44:47]
    ds_read_b64_tr_b16 a[194:195], v244 offset:40960
    v_cvt_pk_bf16_f32 v104, v80, v81
    v_mfma_f32_16x16x32_bf16 v[40:43], a[228:231], v[176:179], v[40:43]
    ds_read_b64_tr_b16 a[196:197], v245 offset:32768
    v_exp_f32 v83, v83
    v_mfma_f32_16x16x32_bf16 v[48:51], a[232:235], v[176:179], v[48:51]
    ds_read_b64_tr_b16 a[198:199], v245 offset:40960
    v_mfma_f32_16x16x32_bf16 v[52:55], a[232:235], v[180:183], v[52:55]
    ds_read_b64_tr_b16 a[200:201], v246 offset:32768
    v_mfma_f32_16x16x32_bf16 v[60:63], a[236:239], v[180:183], v[60:63]
    ds_read_b64_tr_b16 a[202:203], v246 offset:40960
    v_exp_f32 v84, v84
    v_mfma_f32_16x16x32_bf16 v[56:59], a[236:239], v[176:179], v[56:59]
    ds_read_b64_tr_b16 a[204:205], v247 offset:32768
    buffer_load_dwordx4 v123, s[12:15], s36 offen offset:3072 lds
    s_waitcnt lgkmcnt(7)
    v_mfma_f32_16x16x32_bf16 v[32:35], a[240:243], v[184:187], v[32:35]
    ds_read_b64_tr_b16 a[206:207], v247 offset:40960
    v_cvt_pk_bf16_f32 v105, v82, v83
    v_mfma_f32_16x16x32_bf16 v[36:39], a[240:243], v[188:191], v[36:39]
    ds_read_b64_tr_b16 a[208:209], v248 offset:32768
    v_exp_f32 v85, v85
    v_mfma_f32_16x16x32_bf16 v[44:47], a[244:247], v[188:191], v[44:47]
    ds_read_b64_tr_b16 a[210:211], v248 offset:40960
    v_mfma_f32_16x16x32_bf16 v[40:43], a[244:247], v[184:187], v[40:43]
    ds_read_b64_tr_b16 a[212:213], v249 offset:32768
    v_exp_f32 v86, v86
    v_mfma_f32_16x16x32_bf16 v[48:51], a[248:251], v[184:187], v[48:51]
    ds_read_b64_tr_b16 a[214:215], v249 offset:40960
    v_cvt_pk_bf16_f32 v108, v84, v85
    v_mfma_f32_16x16x32_bf16 v[52:55], a[248:251], v[188:191], v[52:55]
    ds_read_b64_tr_b16 a[216:217], v250 offset:32768
    v_mfma_f32_16x16x32_bf16 v[60:63], a[252:255], v[188:191], v[60:63]
    ds_read_b64_tr_b16 a[218:219], v250 offset:40960
    v_exp_f32 v87, v87
    v_mfma_f32_16x16x32_bf16 v[56:59], a[252:255], v[184:187], v[56:59]
    ds_read_b64_tr_b16 a[220:221], v251 offset:32768
    s_waitcnt lgkmcnt(7)
    v_mfma_f32_16x16x32_bf16 a[0:3], a[192:195], v[96:99], a[0:3]
    ds_read_b64_tr_b16 a[222:223], v251 offset:40960
    v_mfma_f32_16x16x32_bf16 a[4:7], a[192:195], v[100:103], a[4:7]
    ds_read_b64_tr_b16 a[224:225], v244 offset:33024
    v_exp_f32 v88, v88
    v_mfma_f32_16x16x32_bf16 a[12:15], a[196:199], v[100:103], a[12:15]
    ds_read_b64_tr_b16 a[226:227], v244 offset:41216
    v_mfma_f32_16x16x32_bf16 v[124:127], v[252:255], v[96:99], v[124:127]
    v_mfma_f32_16x16x32_bf16 a[8:11], a[196:199], v[96:99], a[8:11]
    ds_read_b64_tr_b16 a[228:229], v245 offset:33024
    v_cvt_pk_bf16_f32 v109, v86, v87
    v_mfma_f32_16x16x32_bf16 a[16:19], a[200:203], v[96:99], a[16:19]
    ds_read_b64_tr_b16 a[230:231], v245 offset:41216
    v_mfma_f32_16x16x32_bf16 v[16:19], v[252:255], v[100:103], v[16:19]
    v_mfma_f32_16x16x32_bf16 a[20:23], a[200:203], v[100:103], a[20:23]
    ds_read_b64_tr_b16 a[232:233], v246 offset:33024
    v_exp_f32 v89, v89
    v_mfma_f32_16x16x32_bf16 a[28:31], a[204:207], v[100:103], a[28:31]
    ds_read_b64_tr_b16 a[234:235], v246 offset:41216
    v_exp_f32 v90, v90
    v_mfma_f32_16x16x32_bf16 a[24:27], a[204:207], v[96:99], a[24:27]
    ds_read_b64_tr_b16 a[236:237], v247 offset:33024
    v_cvt_pk_bf16_f32 v106, v88, v89
    s_waitcnt lgkmcnt(7)
    v_mfma_f32_16x16x32_bf16 a[32:35], a[208:211], v[96:99], a[32:35]
    ds_read_b64_tr_b16 a[238:239], v247 offset:41216
    s_waitcnt vmcnt(8)
    s_barrier
    v_mfma_f32_16x16x32_bf16 a[36:39], a[208:211], v[100:103], a[36:39]
    ds_read_b64_tr_b16 a[240:241], v248 offset:33024
    v_exp_f32 v91, v91
    v_mfma_f32_16x16x32_bf16 a[44:47], a[212:215], v[100:103], a[44:47]
    ds_read_b64_tr_b16 a[242:243], v248 offset:41216
    s_add_u32 m0, s44, 0
    s_add_u32 s35, s33, 4096
    v_mfma_f32_16x16x32_bf16 a[40:43], a[212:215], v[96:99], a[40:43]
    ds_read_b64_tr_b16 a[244:245], v249 offset:33024
    buffer_load_dwordx4 v8, s[8:11], s33 offen offset:0 lds
    v_mfma_f32_16x16x32_bf16 a[48:51], a[216:219], v[96:99], a[48:51]
    ds_read_b64_tr_b16 a[246:247], v249 offset:41216
    v_exp_f32 v92, v92
    v_mfma_f32_16x16x32_bf16 a[52:55], a[216:219], v[100:103], a[52:55]
    ds_read_b64_tr_b16 a[248:249], v250 offset:33024
    v_cvt_pk_bf16_f32 v107, v90, v91
    v_mfma_f32_16x16x32_bf16 a[60:63], a[220:223], v[100:103], a[60:63]
    ds_read_b64_tr_b16 a[250:251], v250 offset:41216
    v_exp_f32 v93, v93
    v_mfma_f32_16x16x32_bf16 a[56:59], a[220:223], v[96:99], a[56:59]
    ds_read_b64_tr_b16 a[252:253], v251 offset:33024
    s_waitcnt lgkmcnt(7)
    v_mfma_f32_16x16x32_bf16 a[64:67], a[224:227], v[96:99], a[64:67]
    ds_read_b64_tr_b16 a[254:255], v251 offset:41216
    v_mfma_f32_16x16x32_bf16 a[68:71], a[224:227], v[100:103], a[68:71]
    ds_read_b64_tr_b16 a[192:193], v244 offset:49152
    buffer_load_dwordx4 v9, s[8:11], s33 offen offset:1024 lds
    v_mfma_f32_16x16x32_bf16 a[76:79], a[228:231], v[100:103], a[76:79]
    ds_read_b64_tr_b16 a[194:195], v244 offset:57344
    v_exp_f32 v94, v94
    v_mfma_f32_16x16x32_bf16 a[72:75], a[228:231], v[96:99], a[72:75]
    ds_read_b64_tr_b16 a[196:197], v245 offset:49152
    v_cvt_pk_bf16_f32 v110, v92, v93
    v_mfma_f32_16x16x32_bf16 a[80:83], a[232:235], v[96:99], a[80:83]
    ds_read_b64_tr_b16 a[198:199], v245 offset:57344
    v_exp_f32 v95, v95
    v_mfma_f32_16x16x32_bf16 a[84:87], a[232:235], v[100:103], a[84:87]
    ds_read_b64_tr_b16 a[200:201], v246 offset:49152
    s_nop 0
    v_mfma_f32_16x16x32_bf16 a[92:95], a[236:239], v[100:103], a[92:95]
    ds_read_b64_tr_b16 a[202:203], v246 offset:57344
    v_cvt_pk_bf16_f32 v111, v94, v95
    v_mfma_f32_16x16x32_bf16 a[88:91], a[236:239], v[96:99], a[88:91]
    ds_read_b64_tr_b16 a[204:205], v247 offset:49152
    buffer_load_dwordx4 v10, s[8:11], s33 offen offset:2048 lds
    s_waitcnt lgkmcnt(7)
    v_mfma_f32_16x16x32_bf16 a[96:99], a[240:243], v[96:99], a[96:99]
    ds_read_b64_tr_b16 a[206:207], v247 offset:57344
    v_max3_f32 v22, v32, v33, v34
    v_mfma_f32_16x16x32_bf16 a[100:103], a[240:243], v[100:103], a[100:103]
    ds_read_b64_tr_b16 a[208:209], v248 offset:49152
    v_max3_f32 v23, v36, v37, v38
    v_mfma_f32_16x16x32_bf16 a[108:111], a[244:247], v[100:103], a[108:111]
    ds_read_b64_tr_b16 a[210:211], v248 offset:57344
    v_max3_f32 v22, v22, v35, v40
    v_mfma_f32_16x16x32_bf16 a[104:107], a[244:247], v[96:99], a[104:107]
    ds_read_b64_tr_b16 a[212:213], v249 offset:49152
    v_max3_f32 v23, v23, v39, v44
    v_mfma_f32_16x16x32_bf16 a[112:115], a[248:251], v[96:99], a[112:115]
    ds_read_b64_tr_b16 a[214:215], v249 offset:57344
    v_max3_f32 v22, v22, v41, v42
    v_mfma_f32_16x16x32_bf16 a[116:119], a[248:251], v[100:103], a[116:119]
    ds_read_b64_tr_b16 a[216:217], v250 offset:49152
    buffer_load_dwordx4 v11, s[8:11], s33 offen offset:3072 lds
    v_mfma_f32_16x16x32_bf16 a[124:127], a[252:255], v[100:103], a[124:127]
    ds_read_b64_tr_b16 a[218:219], v250 offset:57344
    v_max3_f32 v23, v23, v45, v46
    v_mfma_f32_16x16x32_bf16 a[120:123], a[252:255], v[96:99], a[120:123]
    ds_read_b64_tr_b16 a[220:221], v251 offset:49152
    s_waitcnt lgkmcnt(7)
    v_mfma_f32_16x16x32_bf16 a[0:3], a[192:195], v[104:107], a[0:3]
    ds_read_b64_tr_b16 a[222:223], v251 offset:57344
    v_max3_f32 v22, v22, v43, v48
    v_mfma_f32_16x16x32_bf16 a[4:7], a[192:195], v[108:111], a[4:7]
    ds_read_b64_tr_b16 a[224:225], v244 offset:49408
    v_max3_f32 v23, v23, v47, v52
    v_max3_f32 v22, v22, v49, v50
    v_max3_f32 v23, v23, v53, v54
    v_max3_f32 v22, v22, v51, v56
    v_mfma_f32_16x16x32_bf16 a[12:15], a[196:199], v[108:111], a[12:15]
    ds_read_b64_tr_b16 a[226:227], v244 offset:57600
    s_add_u32 m0, s44, 4096
    s_add_u32 s33, s33, 32768
    v_mfma_f32_16x16x32_bf16 v[124:127], v[252:255], v[104:107], v[124:127]
    v_mfma_f32_16x16x32_bf16 a[8:11], a[196:199], v[104:107], a[8:11]
    ds_read_b64_tr_b16 a[228:229], v245 offset:49408
    buffer_load_dwordx4 v12, s[8:11], s35 offen offset:0 lds
    v_mfma_f32_16x16x32_bf16 a[16:19], a[200:203], v[104:107], a[16:19]
    ds_read_b64_tr_b16 a[230:231], v245 offset:57600
    v_mfma_f32_16x16x32_bf16 v[16:19], v[252:255], v[108:111], v[16:19]
    v_max3_f32 v23, v23, v55, v60
    v_mfma_f32_16x16x32_bf16 a[20:23], a[200:203], v[108:111], a[20:23]
    ds_read_b64_tr_b16 a[232:233], v246 offset:49408
    v_max3_f32 v22, v22, v57, v58
    v_mfma_f32_16x16x32_bf16 a[28:31], a[204:207], v[108:111], a[28:31]
    ds_read_b64_tr_b16 a[234:235], v246 offset:57600
    v_mfma_f32_16x16x32_bf16 a[24:27], a[204:207], v[104:107], a[24:27]
    ds_read_b64_tr_b16 a[236:237], v247 offset:49408
    s_waitcnt lgkmcnt(7)
    v_mfma_f32_16x16x32_bf16 a[32:35], a[208:211], v[104:107], a[32:35]
    ds_read_b64_tr_b16 a[238:239], v247 offset:57600
    v_max3_f32 v23, v23, v61, v62
    v_mfma_f32_16x16x32_bf16 a[36:39], a[208:211], v[108:111], a[36:39]
    ds_read_b64_tr_b16 a[240:241], v248 offset:49408
    buffer_load_dwordx4 v13, s[8:11], s35 offen offset:1024 lds
    v_mfma_f32_16x16x32_bf16 a[44:47], a[212:215], v[108:111], a[44:47]
    ds_read_b64_tr_b16 a[242:243], v248 offset:57600
    v_max_f32 v22, v22, v59
    v_mfma_f32_16x16x32_bf16 a[40:43], a[212:215], v[104:107], a[40:43]
    ds_read_b64_tr_b16 a[244:245], v249 offset:49408
    v_mfma_f32_16x16x32_bf16 a[48:51], a[216:219], v[104:107], a[48:51]
    ds_read_b64_tr_b16 a[246:247], v249 offset:57600
    v_mfma_f32_16x16x32_bf16 a[52:55], a[216:219], v[108:111], a[52:55]
    ds_read_b64_tr_b16 a[248:249], v250 offset:49408
    v_max_f32 v23, v23, v63
    v_mfma_f32_16x16x32_bf16 a[60:63], a[220:223], v[108:111], a[60:63]
    ds_read_b64_tr_b16 a[250:251], v250 offset:57600
    v_mfma_f32_16x16x32_bf16 a[56:59], a[220:223], v[104:107], a[56:59]
    ds_read_b64_tr_b16 a[252:253], v251 offset:49408
    buffer_load_dwordx4 v14, s[8:11], s35 offen offset:2048 lds
    s_waitcnt lgkmcnt(7)
    v_mfma_f32_16x16x32_bf16 a[64:67], a[224:227], v[104:107], a[64:67]
    ds_read_b64_tr_b16 a[254:255], v251 offset:57600
    v_max_f32 v24, v22, v23
    v_mfma_f32_16x16x32_bf16 a[68:71], a[224:227], v[108:111], a[68:71]
    ds_read_b128 a[192:195], v240 offset:32768
    v_mfma_f32_16x16x32_bf16 a[76:79], a[228:231], v[108:111], a[76:79]
    v_cmp_lt_f32 vcc, s41, v24
    v_mfma_f32_16x16x32_bf16 a[72:75], a[228:231], v[104:107], a[72:75]
    ds_read_b128 a[196:199], v240 offset:40960
    v_mfma_f32_16x16x32_bf16 a[80:83], a[232:235], v[104:107], a[80:83]
    v_mfma_f32_16x16x32_bf16 a[84:87], a[232:235], v[108:111], a[84:87]
    ds_read_b128 a[200:203], v240 offset:49152
    buffer_load_dwordx4 v15, s[8:11], s35 offen offset:3072 lds
    v_mfma_f32_16x16x32_bf16 a[92:95], a[236:239], v[108:111], a[92:95]
    v_mfma_f32_16x16x32_bf16 a[88:91], a[236:239], v[104:107], a[88:91]
    ds_read_b128 a[204:207], v240 offset:57344
    s_waitcnt lgkmcnt(4)
    v_mfma_f32_16x16x32_bf16 a[96:99], a[240:243], v[104:107], a[96:99]
    v_mfma_f32_16x16x32_bf16 a[100:103], a[240:243], v[108:111], a[100:103]
    ds_read_b128 a[208:211], v241 offset:32768
    v_mfma_f32_16x16x32_bf16 a[108:111], a[244:247], v[108:111], a[108:111]
    v_mfma_f32_16x16x32_bf16 a[104:107], a[244:247], v[104:107], a[104:107]
    ds_read_b128 a[212:215], v241 offset:40960
    v_mfma_f32_16x16x32_bf16 a[112:115], a[248:251], v[104:107], a[112:115]
    v_mfma_f32_16x16x32_bf16 a[116:119], a[248:251], v[108:111], a[116:119]
    ds_read_b128 a[216:219], v241 offset:49152
    v_mfma_f32_16x16x32_bf16 a[124:127], a[252:255], v[108:111], a[124:127]
    v_mfma_f32_16x16x32_bf16 a[120:123], a[252:255], v[104:107], a[120:123]
    s_cbranch_vccnz SLOW_1_0
BACK_1_0:
    s_sub_u32 s40, s40, 1
    s_cmp_lg_u32 s40, 0
    s_cbranch_scc1 LOOP0
LOOP_END:
    s_mul_i32 s35, s30, 448
    v_add_u32 v6, s35, v2
    v_add_u32 v6, 0, v6
    v_mul_u32_u24 v7, 9363, v6
    v_lshrrev_b32 v7, 20, v7
    v_and_b32 v7, 3, v7
    v_lshlrev_b32 v7, 5, v7
    v_lshlrev_b32 v6, 4, v6
    v_xor_b32 v6, v6, v7
    v_subrev_u32 v8, 0, v6
    v_add_u32 v6, s35, v2
    v_add_u32 v6, 64, v6
    v_mul_u32_u24 v7, 9363, v6
    v_lshrrev_b32 v7, 20, v7
    v_and_b32 v7, 3, v7
    v_lshlrev_b32 v7, 5, v7
    v_lshlrev_b32 v6, 4, v6
    v_xor_b32 v6, v6, v7
    v_subrev_u32 v9, 1024, v6
    v_add_u32 v6, s35, v2
    v_add_u32 v6, 128, v6
    v_mul_u32_u24 v7, 9363, v6
    v_lshrrev_b32 v7, 20, v7
    v_and_b32 v7, 3, v7
    v_lshlrev_b32 v7, 5, v7
    v_lshlrev_b32 v6, 4, v6
    v_xor_b32 v6, v6, v7
    v_subrev_u32 v10, 2048, v6
    v_add_u32 v6, s35, v2
    v_add_u32 v6, 192, v6
    v_mul_u32_u24 v7, 9363, v6
    v_lshrrev_b32 v7, 20, v7
    v_and_b32 v7, 3, v7
    v_lshlrev_b32 v7, 5, v7
    v_lshlrev_b32 v6, 4, v6
    v_xor_b32 v6, v6, v7
    v_subrev_u32 v11, 3072, v6
    v_add_u32 v6, s35, v2
    v_add_u32 v6, 256, v6
    v_mul_u32_u24 v7, 9363, v6
    v_lshrrev_b32 v7, 20, v7
    v_and_b32 v7, 3, v7
    v_lshlrev_b32 v7, 5, v7
    v_lshlrev_b32 v6, 4, v6
    v_xor_b32 v6, v6, v7
    v_subrev_u32 v12, 0, v6
    v_add_u32 v6, s35, v2
    v_add_u32 v6, 320, v6
    v_mul_u32_u24 v7, 9363, v6
    v_lshrrev_b32 v7, 20, v7
    v_and_b32 v7, 3, v7
    v_lshlrev_b32 v7, 5, v7
    v_lshlrev_b32 v6, 4, v6
    v_xor_b32 v6, v6, v7
    v_subrev_u32 v13, 1024, v6
    v_add_u32 v6, s35, v2
    v_add_u32 v6, 384, v6
    v_mul_u32_u24 v7, 9363, v6
    v_lshrrev_b32 v7, 20, v7
    v_and_b32 v7, 3, v7
    v_lshlrev_b32 v7, 5, v7
    v_lshlrev_b32 v6, 4, v6
    v_xor_b32 v6, v6, v7
    v_subrev_u32 v14, 2048, v6
    s_mul_i32 s37, s28, 512*896
    s_mul_i32 s45, s30, 7168
    ds_read_b128 a[220:223], v241 offset:57344
    s_waitcnt lgkmcnt(4)
    v_mfma_f32_16x16x32_bf16 v[64:67], a[192:195], v[128:131], v[112:115]
    v_exp_f32 v32, v32
    v_mfma_f32_16x16x32_bf16 v[68:71], a[192:195], v[132:135], v[116:119]
    ds_read_b128 a[224:227], v242 offset:32768
    v_mfma_f32_16x16x32_bf16 v[76:79], a[196:199], v[132:135], v[116:119]
    v_exp_f32 v33, v33
    v_mfma_f32_16x16x32_bf16 v[72:75], a[196:199], v[128:131], v[112:115]
    ds_read_b128 a[228:231], v242 offset:40960
    v_mfma_f32_16x16x32_bf16 v[80:83], a[200:203], v[128:131], v[112:115]
    v_exp_f32 v34, v34
    v_mfma_f32_16x16x32_bf16 v[84:87], a[200:203], v[132:135], v[116:119]
    ds_read_b128 a[232:235], v242 offset:49152
    v_cvt_pk_bf16_f32 v96, v32, v33
    v_mfma_f32_16x16x32_bf16 v[92:95], a[204:207], v[132:135], v[116:119]
    v_mfma_f32_16x16x32_bf16 v[88:91], a[204:207], v[128:131], v[112:115]
    ds_read_b128 a[236:239], v242 offset:57344
    s_waitcnt lgkmcnt(4)
    v_mfma_f32_16x16x32_bf16 v[64:67], a[208:211], v[136:139], v[64:67]
    v_exp_f32 v35, v35
    v_mfma_f32_16x16x32_bf16 v[68:71], a[208:211], v[140:143], v[68:71]
    ds_read_b128 a[240:243], v243 offset:32768
    v_mfma_f32_16x16x32_bf16 v[76:79], a[212:215], v[140:143], v[76:79]
    s_waitcnt vmcnt(8)
    s_barrier
    v_mfma_f32_16x16x32_bf16 v[72:75], a[212:215], v[136:139], v[72:75]
    ds_read_b128 a[244:247], v243 offset:40960
    v_exp_f32 v36, v36
    v_mfma_f32_16x16x32_bf16 v[80:83], a[216:219], v[136:139], v[80:83]
    s_add_u32 m0, s44, 98304
    s_add_u32 s36, s34, 4096
    v_cvt_pk_bf16_f32 v97, v34, v35
    v_mfma_f32_16x16x32_bf16 v[84:87], a[216:219], v[140:143], v[84:87]
    ds_read_b128 a[248:251], v243 offset:49152
    buffer_load_dwordx4 v120, s[12:15], s34 offen offset:0 lds
    v_mfma_f32_16x16x32_bf16 v[92:95], a[220:223], v[140:143], v[92:95]
    v_exp_f32 v37, v37
    v_mfma_f32_16x16x32_bf16 v[88:91], a[220:223], v[136:139], v[88:91]
    ds_read_b128 a[252:255], v243 offset:57344
    s_waitcnt lgkmcnt(4)
    v_mfma_f32_16x16x32_bf16 v[64:67], a[224:227], v[144:147], v[64:67]
    v_exp_f32 v38, v38
    v_mfma_f32_16x16x32_bf16 v[68:71], a[224:227], v[148:151], v[68:71]
    ds_read_b128 a[192:195], v240 offset:33024
    v_cvt_pk_bf16_f32 v100, v36, v37
    v_mfma_f32_16x16x32_bf16 v[76:79], a[228:231], v[148:151], v[76:79]
    v_exp_f32 v39, v39
    v_mfma_f32_16x16x32_bf16 v[72:75], a[228:231], v[144:147], v[72:75]
    ds_read_b128 a[196:199], v240 offset:41216
    buffer_load_dwordx4 v121, s[12:15], s34 offen offset:1024 lds
    v_mfma_f32_16x16x32_bf16 v[80:83], a[232:235], v[144:147], v[80:83]
    v_mfma_f32_16x16x32_bf16 v[84:87], a[232:235], v[148:151], v[84:87]
    ds_read_b128 a[200:203], v240 offset:49408
    v_mfma_f32_16x16x32_bf16 v[92:95], a[236:239], v[148:151], v[92:95]
    v_exp_f32 v40, v40
    v_mfma_f32_16x16x32_bf16 v[88:91], a[236:239], v[144:147], v[88:91]
    ds_read_b128 a[204:207], v240 offset:57600
    s_waitcnt lgkmcnt(4)
    v_mfma_f32_16x16x32_bf16 v[64:67], a[240:243], v[152:155], v[64:67]
    v_cvt_pk_bf16_f32 v101, v38, v39
    v_mfma_f32_16x16x32_bf16 v[68:71], a[240:243], v[156:159], v[68:71]
    ds_read_b128 a[208:211], v241 offset:33024
    buffer_load_dwordx4 v122, s[12:15], s34 offen offset:2048 lds
    v_mfma_f32_16x16x32_bf16 v[76:79], a[244:247], v[156:159], v[76:79]
    v_exp_f32 v41, v41
    v_mfma_f32_16x16x32_bf16 v[72:75], a[244:247], v[152:155], v[72:75]
    ds_read_b128 a[212:215], v241 offset:41216
    v_mfma_f32_16x16x32_bf16 v[80:83], a[248:251], v[152:155], v[80:83]
    v_exp_f32 v42, v42
    v_mfma_f32_16x16x32_bf16 v[84:87], a[248:251], v[156:159], v[84:87]
    ds_read_b128 a[216:219], v241 offset:49408
    v_cvt_pk_bf16_f32 v98, v40, v41
    v_mfma_f32_16x16x32_bf16 v[92:95], a[252:255], v[156:159], v[92:95]
    v_exp_f32 v43, v43
    v_mfma_f32_16x16x32_bf16 v[88:91], a[252:255], v[152:155], v[88:91]
    ds_read_b128 a[220:223], v241 offset:57600
    buffer_load_dwordx4 v123, s[12:15], s34 offen offset:3072 lds
    s_waitcnt lgkmcnt(4)
    v_mfma_f32_16x16x32_bf16 v[64:67], a[192:195], v[160:163], v[64:67]
    v_exp_f32 v44, v44
    v_mfma_f32_16x16x32_bf16 v[68:71], a[192:195], v[164:167], v[68:71]
    ds_read_b128 a[224:227], v242 offset:33024
    v_cvt_pk_bf16_f32 v99, v42, v43
    v_mfma_f32_16x16x32_bf16 v[76:79], a[196:199], v[164:167], v[76:79]
    v_exp_f32 v45, v45
    v_mfma_f32_16x16x32_bf16 v[72:75], a[196:199], v[160:163], v[72:75]
    ds_read_b128 a[228:231], v242 offset:41216
    v_mfma_f32_16x16x32_bf16 v[80:83], a[200:203], v[160:163], v[80:83]
    s_add_u32 m0, s44, 102400
    s_add_u32 s34, s34, 32768
    v_mfma_f32_16x16x32_bf16 v[84:87], a[200:203], v[164:167], v[84:87]
    ds_read_b128 a[232:235], v242 offset:49408
    buffer_load_dwordx4 v120, s[12:15], s36 offen offset:0 lds
    v_mfma_f32_16x16x32_bf16 v[92:95], a[204:207], v[164:167], v[92:95]
    v_exp_f32 v46, v46
    v_mfma_f32_16x16x32_bf16 v[88:91], a[204:207], v[160:163], v[88:91]
    ds_read_b128 a[236:239], v242 offset:57600
    s_waitcnt lgkmcnt(4)
    v_mfma_f32_16x16x32_bf16 v[64:67], a[208:211], v[168:171], v[64:67]
    v_cvt_pk_bf16_f32 v102, v44, v45
    v_mfma_f32_16x16x32_bf16 v[68:71], a[208:211], v[172:175], v[68:71]
    ds_read_b128 a[240:243], v243 offset:33024
    v_mfma_f32_16x16x32_bf16 v[76:79], a[212:215], v[172:175], v[76:79]
    v_exp_f32 v47, v47
    v_mfma_f32_16x16x32_bf16 v[72:75], a[212:215], v[168:171], v[72:75]
    ds_read_b128 a[244:247], v243 offset:41216
    buffer_load_dwordx4 v121, s[12:15], s36 offen offset:1024 lds
    v_mfma_f32_16x16x32_bf16 v[80:83], a[216:219], v[168:171], v[80:83]
    v_exp_f32 v48, v48
    v_mfma_f32_16x16x32_bf16 v[84:87], a[216:219], v[172:175], v[84:87]
    ds_read_b128 a[248:251], v243 offset:49408
    v_cvt_pk_bf16_f32 v103, v46, v47
    v_mfma_f32_16x16x32_bf16 v[92:95], a[220:223], v[172:175], v[92:95]
    v_exp_f32 v49, v49
    v_mfma_f32_16x16x32_bf16 v[88:91], a[220:223], v[168:171], v[88:91]
    ds_read_b128 a[252:255], v243 offset:57600
    s_waitcnt lgkmcnt(4)
    v_mfma_f32_16x16x32_bf16 v[64:67], a[224:227], v[176:179], v[64:67]
    v_exp_f32 v50, v50
    v_mfma_f32_16x16x32_bf16 v[68:71], a[224:227], v[180:183], v[68:71]
    ds_read_b64_tr_b16 a[192:193], v244 offset:0
    buffer_load_dwordx4 v122, s[12:15], s36 offen offset:2048 lds
    v_mfma_f32_16x16x32_bf16 v[76:79], a[228:231], v[180:183], v[76:79]
    ds_read_b64_tr_b16 a[194:195], v244 offset:8192
    v_cvt_pk_bf16_f32 v104, v48, v49
    v_mfma_f32_16x16x32_bf16 v[72:75], a[228:231], v[176:179], v[72:75]
    ds_read_b64_tr_b16 a[196:197], v245 offset:0
    v_exp_f32 v51, v51
    v_mfma_f32_16x16x32_bf16 v[80:83], a[232:235], v[176:179], v[80:83]
    ds_read_b64_tr_b16 a[198:199], v245 offset:8192
    v_mfma_f32_16x16x32_bf16 v[84:87], a[232:235], v[180:183], v[84:87]
    ds_read_b64_tr_b16 a[200:201], v246 offset:0
    v_mfma_f32_16x16x32_bf16 v[92:95], a[236:239], v[180:183], v[92:95]
    ds_read_b64_tr_b16 a[202:203], v246 offset:8192
    v_exp_f32 v52, v52
    v_mfma_f32_16x16x32_bf16 v[88:91], a[236:239], v[176:179], v[88:91]
    ds_read_b64_tr_b16 a[204:205], v247 offset:0
    buffer_load_dwordx4 v123, s[12:15], s36 offen offset:3072 lds
    s_waitcnt lgkmcnt(7)
    v_mfma_f32_16x16x32_bf16 v[64:67], a[240:243], v[184:187], v[64:67]
    ds_read_b64_tr_b16 a[206:207], v247 offset:8192
    v_cvt_pk_bf16_f32 v105, v50, v51
    v_mfma_f32_16x16x32_bf16 v[68:71], a[240:243], v[188:191], v[68:71]
    ds_read_b64_tr_b16 a[208:209], v248 offset:0
    v_exp_f32 v53, v53
    v_mfma_f32_16x16x32_bf16 v[76:79], a[244:247], v[188:191], v[76:79]
    ds_read_b64_tr_b16 a[210:211], v248 offset:8192
    v_mfma_f32_16x16x32_bf16 v[72:75], a[244:247], v[184:187], v[72:75]
    ds_read_b64_tr_b16 a[212:213], v249 offset:0
    v_exp_f32 v54, v54
    v_mfma_f32_16x16x32_bf16 v[80:83], a[248:251], v[184:187], v[80:83]
    ds_read_b64_tr_b16 a[214:215], v249 offset:8192
    v_cvt_pk_bf16_f32 v108, v52, v53
    v_mfma_f32_16x16x32_bf16 v[84:87], a[248:251], v[188:191], v[84:87]
    ds_read_b64_tr_b16 a[216:217], v250 offset:0
    v_mfma_f32_16x16x32_bf16 v[92:95], a[252:255], v[188:191], v[92:95]
    ds_read_b64_tr_b16 a[218:219], v250 offset:8192
    v_exp_f32 v55, v55
    v_mfma_f32_16x16x32_bf16 v[88:91], a[252:255], v[184:187], v[88:91]
    ds_read_b64_tr_b16 a[220:221], v251 offset:0
    s_waitcnt lgkmcnt(7)
    v_mfma_f32_16x16x32_bf16 a[0:3], a[192:195], v[96:99], a[0:3]
    ds_read_b64_tr_b16 a[222:223], v251 offset:8192
    v_mfma_f32_16x16x32_bf16 a[4:7], a[192:195], v[100:103], a[4:7]
    ds_read_b64_tr_b16 a[224:225], v244 offset:256
    v_exp_f32 v56, v56
    v_mfma_f32_16x16x32_bf16 a[12:15], a[196:199], v[100:103], a[12:15]
    ds_read_b64_tr_b16 a[226:227], v244 offset:8448
    v_mfma_f32_16x16x32_bf16 v[124:127], v[252:255], v[96:99], v[124:127]
    v_mfma_f32_16x16x32_bf16 a[8:11], a[196:199], v[96:99], a[8:11]
    ds_read_b64_tr_b16 a[228:229], v245 offset:256
    v_cvt_pk_bf16_f32 v109, v54, v55
    v_mfma_f32_16x16x32_bf16 a[16:19], a[200:203], v[96:99], a[16:19]
    ds_read_b64_tr_b16 a[230:231], v245 offset:8448
    v_mfma_f32_16x16x32_bf16 v[16:19], v[252:255], v[100:103], v[16:19]
    v_mfma_f32_16x16x32_bf16 a[20:23], a[200:203], v[100:103], a[20:23]
    ds_read_b64_tr_b16 a[232:233], v246 offset:256
    v_exp_f32 v57, v57
    v_mfma_f32_16x16x32_bf16 a[28:31], a[204:207], v[100:103], a[28:31]
    ds_read_b64_tr_b16 a[234:235], v246 offset:8448
    v_exp_f32 v58, v58
    v_mfma_f32_16x16x32_bf16 a[24:27], a[204:207], v[96:99], a[24:27]
    ds_read_b64_tr_b16 a[236:237], v247 offset:256
    s_waitcnt lgkmcnt(7)
    v_mfma_f32_16x16x32_bf16 a[32:35], a[208:211], v[96:99], a[32:35]
    ds_read_b64_tr_b16 a[238:239], v247 offset:8448
    v_cvt_pk_bf16_f32 v106, v56, v57
    v_mfma_f32_16x16x32_bf16 a[36:39], a[208:211], v[100:103], a[36:39]
    ds_read_b64_tr_b16 a[240:241], v248 offset:256
    v_exp_f32 v59, v59
    v_mfma_f32_16x16x32_bf16 a[44:47], a[212:215], v[100:103], a[44:47]
    ds_read_b64_tr_b16 a[242:243], v248 offset:8448
    v_mfma_f32_16x16x32_bf16 a[40:43], a[212:215], v[96:99], a[40:43]
    ds_read_b64_tr_b16 a[244:245], v249 offset:256
    v_mfma_f32_16x16x32_bf16 a[48:51], a[216:219], v[96:99], a[48:51]
    ds_read_b64_tr_b16 a[246:247], v249 offset:8448
    v_exp_f32 v60, v60
    v_mfma_f32_16x16x32_bf16 a[52:55], a[216:219], v[100:103], a[52:55]
    ds_read_b64_tr_b16 a[248:249], v250 offset:256
    v_cvt_pk_bf16_f32 v107, v58, v59
    v_mfma_f32_16x16x32_bf16 a[60:63], a[220:223], v[100:103], a[60:63]
    ds_read_b64_tr_b16 a[250:251], v250 offset:8448
    v_exp_f32 v61, v61
    v_mfma_f32_16x16x32_bf16 a[56:59], a[220:223], v[96:99], a[56:59]
    ds_read_b64_tr_b16 a[252:253], v251 offset:256
    s_waitcnt lgkmcnt(7)
    v_mfma_f32_16x16x32_bf16 a[64:67], a[224:227], v[96:99], a[64:67]
    ds_read_b64_tr_b16 a[254:255], v251 offset:8448
    v_mfma_f32_16x16x32_bf16 a[68:71], a[224:227], v[100:103], a[68:71]
    ds_read_b64_tr_b16 a[192:193], v244 offset:16384
    v_exp_f32 v62, v62
    v_mfma_f32_16x16x32_bf16 a[76:79], a[228:231], v[100:103], a[76:79]
    ds_read_b64_tr_b16 a[194:195], v244 offset:24576
    v_cvt_pk_bf16_f32 v110, v60, v61
    v_mfma_f32_16x16x32_bf16 a[72:75], a[228:231], v[96:99], a[72:75]
    ds_read_b64_tr_b16 a[196:197], v245 offset:16384
    v_mfma_f32_16x16x32_bf16 a[80:83], a[232:235], v[96:99], a[80:83]
    ds_read_b64_tr_b16 a[198:199], v245 offset:24576
    v_exp_f32 v63, v63
    v_mfma_f32_16x16x32_bf16 a[84:87], a[232:235], v[100:103], a[84:87]
    ds_read_b64_tr_b16 a[200:201], v246 offset:16384
    s_nop 0
    v_mfma_f32_16x16x32_bf16 a[92:95], a[236:239], v[100:103], a[92:95]
    ds_read_b64_tr_b16 a[202:203], v246 offset:24576
    v_cvt_pk_bf16_f32 v111, v62, v63
    v_mfma_f32_16x16x32_bf16 a[88:91], a[236:239], v[96:99], a[88:91]
    ds_read_b64_tr_b16 a[204:205], v247 offset:16384
    s_waitcnt lgkmcnt(7)
    v_mfma_f32_16x16x32_bf16 a[96:99], a[240:243], v[96:99], a[96:99]
    ds_read_b64_tr_b16 a[206:207], v247 offset:24576
    v_max3_f32 v22, v64, v65, v66
    v_mfma_f32_16x16x32_bf16 a[100:103], a[240:243], v[100:103], a[100:103]
    ds_read_b64_tr_b16 a[208:209], v248 offset:16384
    v_max3_f32 v23, v68, v69, v70
    v_mfma_f32_16x16x32_bf16 a[108:111], a[244:247], v[100:103], a[108:111]
    ds_read_b64_tr_b16 a[210:211], v248 offset:24576
    v_max3_f32 v22, v22, v67, v72
    v_mfma_f32_16x16x32_bf16 a[104:107], a[244:247], v[96:99], a[104:107]
    ds_read_b64_tr_b16 a[212:213], v249 offset:16384
    v_max3_f32 v23, v23, v71, v76
    v_mfma_f32_16x16x32_bf16 a[112:115], a[248:251], v[96:99], a[112:115]
    ds_read_b64_tr_b16 a[214:215], v249 offset:24576
    v_max3_f32 v22, v22, v73, v74
    v_mfma_f32_16x16x32_bf16 a[116:119], a[248:251], v[100:103], a[116:119]
    ds_read_b64_tr_b16 a[216:217], v250 offset:16384
    v_max3_f32 v23, v23, v77, v78
    v_mfma_f32_16x16x32_bf16 a[124:127], a[252:255], v[100:103], a[124:127]
    ds_read_b64_tr_b16 a[218:219], v250 offset:24576
    v_max3_f32 v22, v22, v75, v80
    v_mfma_f32_16x16x32_bf16 a[120:123], a[252:255], v[96:99], a[120:123]
    ds_read_b64_tr_b16 a[220:221], v251 offset:16384
    s_waitcnt lgkmcnt(7)
    v_mfma_f32_16x16x32_bf16 a[0:3], a[192:195], v[104:107], a[0:3]
    ds_read_b64_tr_b16 a[222:223], v251 offset:24576
    v_max3_f32 v23, v23, v79, v84
    v_mfma_f32_16x16x32_bf16 a[4:7], a[192:195], v[108:111], a[4:7]
    ds_read_b64_tr_b16 a[224:225], v244 offset:16640
    v_max3_f32 v22, v22, v81, v82
    v_mfma_f32_16x16x32_bf16 a[12:15], a[196:199], v[108:111], a[12:15]
    ds_read_b64_tr_b16 a[226:227], v244 offset:24832
    v_mfma_f32_16x16x32_bf16 v[124:127], v[252:255], v[104:107], v[124:127]
    v_mfma_f32_16x16x32_bf16 a[8:11], a[196:199], v[104:107], a[8:11]
    ds_read_b64_tr_b16 a[228:229], v245 offset:16640
    v_max3_f32 v23, v23, v85, v86
    v_mfma_f32_16x16x32_bf16 a[16:19], a[200:203], v[104:107], a[16:19]
    ds_read_b64_tr_b16 a[230:231], v245 offset:24832
    v_mfma_f32_16x16x32_bf16 v[16:19], v[252:255], v[108:111], v[16:19]
    v_mfma_f32_16x16x32_bf16 a[20:23], a[200:203], v[108:111], a[20:23]
    ds_read_b64_tr_b16 a[232:233], v246 offset:16640
    v_max3_f32 v22, v22, v83, v88
    v_mfma_f32_16x16x32_bf16 a[28:31], a[204:207], v[108:111], a[28:31]
    ds_read_b64_tr_b16 a[234:235], v246 offset:24832
    v_max3_f32 v23, v23, v87, v92
    v_mfma_f32_16x16x32_bf16 a[24:27], a[204:207], v[104:107], a[24:27]
    ds_read_b64_tr_b16 a[236:237], v247 offset:16640
    s_waitcnt lgkmcnt(7)
    v_mfma_f32_16x16x32_bf16 a[32:35], a[208:211], v[104:107], a[32:35]
    ds_read_b64_tr_b16 a[238:239], v247 offset:24832
    v_max3_f32 v22, v22, v89, v90
    v_mfma_f32_16x16x32_bf16 a[36:39], a[208:211], v[108:111], a[36:39]
    ds_read_b64_tr_b16 a[240:241], v248 offset:16640
    v_max3_f32 v23, v23, v93, v94
    v_mfma_f32_16x16x32_bf16 a[44:47], a[212:215], v[108:111], a[44:47]
    ds_read_b64_tr_b16 a[242:243], v248 offset:24832
    v_max_f32 v22, v22, v91
    v_mfma_f32_16x16x32_bf16 a[40:43], a[212:215], v[104:107], a[40:43]
    ds_read_b64_tr_b16 a[244:245], v249 offset:16640
    v_mfma_f32_16x16x32_bf16 a[48:51], a[216:219], v[104:107], a[48:51]
    ds_read_b64_tr_b16 a[246:247], v249 offset:24832
    v_mfma_f32_16x16x32_bf16 a[52:55], a[216:219], v[108:111], a[52:55]
    ds_read_b64_tr_b16 a[248:249], v250 offset:16640
    v_max_f32 v23, v23, v95
    v_mfma_f32_16x16x32_bf16 a[60:63], a[220:223], v[108:111], a[60:63]
    ds_read_b64_tr_b16 a[250:251], v250 offset:24832
    v_mfma_f32_16x16x32_bf16 a[56:59], a[220:223], v[104:107], a[56:59]
    ds_read_b64_tr_b16 a[252:253], v251 offset:16640
    s_waitcnt lgkmcnt(7)
    v_mfma_f32_16x16x32_bf16 a[64:67], a[224:227], v[104:107], a[64:67]
    ds_read_b64_tr_b16 a[254:255], v251 offset:24832
    v_max_f32 v24, v22, v23
    v_mfma_f32_16x16x32_bf16 a[68:71], a[224:227], v[108:111], a[68:71]
    v_mfma_f32_16x16x32_bf16 a[76:79], a[228:231], v[108:111], a[76:79]
    v_cmp_lt_f32 vcc, s41, v24
    v_mfma_f32_16x16x32_bf16 a[72:75], a[228:231], v[104:107], a[72:75]
    v_mfma_f32_16x16x32_bf16 a[80:83], a[232:235], v[104:107], a[80:83]
    v_mfma_f32_16x16x32_bf16 a[84:87], a[232:235], v[108:111], a[84:87]
    v_mfma_f32_16x16x32_bf16 a[92:95], a[236:239], v[108:111], a[92:95]
    v_mfma_f32_16x16x32_bf16 a[88:91], a[236:239], v[104:107], a[88:91]
    s_waitcnt lgkmcnt(0)
    v_mfma_f32_16x16x32_bf16 a[96:99], a[240:243], v[104:107], a[96:99]
    v_mfma_f32_16x16x32_bf16 a[100:103], a[240:243], v[108:111], a[100:103]
    v_mfma_f32_16x16x32_bf16 a[108:111], a[244:247], v[108:111], a[108:111]
    v_mfma_f32_16x16x32_bf16 a[104:107], a[244:247], v[104:107], a[104:107]
    v_mfma_f32_16x16x32_bf16 a[112:115], a[248:251], v[104:107], a[112:115]
    v_mfma_f32_16x16x32_bf16 a[116:119], a[248:251], v[108:111], a[116:119]
    v_mfma_f32_16x16x32_bf16 a[124:127], a[252:255], v[108:111], a[124:127]
    v_mfma_f32_16x16x32_bf16 a[120:123], a[252:255], v[104:107], a[120:123]
    s_cbranch_vccnz SLOW_30_0
BACK_30_0:
    v_exp_f32 v64, v64
    v_exp_f32 v65, v65
    v_exp_f32 v66, v66
    v_cvt_pk_bf16_f32 v96, v64, v65
    v_exp_f32 v67, v67
    v_exp_f32 v68, v68
    v_cvt_pk_bf16_f32 v97, v66, v67
    v_exp_f32 v69, v69
    v_exp_f32 v70, v70
    v_cvt_pk_bf16_f32 v100, v68, v69
    v_exp_f32 v71, v71
    v_exp_f32 v72, v72
    v_cvt_pk_bf16_f32 v101, v70, v71
    v_exp_f32 v73, v73
    v_exp_f32 v74, v74
    v_cvt_pk_bf16_f32 v98, v72, v73
    v_exp_f32 v75, v75
    v_exp_f32 v76, v76
    v_cvt_pk_bf16_f32 v99, v74, v75
    v_exp_f32 v77, v77
    s_waitcnt vmcnt(0)
    s_barrier
    s_add_u32 m0, s45, 0
    s_nop 0
    buffer_load_dwordx4 v8, s[20:23], s37 offen offset:0 lds
    buffer_load_dwordx4 v9, s[20:23], s37 offen offset:1024 lds
    buffer_load_dwordx4 v10, s[20:23], s37 offen offset:2048 lds
    buffer_load_dwordx4 v11, s[20:23], s37 offen offset:3072 lds
    s_add_u32 m0, s45, 4096
    s_nop 0
    buffer_load_dwordx4 v12, s[20:23], s37 offen offset:0 lds
    buffer_load_dwordx4 v13, s[20:23], s37 offen offset:1024 lds
    buffer_load_dwordx4 v14, s[20:23], s37 offen offset:2048 lds
    s_add_u32 s37, s37, 28672
    s_add_u32 m0, s45, 32768
    s_nop 0
    buffer_load_dwordx4 v8, s[20:23], s37 offen offset:0 lds
    buffer_load_dwordx4 v9, s[20:23], s37 offen offset:1024 lds
    buffer_load_dwordx4 v10, s[20:23], s37 offen offset:2048 lds
    buffer_load_dwordx4 v11, s[20:23], s37 offen offset:3072 lds
    s_add_u32 m0, s45, 36864
    s_nop 0
    buffer_load_dwordx4 v12, s[20:23], s37 offen offset:0 lds
    buffer_load_dwordx4 v13, s[20:23], s37 offen offset:1024 lds
    buffer_load_dwordx4 v14, s[20:23], s37 offen offset:2048 lds
    s_add_u32 s37, s37, 28672
    s_add_u32 m0, s45, 131072
    s_nop 0
    buffer_load_dwordx4 v8, s[20:23], s37 offen offset:0 lds
    buffer_load_dwordx4 v9, s[20:23], s37 offen offset:1024 lds
    buffer_load_dwordx4 v10, s[20:23], s37 offen offset:2048 lds
    buffer_load_dwordx4 v11, s[20:23], s37 offen offset:3072 lds
    s_add_u32 m0, s45, 135168
    s_nop 0
    buffer_load_dwordx4 v12, s[20:23], s37 offen offset:0 lds
    buffer_load_dwordx4 v13, s[20:23], s37 offen offset:1024 lds
    buffer_load_dwordx4 v14, s[20:23], s37 offen offset:2048 lds
    s_add_u32 s37, s37, 28672
    v_exp_f32 v78, v78
    v_cvt_pk_bf16_f32 v102, v76, v77
    v_exp_f32 v79, v79
    v_exp_f32 v80, v80
    v_cvt_pk_bf16_f32 v103, v78, v79
    ds_read_b64_tr_b16 a[192:193], v244 offset:32768
    ds_read_b64_tr_b16 a[194:195], v244 offset:40960
    ds_read_b64_tr_b16 a[196:197], v245 offset:32768
    ds_read_b64_tr_b16 a[198:199], v245 offset:40960
    ds_read_b64_tr_b16 a[200:201], v246 offset:32768
    ds_read_b64_tr_b16 a[202:203], v246 offset:40960
    ds_read_b64_tr_b16 a[204:205], v247 offset:32768
    ds_read_b64_tr_b16 a[206:207], v247 offset:40960
    ds_read_b64_tr_b16 a[208:209], v248 offset:32768
    ds_read_b64_tr_b16 a[210:211], v248 offset:40960
    ds_read_b64_tr_b16 a[212:213], v249 offset:32768
    ds_read_b64_tr_b16 a[214:215], v249 offset:40960
    ds_read_b64_tr_b16 a[216:217], v250 offset:32768
    ds_read_b64_tr_b16 a[218:219], v250 offset:40960
    ds_read_b64_tr_b16 a[220:221], v251 offset:32768
    s_waitcnt lgkmcnt(7)
    v_mfma_f32_16x16x32_bf16 a[0:3], a[192:195], v[96:99], a[0:3]
    ds_read_b64_tr_b16 a[222:223], v251 offset:40960
    v_exp_f32 v81, v81
    v_mfma_f32_16x16x32_bf16 a[4:7], a[192:195], v[100:103], a[4:7]
    ds_read_b64_tr_b16 a[224:225], v244 offset:33024
    v_exp_f32 v82, v82
    v_mfma_f32_16x16x32_bf16 a[12:15], a[196:199], v[100:103], a[12:15]
    ds_read_b64_tr_b16 a[226:227], v244 offset:41216
    v_mfma_f32_16x16x32_bf16 v[124:127], v[252:255], v[96:99], v[124:127]
    v_mfma_f32_16x16x32_bf16 a[8:11], a[196:199], v[96:99], a[8:11]
    ds_read_b64_tr_b16 a[228:229], v245 offset:33024
    v_cvt_pk_bf16_f32 v104, v80, v81
    v_mfma_f32_16x16x32_bf16 a[16:19], a[200:203], v[96:99], a[16:19]
    ds_read_b64_tr_b16 a[230:231], v245 offset:41216
    v_mfma_f32_16x16x32_bf16 v[16:19], v[252:255], v[100:103], v[16:19]
    v_mfma_f32_16x16x32_bf16 a[20:23], a[200:203], v[100:103], a[20:23]
    ds_read_b64_tr_b16 a[232:233], v246 offset:33024
    v_exp_f32 v83, v83
    v_mfma_f32_16x16x32_bf16 a[28:31], a[204:207], v[100:103], a[28:31]
    ds_read_b64_tr_b16 a[234:235], v246 offset:41216
    v_exp_f32 v84, v84
    v_mfma_f32_16x16x32_bf16 a[24:27], a[204:207], v[96:99], a[24:27]
    ds_read_b64_tr_b16 a[236:237], v247 offset:33024
    s_waitcnt lgkmcnt(7)
    v_mfma_f32_16x16x32_bf16 a[32:35], a[208:211], v[96:99], a[32:35]
    ds_read_b64_tr_b16 a[238:239], v247 offset:41216
    v_cvt_pk_bf16_f32 v105, v82, v83
    v_mfma_f32_16x16x32_bf16 a[36:39], a[208:211], v[100:103], a[36:39]
    ds_read_b64_tr_b16 a[240:241], v248 offset:33024
    v_exp_f32 v85, v85
    v_mfma_f32_16x16x32_bf16 a[44:47], a[212:215], v[100:103], a[44:47]
    ds_read_b64_tr_b16 a[242:243], v248 offset:41216
    v_exp_f32 v86, v86
    v_mfma_f32_16x16x32_bf16 a[40:43], a[212:215], v[96:99], a[40:43]
    ds_read_b64_tr_b16 a[244:245], v249 offset:33024
    v_cvt_pk_bf16_f32 v108, v84, v85
    v_mfma_f32_16x16x32_bf16 a[48:51], a[216:219], v[96:99], a[48:51]
    ds_read_b64_tr_b16 a[246:247], v249 offset:41216
    v_exp_f32 v87, v87
    v_mfma_f32_16x16x32_bf16 a[52:55], a[216:219], v[100:103], a[52:55]
    ds_read_b64_tr_b16 a[248:249], v250 offset:33024
    v_exp_f32 v88, v88
    v_mfma_f32_16x16x32_bf16 a[60:63], a[220:223], v[100:103], a[60:63]
    ds_read_b64_tr_b16 a[250:251], v250 offset:41216
    v_cvt_pk_bf16_f32 v109, v86, v87
    v_mfma_f32_16x16x32_bf16 a[56:59], a[220:223], v[96:99], a[56:59]
    ds_read_b64_tr_b16 a[252:253], v251 offset:33024
    s_waitcnt lgkmcnt(7)
    v_mfma_f32_16x16x32_bf16 a[64:67], a[224:227], v[96:99], a[64:67]
    ds_read_b64_tr_b16 a[254:255], v251 offset:41216
    v_exp_f32 v89, v89
    v_mfma_f32_16x16x32_bf16 a[68:71], a[224:227], v[100:103], a[68:71]
    ds_read_b64_tr_b16 a[192:193], v244 offset:49152
    v_exp_f32 v90, v90
    v_mfma_f32_16x16x32_bf16 a[76:79], a[228:231], v[100:103], a[76:79]
    ds_read_b64_tr_b16 a[194:195], v244 offset:57344
    v_cvt_pk_bf16_f32 v106, v88, v89
    v_mfma_f32_16x16x32_bf16 a[72:75], a[228:231], v[96:99], a[72:75]
    ds_read_b64_tr_b16 a[196:197], v245 offset:49152
    v_exp_f32 v91, v91
    v_mfma_f32_16x16x32_bf16 a[80:83], a[232:235], v[96:99], a[80:83]
    ds_read_b64_tr_b16 a[198:199], v245 offset:57344
    v_exp_f32 v92, v92
    v_mfma_f32_16x16x32_bf16 a[84:87], a[232:235], v[100:103], a[84:87]
    ds_read_b64_tr_b16 a[200:201], v246 offset:49152
    v_cvt_pk_bf16_f32 v107, v90, v91
    v_mfma_f32_16x16x32_bf16 a[92:95], a[236:239], v[100:103], a[92:95]
    ds_read_b64_tr_b16 a[202:203], v246 offset:57344
    v_exp_f32 v93, v93
    v_mfma_f32_16x16x32_bf16 a[88:91], a[236:239], v[96:99], a[88:91]
    ds_read_b64_tr_b16 a[204:205], v247 offset:49152
    s_waitcnt lgkmcnt(7)
    v_mfma_f32_16x16x32_bf16 a[96:99], a[240:243], v[96:99], a[96:99]
    ds_read_b64_tr_b16 a[206:207], v247 offset:57344
    v_exp_f32 v94, v94
    v_mfma_f32_16x16x32_bf16 a[100:103], a[240:243], v[100:103], a[100:103]
    ds_read_b64_tr_b16 a[208:209], v248 offset:49152
    v_cvt_pk_bf16_f32 v110, v92, v93
    v_mfma_f32_16x16x32_bf16 a[108:111], a[244:247], v[100:103], a[108:111]
    ds_read_b64_tr_b16 a[210:211], v248 offset:57344
    v_exp_f32 v95, v95
    v_mfma_f32_16x16x32_bf16 a[104:107], a[244:247], v[96:99], a[104:107]
    ds_read_b64_tr_b16 a[212:213], v249 offset:49152
    s_nop 0
    v_mfma_f32_16x16x32_bf16 a[112:115], a[248:251], v[96:99], a[112:115]
    ds_read_b64_tr_b16 a[214:215], v249 offset:57344
    v_cvt_pk_bf16_f32 v111, v94, v95
    v_mfma_f32_16x16x32_bf16 a[116:119], a[248:251], v[100:103], a[116:119]
    ds_read_b64_tr_b16 a[216:217], v250 offset:49152
    v_mfma_f32_16x16x32_bf16 a[124:127], a[252:255], v[100:103], a[124:127]
    ds_read_b64_tr_b16 a[218:219], v250 offset:57344
    v_mfma_f32_16x16x32_bf16 a[120:123], a[252:255], v[96:99], a[120:123]
    ds_read_b64_tr_b16 a[220:221], v251 offset:49152
    s_waitcnt lgkmcnt(7)
    v_mfma_f32_16x16x32_bf16 a[0:3], a[192:195], v[104:107], a[0:3]
    ds_read_b64_tr_b16 a[222:223], v251 offset:57344
    v_mfma_f32_16x16x32_bf16 a[4:7], a[192:195], v[108:111], a[4:7]
    ds_read_b64_tr_b16 a[224:225], v244 offset:49408
    v_mfma_f32_16x16x32_bf16 a[12:15], a[196:199], v[108:111], a[12:15]
    ds_read_b64_tr_b16 a[226:227], v244 offset:57600
    v_mfma_f32_16x16x32_bf16 v[124:127], v[252:255], v[104:107], v[124:127]
    v_mfma_f32_16x16x32_bf16 a[8:11], a[196:199], v[104:107], a[8:11]
    ds_read_b64_tr_b16 a[228:229], v245 offset:49408
    v_mfma_f32_16x16x32_bf16 a[16:19], a[200:203], v[104:107], a[16:19]
    ds_read_b64_tr_b16 a[230:231], v245 offset:57600
    v_mfma_f32_16x16x32_bf16 v[16:19], v[252:255], v[108:111], v[16:19]
    v_mfma_f32_16x16x32_bf16 a[20:23], a[200:203], v[108:111], a[20:23]
    ds_read_b64_tr_b16 a[232:233], v246 offset:49408
    v_mfma_f32_16x16x32_bf16 a[28:31], a[204:207], v[108:111], a[28:31]
    ds_read_b64_tr_b16 a[234:235], v246 offset:57600
    v_mfma_f32_16x16x32_bf16 a[24:27], a[204:207], v[104:107], a[24:27]
    ds_read_b64_tr_b16 a[236:237], v247 offset:49408
    s_waitcnt lgkmcnt(7)
    v_mfma_f32_16x16x32_bf16 a[32:35], a[208:211], v[104:107], a[32:35]
    ds_read_b64_tr_b16 a[238:239], v247 offset:57600
    v_mfma_f32_16x16x32_bf16 a[36:39], a[208:211], v[108:111], a[36:39]
    ds_read_b64_tr_b16 a[240:241], v248 offset:49408
    v_mfma_f32_16x16x32_bf16 a[44:47], a[212:215], v[108:111], a[44:47]
    ds_read_b64_tr_b16 a[242:243], v248 offset:57600
    v_mfma_f32_16x16x32_bf16 a[40:43], a[212:215], v[104:107], a[40:43]
    ds_read_b64_tr_b16 a[244:245], v249 offset:49408
    v_mfma_f32_16x16x32_bf16 a[48:51], a[216:219], v[104:107], a[48:51]
    ds_read_b64_tr_b16 a[246:247], v249 offset:57600
    v_mfma_f32_16x16x32_bf16 a[52:55], a[216:219], v[108:111], a[52:55]
    ds_read_b64_tr_b16 a[248:249], v250 offset:49408
    v_mfma_f32_16x16x32_bf16 a[60:63], a[220:223], v[108:111], a[60:63]
    ds_read_b64_tr_b16 a[250:251], v250 offset:57600
    v_mfma_f32_16x16x32_bf16 a[56:59], a[220:223], v[104:107], a[56:59]
    ds_read_b64_tr_b16 a[252:253], v251 offset:49408
    s_waitcnt lgkmcnt(7)
    v_mfma_f32_16x16x32_bf16 a[64:67], a[224:227], v[104:107], a[64:67]
    ds_read_b64_tr_b16 a[254:255], v251 offset:57600
    v_mfma_f32_16x16x32_bf16 a[68:71], a[224:227], v[108:111], a[68:71]
    v_mfma_f32_16x16x32_bf16 a[76:79], a[228:231], v[108:111], a[76:79]
    v_mfma_f32_16x16x32_bf16 a[72:75], a[228:231], v[104:107], a[72:75]
    v_mfma_f32_16x16x32_bf16 a[80:83], a[232:235], v[104:107], a[80:83]
    v_mfma_f32_16x16x32_bf16 a[84:87], a[232:235], v[108:111], a[84:87]
    v_mfma_f32_16x16x32_bf16 a[92:95], a[236:239], v[108:111], a[92:95]
    v_mfma_f32_16x16x32_bf16 a[88:91], a[236:239], v[104:107], a[88:91]
    s_waitcnt lgkmcnt(0)
    v_mfma_f32_16x16x32_bf16 a[96:99], a[240:243], v[104:107], a[96:99]
    v_mfma_f32_16x16x32_bf16 a[100:103], a[240:243], v[108:111], a[100:103]
    v_mfma_f32_16x16x32_bf16 a[108:111], a[244:247], v[108:111], a[108:111]
    v_mfma_f32_16x16x32_bf16 a[104:107], a[244:247], v[104:107], a[104:107]
    v_mfma_f32_16x16x32_bf16 a[112:115], a[248:251], v[104:107], a[112:115]
    v_mfma_f32_16x16x32_bf16 a[116:119], a[248:251], v[108:111], a[116:119]
    v_mfma_f32_16x16x32_bf16 a[124:127], a[252:255], v[108:111], a[124:127]
    v_mfma_f32_16x16x32_bf16 a[120:123], a[252:255], v[104:107], a[120:123]
    s_nop 7
    v_rcp_f32 v20, v124
    s_nop 7
    v_rcp_f32 v21, v16
    s_lshl_b32 s35, s30, 14
    s_add_u32 s35, s35, 65536
    v_lshlrev_b32 v6, 4, v2
    v_add_u32 v7, s35, v6
    s_lshl_b32 s35, s32, 15
    s_add_u32 s35, s35, 65536
    v_add_u32 v6, s35, v6
    s_nop 7
    s_barrier
    v_accvgpr_read_b32 v32, a0
    v_accvgpr_read_b32 v33, a1
    v_accvgpr_read_b32 v34, a2
    v_accvgpr_read_b32 v35, a3
    v_accvgpr_read_b32 v36, a8
    v_accvgpr_read_b32 v37, a9
    v_accvgpr_read_b32 v38, a10
    v_accvgpr_read_b32 v39, a11
    v_mul_f32 v32, v32, v20
    v_mul_f32 v33, v33, v20
    v_mul_f32 v34, v34, v20
    v_mul_f32 v35, v35, v20
    v_mul_f32 v36, v36, v20
    v_mul_f32 v37, v37, v20
    v_mul_f32 v38, v38, v20
    v_mul_f32 v39, v39, v20
    v_cvt_pk_bf16_f32 v40, v32, v33
    v_cvt_pk_bf16_f32 v41, v34, v35
    v_cvt_pk_bf16_f32 v42, v36, v37
    v_cvt_pk_bf16_f32 v43, v38, v39
    ds_write_b128 v7, v[40:43] offset:0
    v_accvgpr_read_b32 v44, a4
    v_accvgpr_read_b32 v45, a5
    v_accvgpr_read_b32 v46, a6
    v_accvgpr_read_b32 v47, a7
    v_accvgpr_read_b32 v48, a12
    v_accvgpr_read_b32 v49, a13
    v_accvgpr_read_b32 v50, a14
    v_accvgpr_read_b32 v51, a15
    v_mul_f32 v44, v44, v21
    v_mul_f32 v45, v45, v21
    v_mul_f32 v46, v46, v21
    v_mul_f32 v47, v47, v21
    v_mul_f32 v48, v48, v21
    v_mul_f32 v49, v49, v21
    v_mul_f32 v50, v50, v21
    v_mul_f32 v51, v51, v21
    v_cvt_pk_bf16_f32 v52, v44, v45
    v_cvt_pk_bf16_f32 v53, v46, v47
    v_cvt_pk_bf16_f32 v54, v48, v49
    v_cvt_pk_bf16_f32 v55, v50, v51
    ds_write_b128 v7, v[52:55] offset:1024
    v_accvgpr_read_b32 v32, a16
    v_accvgpr_read_b32 v33, a17
    v_accvgpr_read_b32 v34, a18
    v_accvgpr_read_b32 v35, a19
    v_accvgpr_read_b32 v36, a24
    v_accvgpr_read_b32 v37, a25
    v_accvgpr_read_b32 v38, a26
    v_accvgpr_read_b32 v39, a27
    v_mul_f32 v32, v32, v20
    v_mul_f32 v33, v33, v20
    v_mul_f32 v34, v34, v20
    v_mul_f32 v35, v35, v20
    v_mul_f32 v36, v36, v20
    v_mul_f32 v37, v37, v20
    v_mul_f32 v38, v38, v20
    v_mul_f32 v39, v39, v20
    v_cvt_pk_bf16_f32 v40, v32, v33
    v_cvt_pk_bf16_f32 v41, v34, v35
    v_cvt_pk_bf16_f32 v42, v36, v37
    v_cvt_pk_bf16_f32 v43, v38, v39
    ds_write_b128 v7, v[40:43] offset:2048
    v_accvgpr_read_b32 v44, a20
    v_accvgpr_read_b32 v45, a21
    v_accvgpr_read_b32 v46, a22
    v_accvgpr_read_b32 v47, a23
    v_accvgpr_read_b32 v48, a28
    v_accvgpr_read_b32 v49, a29
    v_accvgpr_read_b32 v50, a30
    v_accvgpr_read_b32 v51, a31
    v_mul_f32 v44, v44, v21
    v_mul_f32 v45, v45, v21
    v_mul_f32 v46, v46, v21
    v_mul_f32 v47, v47, v21
    v_mul_f32 v48, v48, v21
    v_mul_f32 v49, v49, v21
    v_mul_f32 v50, v50, v21
    v_mul_f32 v51, v51, v21
    v_cvt_pk_bf16_f32 v52, v44, v45
    v_cvt_pk_bf16_f32 v53, v46, v47
    v_cvt_pk_bf16_f32 v54, v48, v49
    v_cvt_pk_bf16_f32 v55, v50, v51
    ds_write_b128 v7, v[52:55] offset:3072
    v_accvgpr_read_b32 v32, a32
    v_accvgpr_read_b32 v33, a33
    v_accvgpr_read_b32 v34, a34
    v_accvgpr_read_b32 v35, a35
    v_accvgpr_read_b32 v36, a40
    v_accvgpr_read_b32 v37, a41
    v_accvgpr_read_b32 v38, a42
    v_accvgpr_read_b32 v39, a43
    v_mul_f32 v32, v32, v20
    v_mul_f32 v33, v33, v20
    v_mul_f32 v34, v34, v20
    v_mul_f32 v35, v35, v20
    v_mul_f32 v36, v36, v20
    v_mul_f32 v37, v37, v20
    v_mul_f32 v38, v38, v20
    v_mul_f32 v39, v39, v20
    v_cvt_pk_bf16_f32 v40, v32, v33
    v_cvt_pk_bf16_f32 v41, v34, v35
    v_cvt_pk_bf16_f32 v42, v36, v37
    v_cvt_pk_bf16_f32 v43, v38, v39
    ds_write_b128 v7, v[40:43] offset:4096
    v_accvgpr_read_b32 v44, a36
    v_accvgpr_read_b32 v45, a37
    v_accvgpr_read_b32 v46, a38
    v_accvgpr_read_b32 v47, a39
    v_accvgpr_read_b32 v48, a44
    v_accvgpr_read_b32 v49, a45
    v_accvgpr_read_b32 v50, a46
    v_accvgpr_read_b32 v51, a47
    v_mul_f32 v44, v44, v21
    v_mul_f32 v45, v45, v21
    v_mul_f32 v46, v46, v21
    v_mul_f32 v47, v47, v21
    v_mul_f32 v48, v48, v21
    v_mul_f32 v49, v49, v21
    v_mul_f32 v50, v50, v21
    v_mul_f32 v51, v51, v21
    v_cvt_pk_bf16_f32 v52, v44, v45
    v_cvt_pk_bf16_f32 v53, v46, v47
    v_cvt_pk_bf16_f32 v54, v48, v49
    v_cvt_pk_bf16_f32 v55, v50, v51
    ds_write_b128 v7, v[52:55] offset:5120
    v_accvgpr_read_b32 v32, a48
    v_accvgpr_read_b32 v33, a49
    v_accvgpr_read_b32 v34, a50
    v_accvgpr_read_b32 v35, a51
    v_accvgpr_read_b32 v36, a56
    v_accvgpr_read_b32 v37, a57
    v_accvgpr_read_b32 v38, a58
    v_accvgpr_read_b32 v39, a59
    v_mul_f32 v32, v32, v20
    v_mul_f32 v33, v33, v20
    v_mul_f32 v34, v34, v20
    v_mul_f32 v35, v35, v20
    v_mul_f32 v36, v36, v20
    v_mul_f32 v37, v37, v20
    v_mul_f32 v38, v38, v20
    v_mul_f32 v39, v39, v20
    v_cvt_pk_bf16_f32 v40, v32, v33
    v_cvt_pk_bf16_f32 v41, v34, v35
    v_cvt_pk_bf16_f32 v42, v36, v37
    v_cvt_pk_bf16_f32 v43, v38, v39
    ds_write_b128 v7, v[40:43] offset:6144
    v_accvgpr_read_b32 v44, a52
    v_accvgpr_read_b32 v45, a53
    v_accvgpr_read_b32 v46, a54
    v_accvgpr_read_b32 v47, a55
    v_accvgpr_read_b32 v48, a60
    v_accvgpr_read_b32 v49, a61
    v_accvgpr_read_b32 v50, a62
    v_accvgpr_read_b32 v51, a63
    v_mul_f32 v44, v44, v21
    v_mul_f32 v45, v45, v21
    v_mul_f32 v46, v46, v21
    v_mul_f32 v47, v47, v21
    v_mul_f32 v48, v48, v21
    v_mul_f32 v49, v49, v21
    v_mul_f32 v50, v50, v21
    v_mul_f32 v51, v51, v21
    v_cvt_pk_bf16_f32 v52, v44, v45
    v_cvt_pk_bf16_f32 v53, v46, v47
    v_cvt_pk_bf16_f32 v54, v48, v49
    v_cvt_pk_bf16_f32 v55, v50, v51
    ds_write_b128 v7, v[52:55] offset:7168
    v_accvgpr_read_b32 v32, a64
    v_accvgpr_read_b32 v33, a65
    v_accvgpr_read_b32 v34, a66
    v_accvgpr_read_b32 v35, a67
    v_accvgpr_read_b32 v36, a72
    v_accvgpr_read_b32 v37, a73
    v_accvgpr_read_b32 v38, a74
    v_accvgpr_read_b32 v39, a75
    v_mul_f32 v32, v32, v20
    v_mul_f32 v33, v33, v20
    v_mul_f32 v34, v34, v20
    v_mul_f32 v35, v35, v20
    v_mul_f32 v36, v36, v20
    v_mul_f32 v37, v37, v20
    v_mul_f32 v38, v38, v20
    v_mul_f32 v39, v39, v20
    v_cvt_pk_bf16_f32 v40, v32, v33
    v_cvt_pk_bf16_f32 v41, v34, v35
    v_cvt_pk_bf16_f32 v42, v36, v37
    v_cvt_pk_bf16_f32 v43, v38, v39
    ds_write_b128 v7, v[40:43] offset:8192
    v_accvgpr_read_b32 v44, a68
    v_accvgpr_read_b32 v45, a69
    v_accvgpr_read_b32 v46, a70
    v_accvgpr_read_b32 v47, a71
    v_accvgpr_read_b32 v48, a76
    v_accvgpr_read_b32 v49, a77
    v_accvgpr_read_b32 v50, a78
    v_accvgpr_read_b32 v51, a79
    v_mul_f32 v44, v44, v21
    v_mul_f32 v45, v45, v21
    v_mul_f32 v46, v46, v21
    v_mul_f32 v47, v47, v21
    v_mul_f32 v48, v48, v21
    v_mul_f32 v49, v49, v21
    v_mul_f32 v50, v50, v21
    v_mul_f32 v51, v51, v21
    v_cvt_pk_bf16_f32 v52, v44, v45
    v_cvt_pk_bf16_f32 v53, v46, v47
    v_cvt_pk_bf16_f32 v54, v48, v49
    v_cvt_pk_bf16_f32 v55, v50, v51
    ds_write_b128 v7, v[52:55] offset:9216
    v_accvgpr_read_b32 v32, a80
    v_accvgpr_read_b32 v33, a81
    v_accvgpr_read_b32 v34, a82
    v_accvgpr_read_b32 v35, a83
    v_accvgpr_read_b32 v36, a88
    v_accvgpr_read_b32 v37, a89
    v_accvgpr_read_b32 v38, a90
    v_accvgpr_read_b32 v39, a91
    v_mul_f32 v32, v32, v20
    v_mul_f32 v33, v33, v20
    v_mul_f32 v34, v34, v20
    v_mul_f32 v35, v35, v20
    v_mul_f32 v36, v36, v20
    v_mul_f32 v37, v37, v20
    v_mul_f32 v38, v38, v20
    v_mul_f32 v39, v39, v20
    v_cvt_pk_bf16_f32 v40, v32, v33
    v_cvt_pk_bf16_f32 v41, v34, v35
    v_cvt_pk_bf16_f32 v42, v36, v37
    v_cvt_pk_bf16_f32 v43, v38, v39
    ds_write_b128 v7, v[40:43] offset:10240
    v_accvgpr_read_b32 v44, a84
    v_accvgpr_read_b32 v45, a85
    v_accvgpr_read_b32 v46, a86
    v_accvgpr_read_b32 v47, a87
    v_accvgpr_read_b32 v48, a92
    v_accvgpr_read_b32 v49, a93
    v_accvgpr_read_b32 v50, a94
    v_accvgpr_read_b32 v51, a95
    v_mul_f32 v44, v44, v21
    v_mul_f32 v45, v45, v21
    v_mul_f32 v46, v46, v21
    v_mul_f32 v47, v47, v21
    v_mul_f32 v48, v48, v21
    v_mul_f32 v49, v49, v21
    v_mul_f32 v50, v50, v21
    v_mul_f32 v51, v51, v21
    v_cvt_pk_bf16_f32 v52, v44, v45
    v_cvt_pk_bf16_f32 v53, v46, v47
    v_cvt_pk_bf16_f32 v54, v48, v49
    v_cvt_pk_bf16_f32 v55, v50, v51
    ds_write_b128 v7, v[52:55] offset:11264
    v_accvgpr_read_b32 v32, a96
    v_accvgpr_read_b32 v33, a97
    v_accvgpr_read_b32 v34, a98
    v_accvgpr_read_b32 v35, a99
    v_accvgpr_read_b32 v36, a104
    v_accvgpr_read_b32 v37, a105
    v_accvgpr_read_b32 v38, a106
    v_accvgpr_read_b32 v39, a107
    v_mul_f32 v32, v32, v20
    v_mul_f32 v33, v33, v20
    v_mul_f32 v34, v34, v20
    v_mul_f32 v35, v35, v20
    v_mul_f32 v36, v36, v20
    v_mul_f32 v37, v37, v20
    v_mul_f32 v38, v38, v20
    v_mul_f32 v39, v39, v20
    v_cvt_pk_bf16_f32 v40, v32, v33
    v_cvt_pk_bf16_f32 v41, v34, v35
    v_cvt_pk_bf16_f32 v42, v36, v37
    v_cvt_pk_bf16_f32 v43, v38, v39
    ds_write_b128 v7, v[40:43] offset:12288
    v_accvgpr_read_b32 v44, a100
    v_accvgpr_read_b32 v45, a101
    v_accvgpr_read_b32 v46, a102
    v_accvgpr_read_b32 v47, a103
    v_accvgpr_read_b32 v48, a108
    v_accvgpr_read_b32 v49, a109
    v_accvgpr_read_b32 v50, a110
    v_accvgpr_read_b32 v51, a111
    v_mul_f32 v44, v44, v21
    v_mul_f32 v45, v45, v21
    v_mul_f32 v46, v46, v21
    v_mul_f32 v47, v47, v21
    v_mul_f32 v48, v48, v21
    v_mul_f32 v49, v49, v21
    v_mul_f32 v50, v50, v21
    v_mul_f32 v51, v51, v21
    v_cvt_pk_bf16_f32 v52, v44, v45
    v_cvt_pk_bf16_f32 v53, v46, v47
    v_cvt_pk_bf16_f32 v54, v48, v49
    v_cvt_pk_bf16_f32 v55, v50, v51
    ds_write_b128 v7, v[52:55] offset:13312
    v_accvgpr_read_b32 v32, a112
    v_accvgpr_read_b32 v33, a113
    v_accvgpr_read_b32 v34, a114
    v_accvgpr_read_b32 v35, a115
    v_accvgpr_read_b32 v36, a120
    v_accvgpr_read_b32 v37, a121
    v_accvgpr_read_b32 v38, a122
    v_accvgpr_read_b32 v39, a123
    v_mul_f32 v32, v32, v20
    v_mul_f32 v33, v33, v20
    v_mul_f32 v34, v34, v20
    v_mul_f32 v35, v35, v20
    v_mul_f32 v36, v36, v20
    v_mul_f32 v37, v37, v20
    v_mul_f32 v38, v38, v20
    v_mul_f32 v39, v39, v20
    v_cvt_pk_bf16_f32 v40, v32, v33
    v_cvt_pk_bf16_f32 v41, v34, v35
    v_cvt_pk_bf16_f32 v42, v36, v37
    v_cvt_pk_bf16_f32 v43, v38, v39
    ds_write_b128 v7, v[40:43] offset:14336
    v_accvgpr_read_b32 v44, a116
    v_accvgpr_read_b32 v45, a117
    v_accvgpr_read_b32 v46, a118
    v_accvgpr_read_b32 v47, a119
    v_accvgpr_read_b32 v48, a124
    v_accvgpr_read_b32 v49, a125
    v_accvgpr_read_b32 v50, a126
    v_accvgpr_read_b32 v51, a127
    v_mul_f32 v44, v44, v21
    v_mul_f32 v45, v45, v21
    v_mul_f32 v46, v46, v21
    v_mul_f32 v47, v47, v21
    v_mul_f32 v48, v48, v21
    v_mul_f32 v49, v49, v21
    v_mul_f32 v50, v50, v21
    v_mul_f32 v51, v51, v21
    v_cvt_pk_bf16_f32 v52, v44, v45
    v_cvt_pk_bf16_f32 v53, v46, v47
    v_cvt_pk_bf16_f32 v54, v48, v49
    v_cvt_pk_bf16_f32 v55, v50, v51
    ds_write_b128 v7, v[52:55] offset:15360
    v_bfe_u32 v28, v2, 2, 2
    v_and_b32 v29, 3, v2
    v_and_b32 v30, 1, v3
    v_lshl_add_u32 v30, v30, 2, v28
    v_lshrrev_b32 v30, 1, v30
    v_lshl_add_u32 v24, v3, 2, v28
    v_mul_u32_u24 v24, 896, v24
    v_lshl_add_u32 v24, v29, 3, v24
    s_mul_i32 s35, s31, 14
    s_add_u32 s36, s35, 0
    s_and_b32 s38, s36, 3
    s_lshr_b32 s36, s36, 2
    s_lshl_b32 s36, s36, 7
    v_xor_b32 v25, s38, v30
    v_lshl_add_u32 v25, v25, 5, v24
    v_add_u32 v240, s36, v25
    v_add_u32 v244, 65536, v240
    v_add_u32 v248, 131072, v240
    s_add_u32 s36, s35, 1
    s_and_b32 s38, s36, 3
    s_lshr_b32 s36, s36, 2
    s_lshl_b32 s36, s36, 7
    v_xor_b32 v25, s38, v30
    v_lshl_add_u32 v25, v25, 5, v24
    v_add_u32 v241, s36, v25
    v_add_u32 v245, 65536, v241
    v_add_u32 v249, 131072, v241
    s_add_u32 s36, s35, 2
    s_and_b32 s38, s36, 3
    s_lshr_b32 s36, s36, 2
    s_lshl_b32 s36, s36, 7
    v_xor_b32 v25, s38, v30
    v_lshl_add_u32 v25, v25, 5, v24
    v_add_u32 v242, s36, v25
    v_add_u32 v246, 65536, v242
    v_add_u32 v250, 131072, v242
    s_add_u32 s36, s35, 3
    s_and_b32 s38, s36, 3
    s_lshr_b32 s36, s36, 2
    s_lshl_b32 s36, s36, 7
    v_xor_b32 v25, s38, v30
    v_lshl_add_u32 v25, v25, 5, v24
    v_add_u32 v243, s36, v25
    v_add_u32 v247, 65536, v243
    v_add_u32 v251, 131072, v243
    s_waitcnt lgkmcnt(0) vmcnt(14)
    s_barrier
    ds_read_b128 a[0:3], v6 offset:0
    ds_read_b128 a[4:7], v6 offset:1024
    ds_read_b128 a[8:11], v6 offset:2048
    ds_read_b128 a[12:15], v6 offset:3072
    ds_read_b128 a[16:19], v6 offset:4096
    ds_read_b128 a[20:23], v6 offset:5120
    ds_read_b128 a[24:27], v6 offset:6144
    ds_read_b128 a[28:31], v6 offset:7168
    ds_read_b128 a[32:35], v6 offset:8192
    ds_read_b128 a[36:39], v6 offset:9216
    ds_read_b128 a[40:43], v6 offset:10240
    ds_read_b128 a[44:47], v6 offset:11264
    ds_read_b128 a[48:51], v6 offset:12288
    ds_read_b128 a[52:55], v6 offset:13312
    ds_read_b128 a[56:59], v6 offset:14336
    ds_read_b128 a[60:63], v6 offset:15360
    ds_read_b128 a[64:67], v6 offset:16384
    ds_read_b128 a[68:71], v6 offset:17408
    ds_read_b128 a[72:75], v6 offset:18432
    ds_read_b128 a[76:79], v6 offset:19456
    ds_read_b128 a[80:83], v6 offset:20480
    ds_read_b128 a[84:87], v6 offset:21504
    ds_read_b128 a[88:91], v6 offset:22528
    ds_read_b128 a[92:95], v6 offset:23552
    ds_read_b128 a[96:99], v6 offset:24576
    ds_read_b128 a[100:103], v6 offset:25600
    ds_read_b128 a[104:107], v6 offset:26624
    ds_read_b128 a[108:111], v6 offset:27648
    ds_read_b128 a[112:115], v6 offset:28672
    ds_read_b128 a[116:119], v6 offset:29696
    ds_read_b128 a[120:123], v6 offset:30720
    ds_read_b128 a[124:127], v6 offset:31744
    s_waitcnt lgkmcnt(0)
    ds_read_b64_tr_b16 a[192:193], v240 offset:0
    ds_read_b64_tr_b16 a[194:195], v240 offset:14336
    ds_read_b64_tr_b16 a[196:197], v241 offset:0
    ds_read_b64_tr_b16 a[198:199], v241 offset:14336
    ds_read_b64_tr_b16 a[200:201], v242 offset:0
    ds_read_b64_tr_b16 a[202:203], v242 offset:14336
    ds_read_b64_tr_b16 a[204:205], v243 offset:0
    ds_read_b64_tr_b16 a[206:207], v243 offset:14336
    ds_read_b64_tr_b16 a[208:209], v240 offset:128
    ds_read_b64_tr_b16 a[210:211], v240 offset:14464
    ds_read_b64_tr_b16 a[212:213], v241 offset:128
    ds_read_b64_tr_b16 a[214:215], v241 offset:14464
    ds_read_b64_tr_b16 a[216:217], v242 offset:128
    ds_read_b64_tr_b16 a[218:219], v242 offset:14464
    ds_read_b64_tr_b16 a[220:221], v243 offset:128
    s_waitcnt lgkmcnt(7)
    v_mfma_f32_16x16x32_bf16 v[32:35], a[192:195], a[0:3], 0
    ds_read_b64_tr_b16 a[222:223], v243 offset:14464
    v_mfma_f32_16x16x32_bf16 v[36:39], a[192:195], a[4:7], 0
    ds_read_b64_tr_b16 a[224:225], v240 offset:256
    v_mfma_f32_16x16x32_bf16 v[44:47], a[196:199], a[4:7], 0
    ds_read_b64_tr_b16 a[226:227], v240 offset:14592
    v_mfma_f32_16x16x32_bf16 v[40:43], a[196:199], a[0:3], 0
    ds_read_b64_tr_b16 a[228:229], v241 offset:256
    v_mfma_f32_16x16x32_bf16 v[48:51], a[200:203], a[0:3], 0
    ds_read_b64_tr_b16 a[230:231], v241 offset:14592
    v_mfma_f32_16x16x32_bf16 v[52:55], a[200:203], a[4:7], 0
    ds_read_b64_tr_b16 a[232:233], v242 offset:256
    v_mfma_f32_16x16x32_bf16 v[60:63], a[204:207], a[4:7], 0
    ds_read_b64_tr_b16 a[234:235], v242 offset:14592
    v_mfma_f32_16x16x32_bf16 v[56:59], a[204:207], a[0:3], 0
    ds_read_b64_tr_b16 a[236:237], v243 offset:256
    s_waitcnt vmcnt(7)
    s_barrier
    s_waitcnt lgkmcnt(7)
    v_mfma_f32_16x16x32_bf16 v[64:67], a[208:211], a[0:3], 0
    ds_read_b64_tr_b16 a[238:239], v243 offset:14592
    v_mfma_f32_16x16x32_bf16 v[68:71], a[208:211], a[4:7], 0
    ds_read_b64_tr_b16 a[240:241], v240 offset:384
    s_add_u32 m0, s45, 65536
    s_nop 0
    buffer_load_dwordx4 v8, s[20:23], s37 offen offset:0 lds
    v_mfma_f32_16x16x32_bf16 v[76:79], a[212:215], a[4:7], 0
    ds_read_b64_tr_b16 a[242:243], v240 offset:14720
    buffer_load_dwordx4 v9, s[20:23], s37 offen offset:1024 lds
    v_mfma_f32_16x16x32_bf16 v[72:75], a[212:215], a[0:3], 0
    ds_read_b64_tr_b16 a[244:245], v241 offset:384
    buffer_load_dwordx4 v10, s[20:23], s37 offen offset:2048 lds
    v_mfma_f32_16x16x32_bf16 v[80:83], a[216:219], a[0:3], 0
    ds_read_b64_tr_b16 a[246:247], v241 offset:14720
    buffer_load_dwordx4 v11, s[20:23], s37 offen offset:3072 lds
    v_mfma_f32_16x16x32_bf16 v[84:87], a[216:219], a[4:7], 0
    ds_read_b64_tr_b16 a[248:249], v240 offset:32768
    s_add_u32 m0, s45, 69632
    s_nop 0
    v_mfma_f32_16x16x32_bf16 v[92:95], a[220:223], a[4:7], 0
    ds_read_b64_tr_b16 a[250:251], v240 offset:47104
    buffer_load_dwordx4 v12, s[20:23], s37 offen offset:0 lds
    v_mfma_f32_16x16x32_bf16 v[88:91], a[220:223], a[0:3], 0
    ds_read_b64_tr_b16 a[252:253], v241 offset:32768
    buffer_load_dwordx4 v13, s[20:23], s37 offen offset:1024 lds
    s_waitcnt lgkmcnt(7)
    v_mfma_f32_16x16x32_bf16 v[96:99], a[224:227], a[0:3], 0
    ds_read_b64_tr_b16 a[254:255], v241 offset:47104
    buffer_load_dwordx4 v14, s[20:23], s37 offen offset:2048 lds
    v_mfma_f32_16x16x32_bf16 v[100:103], a[224:227], a[4:7], 0
    ds_read_b64_tr_b16 a[192:193], v242 offset:32768
    s_add_u32 s37, s37, 28672
    s_add_u32 m0, s45, 98304
    s_nop 0
    v_mfma_f32_16x16x32_bf16 v[108:111], a[228:231], a[4:7], 0
    ds_read_b64_tr_b16 a[194:195], v242 offset:47104
    buffer_load_dwordx4 v8, s[20:23], s37 offen offset:0 lds
    v_mfma_f32_16x16x32_bf16 v[104:107], a[228:231], a[0:3], 0
    ds_read_b64_tr_b16 a[196:197], v243 offset:32768
    buffer_load_dwordx4 v9, s[20:23], s37 offen offset:1024 lds
    v_mfma_f32_16x16x32_bf16 v[112:115], a[232:235], a[0:3], 0
    ds_read_b64_tr_b16 a[198:199], v243 offset:47104
    buffer_load_dwordx4 v10, s[20:23], s37 offen offset:2048 lds
    v_mfma_f32_16x16x32_bf16 v[116:119], a[232:235], a[4:7], 0
    ds_read_b64_tr_b16 a[200:201], v240 offset:32896
    buffer_load_dwordx4 v11, s[20:23], s37 offen offset:3072 lds
    v_mfma_f32_16x16x32_bf16 v[124:127], a[236:239], a[4:7], 0
    ds_read_b64_tr_b16 a[202:203], v240 offset:47232
    s_add_u32 m0, s45, 102400
    s_nop 0
    buffer_load_dwordx4 v12, s[20:23], s37 offen offset:0 lds
    v_mfma_f32_16x16x32_bf16 v[120:123], a[236:239], a[0:3], 0
    ds_read_b64_tr_b16 a[204:205], v241 offset:32896
    buffer_load_dwordx4 v13, s[20:23], s37 offen offset:1024 lds
    s_waitcnt lgkmcnt(11)
    v_mfma_f32_16x16x32_bf16 v[128:131], a[240:243], a[0:3], 0
    ds_read_b64_tr_b16 a[206:207], v241 offset:47232
    buffer_load_dwordx4 v14, s[20:23], s37 offen offset:2048 lds
    v_mfma_f32_16x16x32_bf16 v[132:135], a[240:243], a[4:7], 0
    ds_read_b64_tr_b16 a[208:209], v242 offset:32896
    s_add_u32 s37, s37, 28672
    v_mfma_f32_16x16x32_bf16 v[140:143], a[244:247], a[4:7], 0
    ds_read_b64_tr_b16 a[210:211], v242 offset:47232
    v_mfma_f32_16x16x32_bf16 v[136:139], a[244:247], a[0:3], 0
    ds_read_b64_tr_b16 a[212:213], v243 offset:32896
    s_waitcnt lgkmcnt(7)
    v_mfma_f32_16x16x32_bf16 v[32:35], a[248:251], a[8:11], v[32:35]
    ds_read_b64_tr_b16 a[214:215], v243 offset:47232
    v_mfma_f32_16x16x32_bf16 v[36:39], a[248:251], a[12:15], v[36:39]
    ds_read_b64_tr_b16 a[216:217], v240 offset:33024
    v_mfma_f32_16x16x32_bf16 v[44:47], a[252:255], a[12:15], v[44:47]
    ds_read_b64_tr_b16 a[218:219], v240 offset:47360
    v_mfma_f32_16x16x32_bf16 v[40:43], a[252:255], a[8:11], v[40:43]
    ds_read_b64_tr_b16 a[220:221], v241 offset:33024
    v_mfma_f32_16x16x32_bf16 v[48:51], a[192:195], a[8:11], v[48:51]
    ds_read_b64_tr_b16 a[222:223], v241 offset:47360
    v_mfma_f32_16x16x32_bf16 v[52:55], a[192:195], a[12:15], v[52:55]
    ds_read_b64_tr_b16 a[224:225], v242 offset:33024
    v_mfma_f32_16x16x32_bf16 v[60:63], a[196:199], a[12:15], v[60:63]
    ds_read_b64_tr_b16 a[226:227], v242 offset:47360
    v_mfma_f32_16x16x32_bf16 v[56:59], a[196:199], a[8:11], v[56:59]
    ds_read_b64_tr_b16 a[228:229], v243 offset:33024
    s_waitcnt vmcnt(14)
    s_barrier
    s_waitcnt lgkmcnt(7)
    v_mfma_f32_16x16x32_bf16 v[64:67], a[200:203], a[8:11], v[64:67]
    ds_read_b64_tr_b16 a[230:231], v243 offset:47360
    v_mfma_f32_16x16x32_bf16 v[68:71], a[200:203], a[12:15], v[68:71]
    ds_read_b64_tr_b16 a[232:233], v240 offset:33152
    s_add_u32 m0, s45, 0
    s_nop 0
    buffer_load_dwordx4 v8, s[20:23], s37 offen offset:0 lds
    v_mfma_f32_16x16x32_bf16 v[76:79], a[204:207], a[12:15], v[76:79]
    ds_read_b64_tr_b16 a[234:235], v240 offset:47488
    v_mfma_f32_16x16x32_bf16 v[72:75], a[204:207], a[8:11], v[72:75]
    ds_read_b64_tr_b16 a[236:237], v241 offset:33152
    buffer_load_dwordx4 v9, s[20:23], s37 offen offset:1024 lds
    v_mfma_f32_16x16x32_bf16 v[80:83], a[208:211], a[8:11], v[80:83]
    ds_read_b64_tr_b16 a[238:239], v241 offset:47488
    v_mfma_f32_16x16x32_bf16 v[84:87], a[208:211], a[12:15], v[84:87]
    ds_read_b64_tr_b16 a[240:241], v248 offset:0
    buffer_load_dwordx4 v10, s[20:23], s37 offen offset:2048 lds
    v_mfma_f32_16x16x32_bf16 v[92:95], a[212:215], a[12:15], v[92:95]
    ds_read_b64_tr_b16 a[242:243], v248 offset:14336
    v_mfma_f32_16x16x32_bf16 v[88:91], a[212:215], a[8:11], v[88:91]
    ds_read_b64_tr_b16 a[244:245], v249 offset:0
    buffer_load_dwordx4 v11, s[20:23], s37 offen offset:3072 lds
    s_waitcnt lgkmcnt(7)
    v_mfma_f32_16x16x32_bf16 v[96:99], a[216:219], a[8:11], v[96:99]
    ds_read_b64_tr_b16 a[246:247], v249 offset:14336
    v_mfma_f32_16x16x32_bf16 v[100:103], a[216:219], a[12:15], v[100:103]
    ds_read_b64_tr_b16 a[248:249], v250 offset:0
    s_add_u32 m0, s45, 4096
    v_mfma_f32_16x16x32_bf16 v[108:111], a[220:223], a[12:15], v[108:111]
    ds_read_b64_tr_b16 a[250:251], v250 offset:14336
    s_nop 0
    buffer_load_dwordx4 v12, s[20:23], s37 offen offset:0 lds
    v_mfma_f32_16x16x32_bf16 v[104:107], a[220:223], a[8:11], v[104:107]
    ds_read_b64_tr_b16 a[252:253], v251 offset:0
    v_mfma_f32_16x16x32_bf16 v[112:115], a[224:227], a[8:11], v[112:115]
    ds_read_b64_tr_b16 a[254:255], v251 offset:14336
    buffer_load_dwordx4 v13, s[20:23], s37 offen offset:1024 lds
    v_mfma_f32_16x16x32_bf16 v[116:119], a[224:227], a[12:15], v[116:119]
    ds_read_b64_tr_b16 a[192:193], v248 offset:128
    v_mfma_f32_16x16x32_bf16 v[124:127], a[228:231], a[12:15], v[124:127]
    ds_read_b64_tr_b16 a[194:195], v248 offset:14464
    buffer_load_dwordx4 v14, s[20:23], s37 offen offset:2048 lds
    v_mfma_f32_16x16x32_bf16 v[120:123], a[228:231], a[8:11], v[120:123]
    ds_read_b64_tr_b16 a[196:197], v249 offset:128
    s_waitcnt lgkmcnt(11)
    v_mfma_f32_16x16x32_bf16 v[128:131], a[232:235], a[8:11], v[128:131]
    ds_read_b64_tr_b16 a[198:199], v249 offset:14464
    s_add_u32 s37, s37, 28672
    v_mfma_f32_16x16x32_bf16 v[132:135], a[232:235], a[12:15], v[132:135]
    ds_read_b64_tr_b16 a[200:201], v250 offset:128
    v_mfma_f32_16x16x32_bf16 v[140:143], a[236:239], a[12:15], v[140:143]
    ds_read_b64_tr_b16 a[202:203], v250 offset:14464
    v_mfma_f32_16x16x32_bf16 v[136:139], a[236:239], a[8:11], v[136:139]
    ds_read_b64_tr_b16 a[204:205], v251 offset:128
    s_waitcnt lgkmcnt(7)
    v_mfma_f32_16x16x32_bf16 v[32:35], a[240:243], a[16:19], v[32:35]
    ds_read_b64_tr_b16 a[206:207], v251 offset:14464
    v_mfma_f32_16x16x32_bf16 v[36:39], a[240:243], a[20:23], v[36:39]
    ds_read_b64_tr_b16 a[208:209], v248 offset:256
    v_mfma_f32_16x16x32_bf16 v[44:47], a[244:247], a[20:23], v[44:47]
    ds_read_b64_tr_b16 a[210:211], v248 offset:14592
    v_mfma_f32_16x16x32_bf16 v[40:43], a[244:247], a[16:19], v[40:43]
    ds_read_b64_tr_b16 a[212:213], v249 offset:256
    v_mfma_f32_16x16x32_bf16 v[48:51], a[248:251], a[16:19], v[48:51]
    ds_read_b64_tr_b16 a[214:215], v249 offset:14592
    v_mfma_f32_16x16x32_bf16 v[52:55], a[248:251], a[20:23], v[52:55]
    ds_read_b64_tr_b16 a[216:217], v250 offset:256
    v_mfma_f32_16x16x32_bf16 v[60:63], a[252:255], a[20:23], v[60:63]
    ds_read_b64_tr_b16 a[218:219], v250 offset:14592
    v_mfma_f32_16x16x32_bf16 v[56:59], a[252:255], a[16:19], v[56:59]
    ds_read_b64_tr_b16 a[220:221], v251 offset:256
    s_waitcnt vmcnt(14)
    s_barrier
    s_waitcnt lgkmcnt(7)
    v_mfma_f32_16x16x32_bf16 v[64:67], a[192:195], a[16:19], v[64:67]
    ds_read_b64_tr_b16 a[222:223], v251 offset:14592
    v_mfma_f32_16x16x32_bf16 v[68:71], a[192:195], a[20:23], v[68:71]
    ds_read_b64_tr_b16 a[224:225], v248 offset:384
    s_add_u32 m0, s45, 32768
    s_nop 0
    buffer_load_dwordx4 v8, s[20:23], s37 offen offset:0 lds
    v_mfma_f32_16x16x32_bf16 v[76:79], a[196:199], a[20:23], v[76:79]
    ds_read_b64_tr_b16 a[226:227], v248 offset:14720
    v_mfma_f32_16x16x32_bf16 v[72:75], a[196:199], a[16:19], v[72:75]
    ds_read_b64_tr_b16 a[228:229], v249 offset:384
    buffer_load_dwordx4 v9, s[20:23], s37 offen offset:1024 lds
    v_mfma_f32_16x16x32_bf16 v[80:83], a[200:203], a[16:19], v[80:83]
    ds_read_b64_tr_b16 a[230:231], v249 offset:14720
    v_mfma_f32_16x16x32_bf16 v[84:87], a[200:203], a[20:23], v[84:87]
    ds_read_b64_tr_b16 a[232:233], v244 offset:0
    buffer_load_dwordx4 v10, s[20:23], s37 offen offset:2048 lds
    v_mfma_f32_16x16x32_bf16 v[92:95], a[204:207], a[20:23], v[92:95]
    ds_read_b64_tr_b16 a[234:235], v244 offset:14336
    v_mfma_f32_16x16x32_bf16 v[88:91], a[204:207], a[16:19], v[88:91]
    ds_read_b64_tr_b16 a[236:237], v245 offset:0
    buffer_load_dwordx4 v11, s[20:23], s37 offen offset:3072 lds
    s_waitcnt lgkmcnt(7)
    v_mfma_f32_16x16x32_bf16 v[96:99], a[208:211], a[16:19], v[96:99]
    ds_read_b64_tr_b16 a[238:239], v245 offset:14336
    v_mfma_f32_16x16x32_bf16 v[100:103], a[208:211], a[20:23], v[100:103]
    ds_read_b64_tr_b16 a[240:241], v246 offset:0
    s_add_u32 m0, s45, 36864
    v_mfma_f32_16x16x32_bf16 v[108:111], a[212:215], a[20:23], v[108:111]
    ds_read_b64_tr_b16 a[242:243], v246 offset:14336
    s_nop 0
    buffer_load_dwordx4 v12, s[20:23], s37 offen offset:0 lds
    v_mfma_f32_16x16x32_bf16 v[104:107], a[212:215], a[16:19], v[104:107]
    ds_read_b64_tr_b16 a[244:245], v247 offset:0
    v_mfma_f32_16x16x32_bf16 v[112:115], a[216:219], a[16:19], v[112:115]
    ds_read_b64_tr_b16 a[246:247], v247 offset:14336
    buffer_load_dwordx4 v13, s[20:23], s37 offen offset:1024 lds
    v_mfma_f32_16x16x32_bf16 v[116:119], a[216:219], a[20:23], v[116:119]
    ds_read_b64_tr_b16 a[248:249], v244 offset:128
    v_mfma_f32_16x16x32_bf16 v[124:127], a[220:223], a[20:23], v[124:127]
    ds_read_b64_tr_b16 a[250:251], v244 offset:14464
    buffer_load_dwordx4 v14, s[20:23], s37 offen offset:2048 lds
    v_mfma_f32_16x16x32_bf16 v[120:123], a[220:223], a[16:19], v[120:123]
    ds_read_b64_tr_b16 a[252:253], v245 offset:128
    s_waitcnt lgkmcnt(11)
    v_mfma_f32_16x16x32_bf16 v[128:131], a[224:227], a[16:19], v[128:131]
    ds_read_b64_tr_b16 a[254:255], v245 offset:14464
    s_add_u32 s37, s37, 28672
    v_mfma_f32_16x16x32_bf16 v[132:135], a[224:227], a[20:23], v[132:135]
    ds_read_b64_tr_b16 a[192:193], v246 offset:128
    v_mfma_f32_16x16x32_bf16 v[140:143], a[228:231], a[20:23], v[140:143]
    ds_read_b64_tr_b16 a[194:195], v246 offset:14464
    v_mfma_f32_16x16x32_bf16 v[136:139], a[228:231], a[16:19], v[136:139]
    ds_read_b64_tr_b16 a[196:197], v247 offset:128
    s_waitcnt lgkmcnt(7)
    v_mfma_f32_16x16x32_bf16 v[32:35], a[232:235], a[24:27], v[32:35]
    ds_read_b64_tr_b16 a[198:199], v247 offset:14464
    v_mfma_f32_16x16x32_bf16 v[36:39], a[232:235], a[28:31], v[36:39]
    ds_read_b64_tr_b16 a[200:201], v244 offset:256
    v_mfma_f32_16x16x32_bf16 v[44:47], a[236:239], a[28:31], v[44:47]
    ds_read_b64_tr_b16 a[202:203], v244 offset:14592
    v_mfma_f32_16x16x32_bf16 v[40:43], a[236:239], a[24:27], v[40:43]
    ds_read_b64_tr_b16 a[204:205], v245 offset:256
    v_mfma_f32_16x16x32_bf16 v[48:51], a[240:243], a[24:27], v[48:51]
    ds_read_b64_tr_b16 a[206:207], v245 offset:14592
    v_mfma_f32_16x16x32_bf16 v[52:55], a[240:243], a[28:31], v[52:55]
    ds_read_b64_tr_b16 a[208:209], v246 offset:256
    v_mfma_f32_16x16x32_bf16 v[60:63], a[244:247], a[28:31], v[60:63]
    ds_read_b64_tr_b16 a[210:211], v246 offset:14592
    v_mfma_f32_16x16x32_bf16 v[56:59], a[244:247], a[24:27], v[56:59]
    ds_read_b64_tr_b16 a[212:213], v247 offset:256
    s_waitcnt vmcnt(14)
    s_barrier
    s_waitcnt lgkmcnt(7)
    v_mfma_f32_16x16x32_bf16 v[64:67], a[248:251], a[24:27], v[64:67]
    ds_read_b64_tr_b16 a[214:215], v247 offset:14592
    v_mfma_f32_16x16x32_bf16 v[68:71], a[248:251], a[28:31], v[68:71]
    ds_read_b64_tr_b16 a[216:217], v244 offset:384
    s_add_u32 m0, s45, 131072
    s_nop 0
    buffer_load_dwordx4 v8, s[20:23], s37 offen offset:0 lds
    v_mfma_f32_16x16x32_bf16 v[76:79], a[252:255], a[28:31], v[76:79]
    ds_read_b64_tr_b16 a[218:219], v244 offset:14720
    v_mfma_f32_16x16x32_bf16 v[72:75], a[252:255], a[24:27], v[72:75]
    ds_read_b64_tr_b16 a[220:221], v245 offset:384
    buffer_load_dwordx4 v9, s[20:23], s37 offen offset:1024 lds
    v_mfma_f32_16x16x32_bf16 v[80:83], a[192:195], a[24:27], v[80:83]
    ds_read_b64_tr_b16 a[222:223], v245 offset:14720
    v_mfma_f32_16x16x32_bf16 v[84:87], a[192:195], a[28:31], v[84:87]
    ds_read_b64_tr_b16 a[224:225], v244 offset:32768
    buffer_load_dwordx4 v10, s[20:23], s37 offen offset:2048 lds
    v_mfma_f32_16x16x32_bf16 v[92:95], a[196:199], a[28:31], v[92:95]
    ds_read_b64_tr_b16 a[226:227], v244 offset:47104
    v_mfma_f32_16x16x32_bf16 v[88:91], a[196:199], a[24:27], v[88:91]
    ds_read_b64_tr_b16 a[228:229], v245 offset:32768
    buffer_load_dwordx4 v11, s[20:23], s37 offen offset:3072 lds
    s_waitcnt lgkmcnt(7)
    v_mfma_f32_16x16x32_bf16 v[96:99], a[200:203], a[24:27], v[96:99]
    ds_read_b64_tr_b16 a[230:231], v245 offset:47104
    v_mfma_f32_16x16x32_bf16 v[100:103], a[200:203], a[28:31], v[100:103]
    ds_read_b64_tr_b16 a[232:233], v246 offset:32768
    s_add_u32 m0, s45, 135168
    v_mfma_f32_16x16x32_bf16 v[108:111], a[204:207], a[28:31], v[108:111]
    ds_read_b64_tr_b16 a[234:235], v246 offset:47104
    s_nop 0
    buffer_load_dwordx4 v12, s[20:23], s37 offen offset:0 lds
    v_mfma_f32_16x16x32_bf16 v[104:107], a[204:207], a[24:27], v[104:107]
    ds_read_b64_tr_b16 a[236:237], v247 offset:32768
    v_mfma_f32_16x16x32_bf16 v[112:115], a[208:211], a[24:27], v[112:115]
    ds_read_b64_tr_b16 a[238:239], v247 offset:47104
    buffer_load_dwordx4 v13, s[20:23], s37 offen offset:1024 lds
    v_mfma_f32_16x16x32_bf16 v[116:119], a[208:211], a[28:31], v[116:119]
    ds_read_b64_tr_b16 a[240:241], v244 offset:32896
    v_mfma_f32_16x16x32_bf16 v[124:127], a[212:215], a[28:31], v[124:127]
    ds_read_b64_tr_b16 a[242:243], v244 offset:47232
    buffer_load_dwordx4 v14, s[20:23], s37 offen offset:2048 lds
    v_mfma_f32_16x16x32_bf16 v[120:123], a[212:215], a[24:27], v[120:123]
    ds_read_b64_tr_b16 a[244:245], v245 offset:32896
    s_waitcnt lgkmcnt(11)
    v_mfma_f32_16x16x32_bf16 v[128:131], a[216:219], a[24:27], v[128:131]
    ds_read_b64_tr_b16 a[246:247], v245 offset:47232
    s_add_u32 s37, s37, 28672
    v_mfma_f32_16x16x32_bf16 v[132:135], a[216:219], a[28:31], v[132:135]
    ds_read_b64_tr_b16 a[248:249], v246 offset:32896
    v_mfma_f32_16x16x32_bf16 v[140:143], a[220:223], a[28:31], v[140:143]
    ds_read_b64_tr_b16 a[250:251], v246 offset:47232
    v_mfma_f32_16x16x32_bf16 v[136:139], a[220:223], a[24:27], v[136:139]
    ds_read_b64_tr_b16 a[252:253], v247 offset:32896
    s_waitcnt lgkmcnt(7)
    v_mfma_f32_16x16x32_bf16 v[32:35], a[224:227], a[32:35], v[32:35]
    ds_read_b64_tr_b16 a[254:255], v247 offset:47232
    v_mfma_f32_16x16x32_bf16 v[36:39], a[224:227], a[36:39], v[36:39]
    ds_read_b64_tr_b16 a[192:193], v244 offset:33024
    v_mfma_f32_16x16x32_bf16 v[44:47], a[228:231], a[36:39], v[44:47]
    ds_read_b64_tr_b16 a[194:195], v244 offset:47360
    v_mfma_f32_16x16x32_bf16 v[40:43], a[228:231], a[32:35], v[40:43]
    ds_read_b64_tr_b16 a[196:197], v245 offset:33024
    v_mfma_f32_16x16x32_bf16 v[48:51], a[232:235], a[32:35], v[48:51]
    ds_read_b64_tr_b16 a[198:199], v245 offset:47360
    v_mfma_f32_16x16x32_bf16 v[52:55], a[232:235], a[36:39], v[52:55]
    ds_read_b64_tr_b16 a[200:201], v246 offset:33024
    v_mfma_f32_16x16x32_bf16 v[60:63], a[236:239], a[36:39], v[60:63]
    ds_read_b64_tr_b16 a[202:203], v246 offset:47360
    v_mfma_f32_16x16x32_bf16 v[56:59], a[236:239], a[32:35], v[56:59]
    ds_read_b64_tr_b16 a[204:205], v247 offset:33024
    s_waitcnt vmcnt(14)
    s_barrier
    s_waitcnt lgkmcnt(7)
    v_mfma_f32_16x16x32_bf16 v[64:67], a[240:243], a[32:35], v[64:67]
    ds_read_b64_tr_b16 a[206:207], v247 offset:47360
    v_mfma_f32_16x16x32_bf16 v[68:71], a[240:243], a[36:39], v[68:71]
    ds_read_b64_tr_b16 a[208:209], v244 offset:33152
    s_add_u32 m0, s45, 65536
    s_nop 0
    buffer_load_dwordx4 v8, s[20:23], s37 offen offset:0 lds
    v_mfma_f32_16x16x32_bf16 v[76:79], a[244:247], a[36:39], v[76:79]
    ds_read_b64_tr_b16 a[210:211], v244 offset:47488
    v_mfma_f32_16x16x32_bf16 v[72:75], a[244:247], a[32:35], v[72:75]
    ds_read_b64_tr_b16 a[212:213], v245 offset:33152
    buffer_load_dwordx4 v9, s[20:23], s37 offen offset:1024 lds
    v_mfma_f32_16x16x32_bf16 v[80:83], a[248:251], a[32:35], v[80:83]
    ds_read_b64_tr_b16 a[214:215], v245 offset:47488
    v_mfma_f32_16x16x32_bf16 v[84:87], a[248:251], a[36:39], v[84:87]
    ds_read_b64_tr_b16 a[216:217], v240 offset:0
    buffer_load_dwordx4 v10, s[20:23], s37 offen offset:2048 lds
    v_mfma_f32_16x16x32_bf16 v[92:95], a[252:255], a[36:39], v[92:95]
    ds_read_b64_tr_b16 a[218:219], v240 offset:14336
    v_mfma_f32_16x16x32_bf16 v[88:91], a[252:255], a[32:35], v[88:91]
    ds_read_b64_tr_b16 a[220:221], v241 offset:0
    buffer_load_dwordx4 v11, s[20:23], s37 offen offset:3072 lds
    s_waitcnt lgkmcnt(7)
    v_mfma_f32_16x16x32_bf16 v[96:99], a[192:195], a[32:35], v[96:99]
    ds_read_b64_tr_b16 a[222:223], v241 offset:14336
    v_mfma_f32_16x16x32_bf16 v[100:103], a[192:195], a[36:39], v[100:103]
    ds_read_b64_tr_b16 a[224:225], v242 offset:0
    s_add_u32 m0, s45, 69632
    v_mfma_f32_16x16x32_bf16 v[108:111], a[196:199], a[36:39], v[108:111]
    ds_read_b64_tr_b16 a[226:227], v242 offset:14336
    s_nop 0
    buffer_load_dwordx4 v12, s[20:23], s37 offen offset:0 lds
    v_mfma_f32_16x16x32_bf16 v[104:107], a[196:199], a[32:35], v[104:107]
    ds_read_b64_tr_b16 a[228:229], v243 offset:0
    v_mfma_f32_16x16x32_bf16 v[112:115], a[200:203], a[32:35], v[112:115]
    ds_read_b64_tr_b16 a[230:231], v243 offset:14336
    buffer_load_dwordx4 v13, s[20:23], s37 offen offset:1024 lds
    v_mfma_f32_16x16x32_bf16 v[116:119], a[200:203], a[36:39], v[116:119]
    ds_read_b64_tr_b16 a[232:233], v240 offset:128
    v_mfma_f32_16x16x32_bf16 v[124:127], a[204:207], a[36:39], v[124:127]
    ds_read_b64_tr_b16 a[234:235], v240 offset:14464
    buffer_load_dwordx4 v14, s[20:23], s37 offen offset:2048 lds
    v_mfma_f32_16x16x32_bf16 v[120:123], a[204:207], a[32:35], v[120:123]
    ds_read_b64_tr_b16 a[236:237], v241 offset:128
    s_waitcnt lgkmcnt(11)
    v_mfma_f32_16x16x32_bf16 v[128:131], a[208:211], a[32:35], v[128:131]
    ds_read_b64_tr_b16 a[238:239], v241 offset:14464
    s_add_u32 s37, s37, 28672
    v_mfma_f32_16x16x32_bf16 v[132:135], a[208:211], a[36:39], v[132:135]
    ds_read_b64_tr_b16 a[240:241], v242 offset:128
    v_mfma_f32_16x16x32_bf16 v[140:143], a[212:215], a[36:39], v[140:143]
    ds_read_b64_tr_b16 a[242:243], v242 offset:14464
    v_mfma_f32_16x16x32_bf16 v[136:139], a[212:215], a[32:35], v[136:139]
    ds_read_b64_tr_b16 a[244:245], v243 offset:128
    s_waitcnt lgkmcnt(7)
    v_mfma_f32_16x16x32_bf16 v[32:35], a[216:219], a[40:43], v[32:35]
    ds_read_b64_tr_b16 a[246:247], v243 offset:14464
    v_mfma_f32_16x16x32_bf16 v[36:39], a[216:219], a[44:47], v[36:39]
    ds_read_b64_tr_b16 a[248:249], v240 offset:256
    v_mfma_f32_16x16x32_bf16 v[44:47], a[220:223], a[44:47], v[44:47]
    ds_read_b64_tr_b16 a[250:251], v240 offset:14592
    v_mfma_f32_16x16x32_bf16 v[40:43], a[220:223], a[40:43], v[40:43]
    ds_read_b64_tr_b16 a[252:253], v241 offset:256
    v_mfma_f32_16x16x32_bf16 v[48:51], a[224:227], a[40:43], v[48:51]
    ds_read_b64_tr_b16 a[254:255], v241 offset:14592
    v_mfma_f32_16x16x32_bf16 v[52:55], a[224:227], a[44:47], v[52:55]
    ds_read_b64_tr_b16 a[192:193], v242 offset:256
    v_mfma_f32_16x16x32_bf16 v[60:63], a[228:231], a[44:47], v[60:63]
    ds_read_b64_tr_b16 a[194:195], v242 offset:14592
    v_mfma_f32_16x16x32_bf16 v[56:59], a[228:231], a[40:43], v[56:59]
    ds_read_b64_tr_b16 a[196:197], v243 offset:256
    s_waitcnt vmcnt(14)
    s_barrier
    s_waitcnt lgkmcnt(7)
    v_mfma_f32_16x16x32_bf16 v[64:67], a[232:235], a[40:43], v[64:67]
    ds_read_b64_tr_b16 a[198:199], v243 offset:14592
    v_mfma_f32_16x16x32_bf16 v[68:71], a[232:235], a[44:47], v[68:71]
    ds_read_b64_tr_b16 a[200:201], v240 offset:384
    s_add_u32 m0, s45, 98304
    s_nop 0
    buffer_load_dwordx4 v8, s[20:23], s37 offen offset:0 lds
    v_mfma_f32_16x16x32_bf16 v[76:79], a[236:239], a[44:47], v[76:79]
    ds_read_b64_tr_b16 a[202:203], v240 offset:14720
    v_mfma_f32_16x16x32_bf16 v[72:75], a[236:239], a[40:43], v[72:75]
    ds_read_b64_tr_b16 a[204:205], v241 offset:384
    buffer_load_dwordx4 v9, s[20:23], s37 offen offset:1024 lds
    v_mfma_f32_16x16x32_bf16 v[80:83], a[240:243], a[40:43], v[80:83]
    ds_read_b64_tr_b16 a[206:207], v241 offset:14720
    v_mfma_f32_16x16x32_bf16 v[84:87], a[240:243], a[44:47], v[84:87]
    ds_read_b64_tr_b16 a[208:209], v240 offset:32768
    buffer_load_dwordx4 v10, s[20:23], s37 offen offset:2048 lds
    v_mfma_f32_16x16x32_bf16 v[92:95], a[244:247], a[44:47], v[92:95]
    ds_read_b64_tr_b16 a[210:211], v240 offset:47104
    v_mfma_f32_16x16x32_bf16 v[88:91], a[244:247], a[40:43], v[88:91]
    ds_read_b64_tr_b16 a[212:213], v241 offset:32768
    buffer_load_dwordx4 v11, s[20:23], s37 offen offset:3072 lds
    s_waitcnt lgkmcnt(7)
    v_mfma_f32_16x16x32_bf16 v[96:99], a[248:251], a[40:43], v[96:99]
    ds_read_b64_tr_b16 a[214:215], v241 offset:47104
    v_mfma_f32_16x16x32_bf16 v[100:103], a[248:251], a[44:47], v[100:103]
    ds_read_b64_tr_b16 a[216:217], v242 offset:32768
    s_add_u32 m0, s45, 102400
    v_mfma_f32_16x16x32_bf16 v[108:111], a[252:255], a[44:47], v[108:111]
    ds_read_b64_tr_b16 a[218:219], v242 offset:47104
    s_nop 0
    buffer_load_dwordx4 v12, s[20:23], s37 offen offset:0 lds
    v_mfma_f32_16x16x32_bf16 v[104:107], a[252:255], a[40:43], v[104:107]
    ds_read_b64_tr_b16 a[220:221], v243 offset:32768
    v_mfma_f32_16x16x32_bf16 v[112:115], a[192:195], a[40:43], v[112:115]
    ds_read_b64_tr_b16 a[222:223], v243 offset:47104
    buffer_load_dwordx4 v13, s[20:23], s37 offen offset:1024 lds
    v_mfma_f32_16x16x32_bf16 v[116:119], a[192:195], a[44:47], v[116:119]
    ds_read_b64_tr_b16 a[224:225], v240 offset:32896
    v_mfma_f32_16x16x32_bf16 v[124:127], a[196:199], a[44:47], v[124:127]
    ds_read_b64_tr_b16 a[226:227], v240 offset:47232
    buffer_load_dwordx4 v14, s[20:23], s37 offen offset:2048 lds
    v_mfma_f32_16x16x32_bf16 v[120:123], a[196:199], a[40:43], v[120:123]
    ds_read_b64_tr_b16 a[228:229], v241 offset:32896
    s_waitcnt lgkmcnt(11)
    v_mfma_f32_16x16x32_bf16 v[128:131], a[200:203], a[40:43], v[128:131]
    ds_read_b64_tr_b16 a[230:231], v241 offset:47232
    s_add_u32 s37, s37, 28672
    v_mfma_f32_16x16x32_bf16 v[132:135], a[200:203], a[44:47], v[132:135]
    ds_read_b64_tr_b16 a[232:233], v242 offset:32896
    v_mfma_f32_16x16x32_bf16 v[140:143], a[204:207], a[44:47], v[140:143]
    ds_read_b64_tr_b16 a[234:235], v242 offset:47232
    v_mfma_f32_16x16x32_bf16 v[136:139], a[204:207], a[40:43], v[136:139]
    ds_read_b64_tr_b16 a[236:237], v243 offset:32896
    s_waitcnt lgkmcnt(7)
    v_mfma_f32_16x16x32_bf16 v[32:35], a[208:211], a[48:51], v[32:35]
    ds_read_b64_tr_b16 a[238:239], v243 offset:47232
    v_mfma_f32_16x16x32_bf16 v[36:39], a[208:211], a[52:55], v[36:39]
    ds_read_b64_tr_b16 a[240:241], v240 offset:33024
    v_mfma_f32_16x16x32_bf16 v[44:47], a[212:215], a[52:55], v[44:47]
    ds_read_b64_tr_b16 a[242:243], v240 offset:47360
    v_mfma_f32_16x16x32_bf16 v[40:43], a[212:215], a[48:51], v[40:43]
    ds_read_b64_tr_b16 a[244:245], v241 offset:33024
    v_mfma_f32_16x16x32_bf16 v[48:51], a[216:219], a[48:51], v[48:51]
    ds_read_b64_tr_b16 a[246:247], v241 offset:47360
    v_mfma_f32_16x16x32_bf16 v[52:55], a[216:219], a[52:55], v[52:55]
    ds_read_b64_tr_b16 a[248:249], v242 offset:33024
    v_mfma_f32_16x16x32_bf16 v[60:63], a[220:223], a[52:55], v[60:63]
    ds_read_b64_tr_b16 a[250:251], v242 offset:47360
    v_mfma_f32_16x16x32_bf16 v[56:59], a[220:223], a[48:51], v[56:59]
    ds_read_b64_tr_b16 a[252:253], v243 offset:33024
    s_waitcnt vmcnt(14)
    s_barrier
    s_waitcnt lgkmcnt(7)
    v_mfma_f32_16x16x32_bf16 v[64:67], a[224:227], a[48:51], v[64:67]
    ds_read_b64_tr_b16 a[254:255], v243 offset:47360
    v_mfma_f32_16x16x32_bf16 v[68:71], a[224:227], a[52:55], v[68:71]
    ds_read_b64_tr_b16 a[192:193], v240 offset:33152
    s_add_u32 m0, s45, 0
    s_nop 0
    buffer_load_dwordx4 v8, s[20:23], s37 offen offset:0 lds
    v_mfma_f32_16x16x32_bf16 v[76:79], a[228:231], a[52:55], v[76:79]
    ds_read_b64_tr_b16 a[194:195], v240 offset:47488
    v_mfma_f32_16x16x32_bf16 v[72:75], a[228:231], a[48:51], v[72:75]
    ds_read_b64_tr_b16 a[196:197], v241 offset:33152
    buffer_load_dwordx4 v9, s[20:23], s37 offen offset:1024 lds
    v_mfma_f32_16x16x32_bf16 v[80:83], a[232:235], a[48:51], v[80:83]
    ds_read_b64_tr_b16 a[198:199], v241 offset:47488
    v_mfma_f32_16x16x32_bf16 v[84:87], a[232:235], a[52:55], v[84:87]
    ds_read_b64_tr_b16 a[200:201], v248 offset:0
    buffer_load_dwordx4 v10, s[20:23], s37 offen offset:2048 lds
    v_mfma_f32_16x16x32_bf16 v[92:95], a[236:239], a[52:55], v[92:95]
    ds_read_b64_tr_b16 a[202:203], v248 offset:14336
    v_mfma_f32_16x16x32_bf16 v[88:91], a[236:239], a[48:51], v[88:91]
    ds_read_b64_tr_b16 a[204:205], v249 offset:0
    buffer_load_dwordx4 v11, s[20:23], s37 offen offset:3072 lds
    s_waitcnt lgkmcnt(7)
    v_mfma_f32_16x16x32_bf16 v[96:99], a[240:243], a[48:51], v[96:99]
    ds_read_b64_tr_b16 a[206:207], v249 offset:14336
    v_mfma_f32_16x16x32_bf16 v[100:103], a[240:243], a[52:55], v[100:103]
    ds_read_b64_tr_b16 a[208:209], v250 offset:0
    s_add_u32 m0, s45, 4096
    v_mfma_f32_16x16x32_bf16 v[108:111], a[244:247], a[52:55], v[108:111]
    ds_read_b64_tr_b16 a[210:211], v250 offset:14336
    s_nop 0
    buffer_load_dwordx4 v12, s[20:23], s37 offen offset:0 lds
    v_mfma_f32_16x16x32_bf16 v[104:107], a[244:247], a[48:51], v[104:107]
    ds_read_b64_tr_b16 a[212:213], v251 offset:0
    v_mfma_f32_16x16x32_bf16 v[112:115], a[248:251], a[48:51], v[112:115]
    ds_read_b64_tr_b16 a[214:215], v251 offset:14336
    buffer_load_dwordx4 v13, s[20:23], s37 offen offset:1024 lds
    v_mfma_f32_16x16x32_bf16 v[116:119], a[248:251], a[52:55], v[116:119]
    ds_read_b64_tr_b16 a[216:217], v248 offset:128
    v_mfma_f32_16x16x32_bf16 v[124:127], a[252:255], a[52:55], v[124:127]
    ds_read_b64_tr_b16 a[218:219], v248 offset:14464
    buffer_load_dwordx4 v14, s[20:23], s37 offen offset:2048 lds
    v_mfma_f32_16x16x32_bf16 v[120:123], a[252:255], a[48:51], v[120:123]
    ds_read_b64_tr_b16 a[220:221], v249 offset:128
    s_waitcnt lgkmcnt(11)
    v_mfma_f32_16x16x32_bf16 v[128:131], a[192:195], a[48:51], v[128:131]
    ds_read_b64_tr_b16 a[222:223], v249 offset:14464
    s_add_u32 s37, s37, 28672
    v_mfma_f32_16x16x32_bf16 v[132:135], a[192:195], a[52:55], v[132:135]
    ds_read_b64_tr_b16 a[224:225], v250 offset:128
    v_mfma_f32_16x16x32_bf16 v[140:143], a[196:199], a[52:55], v[140:143]
    ds_read_b64_tr_b16 a[226:227], v250 offset:14464
    v_mfma_f32_16x16x32_bf16 v[136:139], a[196:199], a[48:51], v[136:139]
    ds_read_b64_tr_b16 a[228:229], v251 offset:128
    s_waitcnt lgkmcnt(7)
    v_mfma_f32_16x16x32_bf16 v[32:35], a[200:203], a[56:59], v[32:35]
    ds_read_b64_tr_b16 a[230:231], v251 offset:14464
    v_mfma_f32_16x16x32_bf16 v[36:39], a[200:203], a[60:63], v[36:39]
    ds_read_b64_tr_b16 a[232:233], v248 offset:256
    v_mfma_f32_16x16x32_bf16 v[44:47], a[204:207], a[60:63], v[44:47]
    ds_read_b64_tr_b16 a[234:235], v248 offset:14592
    v_mfma_f32_16x16x32_bf16 v[40:43], a[204:207], a[56:59], v[40:43]
    ds_read_b64_tr_b16 a[236:237], v249 offset:256
    v_mfma_f32_16x16x32_bf16 v[48:51], a[208:211], a[56:59], v[48:51]
    ds_read_b64_tr_b16 a[238:239], v249 offset:14592
    v_mfma_f32_16x16x32_bf16 v[52:55], a[208:211], a[60:63], v[52:55]
    ds_read_b64_tr_b16 a[240:241], v250 offset:256
    v_mfma_f32_16x16x32_bf16 v[60:63], a[212:215], a[60:63], v[60:63]
    ds_read_b64_tr_b16 a[242:243], v250 offset:14592
    v_mfma_f32_16x16x32_bf16 v[56:59], a[212:215], a[56:59], v[56:59]
    ds_read_b64_tr_b16 a[244:245], v251 offset:256
    s_waitcnt vmcnt(14)
    s_barrier
    s_waitcnt lgkmcnt(7)
    v_mfma_f32_16x16x32_bf16 v[64:67], a[216:219], a[56:59], v[64:67]
    ds_read_b64_tr_b16 a[246:247], v251 offset:14592
    v_mfma_f32_16x16x32_bf16 v[68:71], a[216:219], a[60:63], v[68:71]
    ds_read_b64_tr_b16 a[248:249], v248 offset:384
    s_add_u32 m0, s45, 32768
    s_nop 0
    buffer_load_dwordx4 v8, s[20:23], s37 offen offset:0 lds
    v_mfma_f32_16x16x32_bf16 v[76:79], a[220:223], a[60:63], v[76:79]
    ds_read_b64_tr_b16 a[250:251], v248 offset:14720
    v_mfma_f32_16x16x32_bf16 v[72:75], a[220:223], a[56:59], v[72:75]
    ds_read_b64_tr_b16 a[252:253], v249 offset:384
    buffer_load_dwordx4 v9, s[20:23], s37 offen offset:1024 lds
    v_mfma_f32_16x16x32_bf16 v[80:83], a[224:227], a[56:59], v[80:83]
    ds_read_b64_tr_b16 a[254:255], v249 offset:14720
    v_mfma_f32_16x16x32_bf16 v[84:87], a[224:227], a[60:63], v[84:87]
    ds_read_b64_tr_b16 a[192:193], v244 offset:0
    buffer_load_dwordx4 v10, s[20:23], s37 offen offset:2048 lds
    v_mfma_f32_16x16x32_bf16 v[92:95], a[228:231], a[60:63], v[92:95]
    ds_read_b64_tr_b16 a[194:195], v244 offset:14336
    v_mfma_f32_16x16x32_bf16 v[88:91], a[228:231], a[56:59], v[88:91]
    ds_read_b64_tr_b16 a[196:197], v245 offset:0
    buffer_load_dwordx4 v11, s[20:23], s37 offen offset:3072 lds
    s_waitcnt lgkmcnt(7)
    v_mfma_f32_16x16x32_bf16 v[96:99], a[232:235], a[56:59], v[96:99]
    ds_read_b64_tr_b16 a[198:199], v245 offset:14336
    v_mfma_f32_16x16x32_bf16 v[100:103], a[232:235], a[60:63], v[100:103]
    ds_read_b64_tr_b16 a[200:201], v246 offset:0
    s_add_u32 m0, s45, 36864
    v_mfma_f32_16x16x32_bf16 v[108:111], a[236:239], a[60:63], v[108:111]
    ds_read_b64_tr_b16 a[202:203], v246 offset:14336
    s_nop 0
    buffer_load_dwordx4 v12, s[20:23], s37 offen offset:0 lds
    v_mfma_f32_16x16x32_bf16 v[104:107], a[236:239], a[56:59], v[104:107]
    ds_read_b64_tr_b16 a[204:205], v247 offset:0
    v_mfma_f32_16x16x32_bf16 v[112:115], a[240:243], a[56:59], v[112:115]
    ds_read_b64_tr_b16 a[206:207], v247 offset:14336
    buffer_load_dwordx4 v13, s[20:23], s37 offen offset:1024 lds
    v_mfma_f32_16x16x32_bf16 v[116:119], a[240:243], a[60:63], v[116:119]
    ds_read_b64_tr_b16 a[208:209], v244 offset:128
    v_mfma_f32_16x16x32_bf16 v[124:127], a[244:247], a[60:63], v[124:127]
    ds_read_b64_tr_b16 a[210:211], v244 offset:14464
    buffer_load_dwordx4 v14, s[20:23], s37 offen offset:2048 lds
    v_mfma_f32_16x16x32_bf16 v[120:123], a[244:247], a[56:59], v[120:123]
    ds_read_b64_tr_b16 a[212:213], v245 offset:128
    s_waitcnt lgkmcnt(11)
    v_mfma_f32_16x16x32_bf16 v[128:131], a[248:251], a[56:59], v[128:131]
    ds_read_b64_tr_b16 a[214:215], v245 offset:14464
    s_add_u32 s37, s37, 28672
    v_mfma_f32_16x16x32_bf16 v[132:135], a[248:251], a[60:63], v[132:135]
    ds_read_b64_tr_b16 a[216:217], v246 offset:128
    v_mfma_f32_16x16x32_bf16 v[140:143], a[252:255], a[60:63], v[140:143]
    ds_read_b64_tr_b16 a[218:219], v246 offset:14464
    v_mfma_f32_16x16x32_bf16 v[136:139], a[252:255], a[56:59], v[136:139]
    ds_read_b64_tr_b16 a[220:221], v247 offset:128
    s_waitcnt lgkmcnt(7)
    v_mfma_f32_16x16x32_bf16 v[32:35], a[192:195], a[64:67], v[32:35]
    ds_read_b64_tr_b16 a[222:223], v247 offset:14464
    v_mfma_f32_16x16x32_bf16 v[36:39], a[192:195], a[68:71], v[36:39]
    ds_read_b64_tr_b16 a[224:225], v244 offset:256
    v_mfma_f32_16x16x32_bf16 v[44:47], a[196:199], a[68:71], v[44:47]
    ds_read_b64_tr_b16 a[226:227], v244 offset:14592
    v_mfma_f32_16x16x32_bf16 v[40:43], a[196:199], a[64:67], v[40:43]
    ds_read_b64_tr_b16 a[228:229], v245 offset:256
    v_mfma_f32_16x16x32_bf16 v[48:51], a[200:203], a[64:67], v[48:51]
    ds_read_b64_tr_b16 a[230:231], v245 offset:14592
    v_mfma_f32_16x16x32_bf16 v[52:55], a[200:203], a[68:71], v[52:55]
    ds_read_b64_tr_b16 a[232:233], v246 offset:256
    v_mfma_f32_16x16x32_bf16 v[60:63], a[204:207], a[68:71], v[60:63]
    ds_read_b64_tr_b16 a[234:235], v246 offset:14592
    v_mfma_f32_16x16x32_bf16 v[56:59], a[204:207], a[64:67], v[56:59]
    ds_read_b64_tr_b16 a[236:237], v247 offset:256
    s_waitcnt vmcnt(14)
    s_barrier
    s_waitcnt lgkmcnt(7)
    v_mfma_f32_16x16x32_bf16 v[64:67], a[208:211], a[64:67], v[64:67]
    ds_read_b64_tr_b16 a[238:239], v247 offset:14592
    v_mfma_f32_16x16x32_bf16 v[68:71], a[208:211], a[68:71], v[68:71]
    ds_read_b64_tr_b16 a[240:241], v244 offset:384
    s_add_u32 m0, s45, 131072
    s_nop 0
    buffer_load_dwordx4 v8, s[20:23], s37 offen offset:0 lds
    v_mfma_f32_16x16x32_bf16 v[76:79], a[212:215], a[68:71], v[76:79]
    ds_read_b64_tr_b16 a[242:243], v244 offset:14720
    v_mfma_f32_16x16x32_bf16 v[72:75], a[212:215], a[64:67], v[72:75]
    ds_read_b64_tr_b16 a[244:245], v245 offset:384
    buffer_load_dwordx4 v9, s[20:23], s37 offen offset:1024 lds
    v_mfma_f32_16x16x32_bf16 v[80:83], a[216:219], a[64:67], v[80:83]
    ds_read_b64_tr_b16 a[246:247], v245 offset:14720
    v_mfma_f32_16x16x32_bf16 v[84:87], a[216:219], a[68:71], v[84:87]
    ds_read_b64_tr_b16 a[248:249], v244 offset:32768
    buffer_load_dwordx4 v10, s[20:23], s37 offen offset:2048 lds
    v_mfma_f32_16x16x32_bf16 v[92:95], a[220:223], a[68:71], v[92:95]
    ds_read_b64_tr_b16 a[250:251], v244 offset:47104
    v_mfma_f32_16x16x32_bf16 v[88:91], a[220:223], a[64:67], v[88:91]
    ds_read_b64_tr_b16 a[252:253], v245 offset:32768
    buffer_load_dwordx4 v11, s[20:23], s37 offen offset:3072 lds
    s_waitcnt lgkmcnt(7)
    v_mfma_f32_16x16x32_bf16 v[96:99], a[224:227], a[64:67], v[96:99]
    ds_read_b64_tr_b16 a[254:255], v245 offset:47104
    v_mfma_f32_16x16x32_bf16 v[100:103], a[224:227], a[68:71], v[100:103]
    ds_read_b64_tr_b16 a[192:193], v246 offset:32768
    s_add_u32 m0, s45, 135168
    v_mfma_f32_16x16x32_bf16 v[108:111], a[228:231], a[68:71], v[108:111]
    ds_read_b64_tr_b16 a[194:195], v246 offset:47104
    s_nop 0
    buffer_load_dwordx4 v12, s[20:23], s37 offen offset:0 lds
    v_mfma_f32_16x16x32_bf16 v[104:107], a[228:231], a[64:67], v[104:107]
    ds_read_b64_tr_b16 a[196:197], v247 offset:32768
    v_mfma_f32_16x16x32_bf16 v[112:115], a[232:235], a[64:67], v[112:115]
    ds_read_b64_tr_b16 a[198:199], v247 offset:47104
    buffer_load_dwordx4 v13, s[20:23], s37 offen offset:1024 lds
    v_mfma_f32_16x16x32_bf16 v[116:119], a[232:235], a[68:71], v[116:119]
    ds_read_b64_tr_b16 a[200:201], v244 offset:32896
    v_mfma_f32_16x16x32_bf16 v[124:127], a[236:239], a[68:71], v[124:127]
    ds_read_b64_tr_b16 a[202:203], v244 offset:47232
    buffer_load_dwordx4 v14, s[20:23], s37 offen offset:2048 lds
    v_mfma_f32_16x16x32_bf16 v[120:123], a[236:239], a[64:67], v[120:123]
    ds_read_b64_tr_b16 a[204:205], v245 offset:32896
    s_waitcnt lgkmcnt(11)
    v_mfma_f32_16x16x32_bf16 v[128:131], a[240:243], a[64:67], v[128:131]
    ds_read_b64_tr_b16 a[206:207], v245 offset:47232
    s_add_u32 s37, s37, 28672
    v_mfma_f32_16x16x32_bf16 v[132:135], a[240:243], a[68:71], v[132:135]
    ds_read_b64_tr_b16 a[208:209], v246 offset:32896
    v_mfma_f32_16x16x32_bf16 v[140:143], a[244:247], a[68:71], v[140:143]
    ds_read_b64_tr_b16 a[210:211], v246 offset:47232
    v_mfma_f32_16x16x32_bf16 v[136:139], a[244:247], a[64:67], v[136:139]
    ds_read_b64_tr_b16 a[212:213], v247 offset:32896
    s_waitcnt lgkmcnt(7)
    v_mfma_f32_16x16x32_bf16 v[32:35], a[248:251], a[72:75], v[32:35]
    ds_read_b64_tr_b16 a[214:215], v247 offset:47232
    v_mfma_f32_16x16x32_bf16 v[36:39], a[248:251], a[76:79], v[36:39]
    ds_read_b64_tr_b16 a[216:217], v244 offset:33024
    v_mfma_f32_16x16x32_bf16 v[44:47], a[252:255], a[76:79], v[44:47]
    ds_read_b64_tr_b16 a[218:219], v244 offset:47360
    v_mfma_f32_16x16x32_bf16 v[40:43], a[252:255], a[72:75], v[40:43]
    ds_read_b64_tr_b16 a[220:221], v245 offset:33024
    v_mfma_f32_16x16x32_bf16 v[48:51], a[192:195], a[72:75], v[48:51]
    ds_read_b64_tr_b16 a[222:223], v245 offset:47360
    v_mfma_f32_16x16x32_bf16 v[52:55], a[192:195], a[76:79], v[52:55]
    ds_read_b64_tr_b16 a[224:225], v246 offset:33024
    v_mfma_f32_16x16x32_bf16 v[60:63], a[196:199], a[76:79], v[60:63]
    ds_read_b64_tr_b16 a[226:227], v246 offset:47360
    v_mfma_f32_16x16x32_bf16 v[56:59], a[196:199], a[72:75], v[56:59]
    ds_read_b64_tr_b16 a[228:229], v247 offset:33024
    s_waitcnt vmcnt(14)
    s_barrier
    s_waitcnt lgkmcnt(7)
    v_mfma_f32_16x16x32_bf16 v[64:67], a[200:203], a[72:75], v[64:67]
    ds_read_b64_tr_b16 a[230:231], v247 offset:47360
    v_mfma_f32_16x16x32_bf16 v[68:71], a[200:203], a[76:79], v[68:71]
    ds_read_b64_tr_b16 a[232:233], v244 offset:33152
    s_add_u32 m0, s45, 65536
    s_nop 0
    buffer_load_dwordx4 v8, s[20:23], s37 offen offset:0 lds
    v_mfma_f32_16x16x32_bf16 v[76:79], a[204:207], a[76:79], v[76:79]
    ds_read_b64_tr_b16 a[234:235], v244 offset:47488
    v_mfma_f32_16x16x32_bf16 v[72:75], a[204:207], a[72:75], v[72:75]
    ds_read_b64_tr_b16 a[236:237], v245 offset:33152
    buffer_load_dwordx4 v9, s[20:23], s37 offen offset:1024 lds
    v_mfma_f32_16x16x32_bf16 v[80:83], a[208:211], a[72:75], v[80:83]
    ds_read_b64_tr_b16 a[238:239], v245 offset:47488
    v_mfma_f32_16x16x32_bf16 v[84:87], a[208:211], a[76:79], v[84:87]
    ds_read_b64_tr_b16 a[240:241], v240 offset:0
    buffer_load_dwordx4 v10, s[20:23], s37 offen offset:2048 lds
    v_mfma_f32_16x16x32_bf16 v[92:95], a[212:215], a[76:79], v[92:95]
    ds_read_b64_tr_b16 a[242:243], v240 offset:14336
    v_mfma_f32_16x16x32_bf16 v[88:91], a[212:215], a[72:75], v[88:91]
    ds_read_b64_tr_b16 a[244:245], v241 offset:0
    buffer_load_dwordx4 v11, s[20:23], s37 offen offset:3072 lds
    s_waitcnt lgkmcnt(7)
    v_mfma_f32_16x16x32_bf16 v[96:99], a[216:219], a[72:75], v[96:99]
    ds_read_b64_tr_b16 a[246:247], v241 offset:14336
    v_mfma_f32_16x16x32_bf16 v[100:103], a[216:219], a[76:79], v[100:103]
    ds_read_b64_tr_b16 a[248:249], v242 offset:0
    s_add_u32 m0, s45, 69632
    v_mfma_f32_16x16x32_bf16 v[108:111], a[220:223], a[76:79], v[108:111]
    ds_read_b64_tr_b16 a[250:251], v242 offset:14336
    s_nop 0
    buffer_load_dwordx4 v12, s[20:23], s37 offen offset:0 lds
    v_mfma_f32_16x16x32_bf16 v[104:107], a[220:223], a[72:75], v[104:107]
    ds_read_b64_tr_b16 a[252:253], v243 offset:0
    v_mfma_f32_16x16x32_bf16 v[112:115], a[224:227], a[72:75], v[112:115]
    ds_read_b64_tr_b16 a[254:255], v243 offset:14336
    buffer_load_dwordx4 v13, s[20:23], s37 offen offset:1024 lds
    v_mfma_f32_16x16x32_bf16 v[116:119], a[224:227], a[76:79], v[116:119]
    ds_read_b64_tr_b16 a[192:193], v240 offset:128
    v_mfma_f32_16x16x32_bf16 v[124:127], a[228:231], a[76:79], v[124:127]
    ds_read_b64_tr_b16 a[194:195], v240 offset:14464
    buffer_load_dwordx4 v14, s[20:23], s37 offen offset:2048 lds
    v_mfma_f32_16x16x32_bf16 v[120:123], a[228:231], a[72:75], v[120:123]
    ds_read_b64_tr_b16 a[196:197], v241 offset:128
    s_waitcnt lgkmcnt(11)
    v_mfma_f32_16x16x32_bf16 v[128:131], a[232:235], a[72:75], v[128:131]
    ds_read_b64_tr_b16 a[198:199], v241 offset:14464
    s_add_u32 s37, s37, 28672
    v_mfma_f32_16x16x32_bf16 v[132:135], a[232:235], a[76:79], v[132:135]
    ds_read_b64_tr_b16 a[200:201], v242 offset:128
    v_mfma_f32_16x16x32_bf16 v[140:143], a[236:239], a[76:79], v[140:143]
    ds_read_b64_tr_b16 a[202:203], v242 offset:14464
    v_mfma_f32_16x16x32_bf16 v[136:139], a[236:239], a[72:75], v[136:139]
    ds_read_b64_tr_b16 a[204:205], v243 offset:128
    s_waitcnt lgkmcnt(7)
    v_mfma_f32_16x16x32_bf16 v[32:35], a[240:243], a[80:83], v[32:35]
    ds_read_b64_tr_b16 a[206:207], v243 offset:14464
    v_mfma_f32_16x16x32_bf16 v[36:39], a[240:243], a[84:87], v[36:39]
    ds_read_b64_tr_b16 a[208:209], v240 offset:256
    v_mfma_f32_16x16x32_bf16 v[44:47], a[244:247], a[84:87], v[44:47]
    ds_read_b64_tr_b16 a[210:211], v240 offset:14592
    v_mfma_f32_16x16x32_bf16 v[40:43], a[244:247], a[80:83], v[40:43]
    ds_read_b64_tr_b16 a[212:213], v241 offset:256
    v_mfma_f32_16x16x32_bf16 v[48:51], a[248:251], a[80:83], v[48:51]
    ds_read_b64_tr_b16 a[214:215], v241 offset:14592
    v_mfma_f32_16x16x32_bf16 v[52:55], a[248:251], a[84:87], v[52:55]
    ds_read_b64_tr_b16 a[216:217], v242 offset:256
    v_mfma_f32_16x16x32_bf16 v[60:63], a[252:255], a[84:87], v[60:63]
    ds_read_b64_tr_b16 a[218:219], v242 offset:14592
    v_mfma_f32_16x16x32_bf16 v[56:59], a[252:255], a[80:83], v[56:59]
    ds_read_b64_tr_b16 a[220:221], v243 offset:256
    s_waitcnt vmcnt(14)
    s_barrier
    s_waitcnt lgkmcnt(7)
    v_mfma_f32_16x16x32_bf16 v[64:67], a[192:195], a[80:83], v[64:67]
    ds_read_b64_tr_b16 a[222:223], v243 offset:14592
    v_mfma_f32_16x16x32_bf16 v[68:71], a[192:195], a[84:87], v[68:71]
    ds_read_b64_tr_b16 a[224:225], v240 offset:384
    s_add_u32 m0, s45, 98304
    s_nop 0
    buffer_load_dwordx4 v8, s[20:23], s37 offen offset:0 lds
    v_mfma_f32_16x16x32_bf16 v[76:79], a[196:199], a[84:87], v[76:79]
    ds_read_b64_tr_b16 a[226:227], v240 offset:14720
    v_mfma_f32_16x16x32_bf16 v[72:75], a[196:199], a[80:83], v[72:75]
    ds_read_b64_tr_b16 a[228:229], v241 offset:384
    buffer_load_dwordx4 v9, s[20:23], s37 offen offset:1024 lds
    v_mfma_f32_16x16x32_bf16 v[80:83], a[200:203], a[80:83], v[80:83]
    ds_read_b64_tr_b16 a[230:231], v241 offset:14720
    v_mfma_f32_16x16x32_bf16 v[84:87], a[200:203], a[84:87], v[84:87]
    ds_read_b64_tr_b16 a[232:233], v240 offset:32768
    buffer_load_dwordx4 v10, s[20:23], s37 offen offset:2048 lds
    v_mfma_f32_16x16x32_bf16 v[92:95], a[204:207], a[84:87], v[92:95]
    ds_read_b64_tr_b16 a[234:235], v240 offset:47104
    v_mfma_f32_16x16x32_bf16 v[88:91], a[204:207], a[80:83], v[88:91]
    ds_read_b64_tr_b16 a[236:237], v241 offset:32768
    buffer_load_dwordx4 v11, s[20:23], s37 offen offset:3072 lds
    s_waitcnt lgkmcnt(7)
    v_mfma_f32_16x16x32_bf16 v[96:99], a[208:211], a[80:83], v[96:99]
    ds_read_b64_tr_b16 a[238:239], v241 offset:47104
    v_mfma_f32_16x16x32_bf16 v[100:103], a[208:211], a[84:87], v[100:103]
    ds_read_b64_tr_b16 a[240:241], v242 offset:32768
    s_add_u32 m0, s45, 102400
    v_mfma_f32_16x16x32_bf16 v[108:111], a[212:215], a[84:87], v[108:111]
    ds_read_b64_tr_b16 a[242:243], v242 offset:47104
    s_nop 0
    buffer_load_dwordx4 v12, s[20:23], s37 offen offset:0 lds
    v_mfma_f32_16x16x32_bf16 v[104:107], a[212:215], a[80:83], v[104:107]
    ds_read_b64_tr_b16 a[244:245], v243 offset:32768
    v_mfma_f32_16x16x32_bf16 v[112:115], a[216:219], a[80:83], v[112:115]
    ds_read_b64_tr_b16 a[246:247], v243 offset:47104
    buffer_load_dwordx4 v13, s[20:23], s37 offen offset:1024 lds
    v_mfma_f32_16x16x32_bf16 v[116:119], a[216:219], a[84:87], v[116:119]
    ds_read_b64_tr_b16 a[248:249], v240 offset:32896
    v_mfma_f32_16x16x32_bf16 v[124:127], a[220:223], a[84:87], v[124:127]
    ds_read_b64_tr_b16 a[250:251], v240 offset:47232
    buffer_load_dwordx4 v14, s[20:23], s37 offen offset:2048 lds
    v_mfma_f32_16x16x32_bf16 v[120:123], a[220:223], a[80:83], v[120:123]
    ds_read_b64_tr_b16 a[252:253], v241 offset:32896
    s_waitcnt lgkmcnt(11)
    v_mfma_f32_16x16x32_bf16 v[128:131], a[224:227], a[80:83], v[128:131]
    ds_read_b64_tr_b16 a[254:255], v241 offset:47232
    s_add_u32 s37, s37, 28672
    v_mfma_f32_16x16x32_bf16 v[132:135], a[224:227], a[84:87], v[132:135]
    ds_read_b64_tr_b16 a[192:193], v242 offset:32896
    v_mfma_f32_16x16x32_bf16 v[140:143], a[228:231], a[84:87], v[140:143]
    ds_read_b64_tr_b16 a[194:195], v242 offset:47232
    v_mfma_f32_16x16x32_bf16 v[136:139], a[228:231], a[80:83], v[136:139]
    ds_read_b64_tr_b16 a[196:197], v243 offset:32896
    s_waitcnt lgkmcnt(7)
    v_mfma_f32_16x16x32_bf16 v[32:35], a[232:235], a[88:91], v[32:35]
    ds_read_b64_tr_b16 a[198:199], v243 offset:47232
    v_mfma_f32_16x16x32_bf16 v[36:39], a[232:235], a[92:95], v[36:39]
    ds_read_b64_tr_b16 a[200:201], v240 offset:33024
    v_mfma_f32_16x16x32_bf16 v[44:47], a[236:239], a[92:95], v[44:47]
    ds_read_b64_tr_b16 a[202:203], v240 offset:47360
    v_mfma_f32_16x16x32_bf16 v[40:43], a[236:239], a[88:91], v[40:43]
    ds_read_b64_tr_b16 a[204:205], v241 offset:33024
    v_mfma_f32_16x16x32_bf16 v[48:51], a[240:243], a[88:91], v[48:51]
    ds_read_b64_tr_b16 a[206:207], v241 offset:47360
    v_mfma_f32_16x16x32_bf16 v[52:55], a[240:243], a[92:95], v[52:55]
    ds_read_b64_tr_b16 a[208:209], v242 offset:33024
    v_mfma_f32_16x16x32_bf16 v[60:63], a[244:247], a[92:95], v[60:63]
    ds_read_b64_tr_b16 a[210:211], v242 offset:47360
    v_mfma_f32_16x16x32_bf16 v[56:59], a[244:247], a[88:91], v[56:59]
    ds_read_b64_tr_b16 a[212:213], v243 offset:33024
    s_waitcnt vmcnt(14)
    s_barrier
    s_waitcnt lgkmcnt(7)
    v_mfma_f32_16x16x32_bf16 v[64:67], a[248:251], a[88:91], v[64:67]
    ds_read_b64_tr_b16 a[214:215], v243 offset:47360
    v_mfma_f32_16x16x32_bf16 v[68:71], a[248:251], a[92:95], v[68:71]
    ds_read_b64_tr_b16 a[216:217], v240 offset:33152
    s_add_u32 m0, s45, 0
    s_nop 0
    buffer_load_dwordx4 v8, s[20:23], s37 offen offset:0 lds
    v_mfma_f32_16x16x32_bf16 v[76:79], a[252:255], a[92:95], v[76:79]
    ds_read_b64_tr_b16 a[218:219], v240 offset:47488
    v_mfma_f32_16x16x32_bf16 v[72:75], a[252:255], a[88:91], v[72:75]
    ds_read_b64_tr_b16 a[220:221], v241 offset:33152
    buffer_load_dwordx4 v9, s[20:23], s37 offen offset:1024 lds
    v_mfma_f32_16x16x32_bf16 v[80:83], a[192:195], a[88:91], v[80:83]
    ds_read_b64_tr_b16 a[222:223], v241 offset:47488
    v_mfma_f32_16x16x32_bf16 v[84:87], a[192:195], a[92:95], v[84:87]
    ds_read_b64_tr_b16 a[224:225], v248 offset:0
    buffer_load_dwordx4 v10, s[20:23], s37 offen offset:2048 lds
    v_mfma_f32_16x16x32_bf16 v[92:95], a[196:199], a[92:95], v[92:95]
    ds_read_b64_tr_b16 a[226:227], v248 offset:14336
    v_mfma_f32_16x16x32_bf16 v[88:91], a[196:199], a[88:91], v[88:91]
    ds_read_b64_tr_b16 a[228:229], v249 offset:0
    buffer_load_dwordx4 v11, s[20:23], s37 offen offset:3072 lds
    s_waitcnt lgkmcnt(7)
    v_mfma_f32_16x16x32_bf16 v[96:99], a[200:203], a[88:91], v[96:99]
    ds_read_b64_tr_b16 a[230:231], v249 offset:14336
    v_mfma_f32_16x16x32_bf16 v[100:103], a[200:203], a[92:95], v[100:103]
    ds_read_b64_tr_b16 a[232:233], v250 offset:0
    s_add_u32 m0, s45, 4096
    v_mfma_f32_16x16x32_bf16 v[108:111], a[204:207], a[92:95], v[108:111]
    ds_read_b64_tr_b16 a[234:235], v250 offset:14336
    s_nop 0
    buffer_load_dwordx4 v12, s[20:23], s37 offen offset:0 lds
    v_mfma_f32_16x16x32_bf16 v[104:107], a[204:207], a[88:91], v[104:107]
    ds_read_b64_tr_b16 a[236:237], v251 offset:0
    v_mfma_f32_16x16x32_bf16 v[112:115], a[208:211], a[88:91], v[112:115]
    ds_read_b64_tr_b16 a[238:239], v251 offset:14336
    buffer_load_dwordx4 v13, s[20:23], s37 offen offset:1024 lds
    v_mfma_f32_16x16x32_bf16 v[116:119], a[208:211], a[92:95], v[116:119]
    ds_read_b64_tr_b16 a[240:241], v248 offset:128
    v_mfma_f32_16x16x32_bf16 v[124:127], a[212:215], a[92:95], v[124:127]
    ds_read_b64_tr_b16 a[242:243], v248 offset:14464
    buffer_load_dwordx4 v14, s[20:23], s37 offen offset:2048 lds
    v_mfma_f32_16x16x32_bf16 v[120:123], a[212:215], a[88:91], v[120:123]
    ds_read_b64_tr_b16 a[244:245], v249 offset:128
    s_waitcnt lgkmcnt(11)
    v_mfma_f32_16x16x32_bf16 v[128:131], a[216:219], a[88:91], v[128:131]
    ds_read_b64_tr_b16 a[246:247], v249 offset:14464
    s_add_u32 s37, s37, 28672
    v_mfma_f32_16x16x32_bf16 v[132:135], a[216:219], a[92:95], v[132:135]
    ds_read_b64_tr_b16 a[248:249], v250 offset:128
    v_mfma_f32_16x16x32_bf16 v[140:143], a[220:223], a[92:95], v[140:143]
    ds_read_b64_tr_b16 a[250:251], v250 offset:14464
    v_mfma_f32_16x16x32_bf16 v[136:139], a[220:223], a[88:91], v[136:139]
    ds_read_b64_tr_b16 a[252:253], v251 offset:128
    s_waitcnt lgkmcnt(7)
    v_mfma_f32_16x16x32_bf16 v[32:35], a[224:227], a[96:99], v[32:35]
    ds_read_b64_tr_b16 a[254:255], v251 offset:14464
    v_mfma_f32_16x16x32_bf16 v[36:39], a[224:227], a[100:103], v[36:39]
    ds_read_b64_tr_b16 a[192:193], v248 offset:256
    v_mfma_f32_16x16x32_bf16 v[44:47], a[228:231], a[100:103], v[44:47]
    ds_read_b64_tr_b16 a[194:195], v248 offset:14592
    v_mfma_f32_16x16x32_bf16 v[40:43], a[228:231], a[96:99], v[40:43]
    ds_read_b64_tr_b16 a[196:197], v249 offset:256
    v_mfma_f32_16x16x32_bf16 v[48:51], a[232:235], a[96:99], v[48:51]
    ds_read_b64_tr_b16 a[198:199], v249 offset:14592
    v_mfma_f32_16x16x32_bf16 v[52:55], a[232:235], a[100:103], v[52:55]
    ds_read_b64_tr_b16 a[200:201], v250 offset:256
    v_mfma_f32_16x16x32_bf16 v[60:63], a[236:239], a[100:103], v[60:63]
    ds_read_b64_tr_b16 a[202:203], v250 offset:14592
    v_mfma_f32_16x16x32_bf16 v[56:59], a[236:239], a[96:99], v[56:59]
    ds_read_b64_tr_b16 a[204:205], v251 offset:256
    s_waitcnt vmcnt(14)
    s_barrier
    s_waitcnt lgkmcnt(7)
    v_mfma_f32_16x16x32_bf16 v[64:67], a[240:243], a[96:99], v[64:67]
    ds_read_b64_tr_b16 a[206:207], v251 offset:14592
    v_mfma_f32_16x16x32_bf16 v[68:71], a[240:243], a[100:103], v[68:71]
    ds_read_b64_tr_b16 a[208:209], v248 offset:384
    v_mfma_f32_16x16x32_bf16 v[76:79], a[244:247], a[100:103], v[76:79]
    ds_read_b64_tr_b16 a[210:211], v248 offset:14720
    v_mfma_f32_16x16x32_bf16 v[72:75], a[244:247], a[96:99], v[72:75]
    ds_read_b64_tr_b16 a[212:213], v249 offset:384
    v_mfma_f32_16x16x32_bf16 v[80:83], a[248:251], a[96:99], v[80:83]
    ds_read_b64_tr_b16 a[214:215], v249 offset:14720
    v_mfma_f32_16x16x32_bf16 v[84:87], a[248:251], a[100:103], v[84:87]
    ds_read_b64_tr_b16 a[216:217], v244 offset:0
    v_mfma_f32_16x16x32_bf16 v[92:95], a[252:255], a[100:103], v[92:95]
    ds_read_b64_tr_b16 a[218:219], v244 offset:14336
    v_mfma_f32_16x16x32_bf16 v[88:91], a[252:255], a[96:99], v[88:91]
    ds_read_b64_tr_b16 a[220:221], v245 offset:0
    s_waitcnt lgkmcnt(7)
    v_mfma_f32_16x16x32_bf16 v[96:99], a[192:195], a[96:99], v[96:99]
    ds_read_b64_tr_b16 a[222:223], v245 offset:14336
    v_mfma_f32_16x16x32_bf16 v[100:103], a[192:195], a[100:103], v[100:103]
    ds_read_b64_tr_b16 a[224:225], v246 offset:0
    v_mfma_f32_16x16x32_bf16 v[108:111], a[196:199], a[100:103], v[108:111]
    ds_read_b64_tr_b16 a[226:227], v246 offset:14336
    v_mfma_f32_16x16x32_bf16 v[104:107], a[196:199], a[96:99], v[104:107]
    ds_read_b64_tr_b16 a[228:229], v247 offset:0
    v_mfma_f32_16x16x32_bf16 v[112:115], a[200:203], a[96:99], v[112:115]
    ds_read_b64_tr_b16 a[230:231], v247 offset:14336
    v_mfma_f32_16x16x32_bf16 v[116:119], a[200:203], a[100:103], v[116:119]
    ds_read_b64_tr_b16 a[232:233], v244 offset:128
    v_mfma_f32_16x16x32_bf16 v[124:127], a[204:207], a[100:103], v[124:127]
    ds_read_b64_tr_b16 a[234:235], v244 offset:14464
    v_mfma_f32_16x16x32_bf16 v[120:123], a[204:207], a[96:99], v[120:123]
    ds_read_b64_tr_b16 a[236:237], v245 offset:128
    s_waitcnt lgkmcnt(11)
    v_mfma_f32_16x16x32_bf16 v[128:131], a[208:211], a[96:99], v[128:131]
    ds_read_b64_tr_b16 a[238:239], v245 offset:14464
    v_mfma_f32_16x16x32_bf16 v[132:135], a[208:211], a[100:103], v[132:135]
    ds_read_b64_tr_b16 a[240:241], v246 offset:128
    v_mfma_f32_16x16x32_bf16 v[140:143], a[212:215], a[100:103], v[140:143]
    ds_read_b64_tr_b16 a[242:243], v246 offset:14464
    v_mfma_f32_16x16x32_bf16 v[136:139], a[212:215], a[96:99], v[136:139]
    ds_read_b64_tr_b16 a[244:245], v247 offset:128
    s_waitcnt lgkmcnt(7)
    v_mfma_f32_16x16x32_bf16 v[32:35], a[216:219], a[104:107], v[32:35]
    ds_read_b64_tr_b16 a[246:247], v247 offset:14464
    v_mfma_f32_16x16x32_bf16 v[36:39], a[216:219], a[108:111], v[36:39]
    ds_read_b64_tr_b16 a[248:249], v244 offset:256
    v_mfma_f32_16x16x32_bf16 v[44:47], a[220:223], a[108:111], v[44:47]
    ds_read_b64_tr_b16 a[250:251], v244 offset:14592
    v_mfma_f32_16x16x32_bf16 v[40:43], a[220:223], a[104:107], v[40:43]
    ds_read_b64_tr_b16 a[252:253], v245 offset:256
    v_mfma_f32_16x16x32_bf16 v[48:51], a[224:227], a[104:107], v[48:51]
    ds_read_b64_tr_b16 a[254:255], v245 offset:14592
    v_mfma_f32_16x16x32_bf16 v[52:55], a[224:227], a[108:111], v[52:55]
    ds_read_b64_tr_b16 a[192:193], v246 offset:256
    v_mfma_f32_16x16x32_bf16 v[60:63], a[228:231], a[108:111], v[60:63]
    ds_read_b64_tr_b16 a[194:195], v246 offset:14592
    v_mfma_f32_16x16x32_bf16 v[56:59], a[228:231], a[104:107], v[56:59]
    ds_read_b64_tr_b16 a[196:197], v247 offset:256
    s_waitcnt vmcnt(7)
    s_barrier
    s_waitcnt lgkmcnt(7)
    v_mfma_f32_16x16x32_bf16 v[64:67], a[232:235], a[104:107], v[64:67]
    ds_read_b64_tr_b16 a[198:199], v247 offset:14592
    v_mfma_f32_16x16x32_bf16 v[68:71], a[232:235], a[108:111], v[68:71]
    ds_read_b64_tr_b16 a[200:201], v244 offset:384
    v_mfma_f32_16x16x32_bf16 v[76:79], a[236:239], a[108:111], v[76:79]
    ds_read_b64_tr_b16 a[202:203], v244 offset:14720
    v_mfma_f32_16x16x32_bf16 v[72:75], a[236:239], a[104:107], v[72:75]
    ds_read_b64_tr_b16 a[204:205], v245 offset:384
    v_mfma_f32_16x16x32_bf16 v[80:83], a[240:243], a[104:107], v[80:83]
    ds_read_b64_tr_b16 a[206:207], v245 offset:14720
    v_mfma_f32_16x16x32_bf16 v[84:87], a[240:243], a[108:111], v[84:87]
    ds_read_b64_tr_b16 a[208:209], v244 offset:32768
    v_mfma_f32_16x16x32_bf16 v[92:95], a[244:247], a[108:111], v[92:95]
    ds_read_b64_tr_b16 a[210:211], v244 offset:47104
    v_mfma_f32_16x16x32_bf16 v[88:91], a[244:247], a[104:107], v[88:91]
    ds_read_b64_tr_b16 a[212:213], v245 offset:32768
    s_waitcnt lgkmcnt(7)
    v_mfma_f32_16x16x32_bf16 v[96:99], a[248:251], a[104:107], v[96:99]
    ds_read_b64_tr_b16 a[214:215], v245 offset:47104
    v_mfma_f32_16x16x32_bf16 v[100:103], a[248:251], a[108:111], v[100:103]
    ds_read_b64_tr_b16 a[216:217], v246 offset:32768
    v_mfma_f32_16x16x32_bf16 v[108:111], a[252:255], a[108:111], v[108:111]
    ds_read_b64_tr_b16 a[218:219], v246 offset:47104
    v_mfma_f32_16x16x32_bf16 v[104:107], a[252:255], a[104:107], v[104:107]
    ds_read_b64_tr_b16 a[220:221], v247 offset:32768
    v_mfma_f32_16x16x32_bf16 v[112:115], a[192:195], a[104:107], v[112:115]
    ds_read_b64_tr_b16 a[222:223], v247 offset:47104
    v_mfma_f32_16x16x32_bf16 v[116:119], a[192:195], a[108:111], v[116:119]
    ds_read_b64_tr_b16 a[224:225], v244 offset:32896
    v_mfma_f32_16x16x32_bf16 v[124:127], a[196:199], a[108:111], v[124:127]
    ds_read_b64_tr_b16 a[226:227], v244 offset:47232
    v_mfma_f32_16x16x32_bf16 v[120:123], a[196:199], a[104:107], v[120:123]
    ds_read_b64_tr_b16 a[228:229], v245 offset:32896
    s_waitcnt lgkmcnt(11)
    v_mfma_f32_16x16x32_bf16 v[128:131], a[200:203], a[104:107], v[128:131]
    ds_read_b64_tr_b16 a[230:231], v245 offset:47232
    v_mfma_f32_16x16x32_bf16 v[132:135], a[200:203], a[108:111], v[132:135]
    ds_read_b64_tr_b16 a[232:233], v246 offset:32896
    v_mfma_f32_16x16x32_bf16 v[140:143], a[204:207], a[108:111], v[140:143]
    ds_read_b64_tr_b16 a[234:235], v246 offset:47232
    v_mfma_f32_16x16x32_bf16 v[136:139], a[204:207], a[104:107], v[136:139]
    ds_read_b64_tr_b16 a[236:237], v247 offset:32896
    s_waitcnt lgkmcnt(7)
    v_mfma_f32_16x16x32_bf16 v[32:35], a[208:211], a[112:115], v[32:35]
    ds_read_b64_tr_b16 a[238:239], v247 offset:47232
    v_mfma_f32_16x16x32_bf16 v[36:39], a[208:211], a[116:119], v[36:39]
    ds_read_b64_tr_b16 a[240:241], v244 offset:33024
    v_mfma_f32_16x16x32_bf16 v[44:47], a[212:215], a[116:119], v[44:47]
    ds_read_b64_tr_b16 a[242:243], v244 offset:47360
    v_mfma_f32_16x16x32_bf16 v[40:43], a[212:215], a[112:115], v[40:43]
    ds_read_b64_tr_b16 a[244:245], v245 offset:33024
    v_mfma_f32_16x16x32_bf16 v[48:51], a[216:219], a[112:115], v[48:51]
    ds_read_b64_tr_b16 a[246:247], v245 offset:47360
    v_mfma_f32_16x16x32_bf16 v[52:55], a[216:219], a[116:119], v[52:55]
    ds_read_b64_tr_b16 a[248:249], v246 offset:33024
    v_mfma_f32_16x16x32_bf16 v[60:63], a[220:223], a[116:119], v[60:63]
    ds_read_b64_tr_b16 a[250:251], v246 offset:47360
    v_mfma_f32_16x16x32_bf16 v[56:59], a[220:223], a[112:115], v[56:59]
    ds_read_b64_tr_b16 a[252:253], v247 offset:33024
    s_waitcnt vmcnt(0)
    s_barrier
    s_waitcnt lgkmcnt(7)
    v_mfma_f32_16x16x32_bf16 v[64:67], a[224:227], a[112:115], v[64:67]
    ds_read_b64_tr_b16 a[254:255], v247 offset:47360
    v_mfma_f32_16x16x32_bf16 v[68:71], a[224:227], a[116:119], v[68:71]
    ds_read_b64_tr_b16 a[192:193], v244 offset:33152
    v_mfma_f32_16x16x32_bf16 v[76:79], a[228:231], a[116:119], v[76:79]
    ds_read_b64_tr_b16 a[194:195], v244 offset:47488
    v_mfma_f32_16x16x32_bf16 v[72:75], a[228:231], a[112:115], v[72:75]
    ds_read_b64_tr_b16 a[196:197], v245 offset:33152
    v_mfma_f32_16x16x32_bf16 v[80:83], a[232:235], a[112:115], v[80:83]
    ds_read_b64_tr_b16 a[198:199], v245 offset:47488
    v_mfma_f32_16x16x32_bf16 v[84:87], a[232:235], a[116:119], v[84:87]
    ds_read_b64_tr_b16 a[200:201], v240 offset:0
    v_mfma_f32_16x16x32_bf16 v[92:95], a[236:239], a[116:119], v[92:95]
    ds_read_b64_tr_b16 a[202:203], v240 offset:14336
    v_mfma_f32_16x16x32_bf16 v[88:91], a[236:239], a[112:115], v[88:91]
    ds_read_b64_tr_b16 a[204:205], v241 offset:0
    s_waitcnt lgkmcnt(7)
    v_mfma_f32_16x16x32_bf16 v[96:99], a[240:243], a[112:115], v[96:99]
    ds_read_b64_tr_b16 a[206:207], v241 offset:14336
    v_mfma_f32_16x16x32_bf16 v[100:103], a[240:243], a[116:119], v[100:103]
    ds_read_b64_tr_b16 a[208:209], v242 offset:0
    v_mfma_f32_16x16x32_bf16 v[108:111], a[244:247], a[116:119], v[108:111]
    ds_read_b64_tr_b16 a[210:211], v242 offset:14336
    v_mfma_f32_16x16x32_bf16 v[104:107], a[244:247], a[112:115], v[104:107]
    ds_read_b64_tr_b16 a[212:213], v243 offset:0
    v_mfma_f32_16x16x32_bf16 v[112:115], a[248:251], a[112:115], v[112:115]
    ds_read_b64_tr_b16 a[214:215], v243 offset:14336
    v_mfma_f32_16x16x32_bf16 v[116:119], a[248:251], a[116:119], v[116:119]
    ds_read_b64_tr_b16 a[216:217], v240 offset:128
    v_mfma_f32_16x16x32_bf16 v[124:127], a[252:255], a[116:119], v[124:127]
    ds_read_b64_tr_b16 a[218:219], v240 offset:14464
    v_mfma_f32_16x16x32_bf16 v[120:123], a[252:255], a[112:115], v[120:123]
    ds_read_b64_tr_b16 a[220:221], v241 offset:128
    s_waitcnt lgkmcnt(11)
    v_mfma_f32_16x16x32_bf16 v[128:131], a[192:195], a[112:115], v[128:131]
    ds_read_b64_tr_b16 a[222:223], v241 offset:14464
    v_mfma_f32_16x16x32_bf16 v[132:135], a[192:195], a[116:119], v[132:135]
    ds_read_b64_tr_b16 a[224:225], v242 offset:128
    v_mfma_f32_16x16x32_bf16 v[140:143], a[196:199], a[116:119], v[140:143]
    ds_read_b64_tr_b16 a[226:227], v242 offset:14464
    v_mfma_f32_16x16x32_bf16 v[136:139], a[196:199], a[112:115], v[136:139]
    ds_read_b64_tr_b16 a[228:229], v243 offset:128
    s_waitcnt lgkmcnt(7)
    v_mfma_f32_16x16x32_bf16 v[32:35], a[200:203], a[120:123], v[32:35]
    ds_read_b64_tr_b16 a[230:231], v243 offset:14464
    v_mfma_f32_16x16x32_bf16 v[36:39], a[200:203], a[124:127], v[36:39]
    ds_read_b64_tr_b16 a[232:233], v240 offset:256
    v_mfma_f32_16x16x32_bf16 v[44:47], a[204:207], a[124:127], v[44:47]
    ds_read_b64_tr_b16 a[234:235], v240 offset:14592
    v_mfma_f32_16x16x32_bf16 v[40:43], a[204:207], a[120:123], v[40:43]
    ds_read_b64_tr_b16 a[236:237], v241 offset:256
    v_mfma_f32_16x16x32_bf16 v[48:51], a[208:211], a[120:123], v[48:51]
    ds_read_b64_tr_b16 a[238:239], v241 offset:14592
    v_mfma_f32_16x16x32_bf16 v[52:55], a[208:211], a[124:127], v[52:55]
    ds_read_b64_tr_b16 a[240:241], v242 offset:256
    v_mfma_f32_16x16x32_bf16 v[60:63], a[212:215], a[124:127], v[60:63]
    ds_read_b64_tr_b16 a[242:243], v242 offset:14592
    v_mfma_f32_16x16x32_bf16 v[56:59], a[212:215], a[120:123], v[56:59]
    ds_read_b64_tr_b16 a[244:245], v243 offset:256
    s_waitcnt lgkmcnt(7)
    v_mfma_f32_16x16x32_bf16 v[64:67], a[216:219], a[120:123], v[64:67]
    ds_read_b64_tr_b16 a[246:247], v243 offset:14592
    v_mfma_f32_16x16x32_bf16 v[68:71], a[216:219], a[124:127], v[68:71]
    ds_read_b64_tr_b16 a[248:249], v240 offset:384
    v_mfma_f32_16x16x32_bf16 v[76:79], a[220:223], a[124:127], v[76:79]
    ds_read_b64_tr_b16 a[250:251], v240 offset:14720
    v_mfma_f32_16x16x32_bf16 v[72:75], a[220:223], a[120:123], v[72:75]
    ds_read_b64_tr_b16 a[252:253], v241 offset:384
    v_mfma_f32_16x16x32_bf16 v[80:83], a[224:227], a[120:123], v[80:83]
    ds_read_b64_tr_b16 a[254:255], v241 offset:14720
    v_mfma_f32_16x16x32_bf16 v[84:87], a[224:227], a[124:127], v[84:87]
    v_mfma_f32_16x16x32_bf16 v[92:95], a[228:231], a[124:127], v[92:95]
    v_mfma_f32_16x16x32_bf16 v[88:91], a[228:231], a[120:123], v[88:91]
    s_waitcnt lgkmcnt(4)
    v_mfma_f32_16x16x32_bf16 v[96:99], a[232:235], a[120:123], v[96:99]
    v_mfma_f32_16x16x32_bf16 v[100:103], a[232:235], a[124:127], v[100:103]
    v_mfma_f32_16x16x32_bf16 v[108:111], a[236:239], a[124:127], v[108:111]
    v_mfma_f32_16x16x32_bf16 v[104:107], a[236:239], a[120:123], v[104:107]
    v_mfma_f32_16x16x32_bf16 v[112:115], a[240:243], a[120:123], v[112:115]
    v_mfma_f32_16x16x32_bf16 v[116:119], a[240:243], a[124:127], v[116:119]
    v_mfma_f32_16x16x32_bf16 v[124:127], a[244:247], a[124:127], v[124:127]
    v_mfma_f32_16x16x32_bf16 v[120:123], a[244:247], a[120:123], v[120:123]
    s_waitcnt lgkmcnt(0)
    v_mfma_f32_16x16x32_bf16 v[128:131], a[248:251], a[120:123], v[128:131]
    v_mfma_f32_16x16x32_bf16 v[132:135], a[248:251], a[124:127], v[132:135]
    v_mfma_f32_16x16x32_bf16 v[140:143], a[252:255], a[124:127], v[140:143]
    v_mfma_f32_16x16x32_bf16 v[136:139], a[252:255], a[120:123], v[136:139]
    s_lshl_b32 s35, s29, 1
    s_add_u32 s35, s35, s32
    s_mul_i32 s35, s35, 28672
    s_mul_i32 s36, s28, 1835008
    s_add_u32 s35, s35, s36
    s_mul_i32 s36, s31, 14336
    s_add_u32 s35, s35, s36
    s_add_u32 s35, s35, 4194304
    v_lshlrev_b32 v6, 4, v2
    s_nop 15
    v_cvt_pk_bf16_f32 v160, v32, v33
    v_cvt_pk_bf16_f32 v161, v34, v35
    v_cvt_pk_bf16_f32 v162, v36, v37
    v_cvt_pk_bf16_f32 v163, v38, v39
    s_nop 1
    v_permlane16_swap_b32 v160, v162
    v_permlane16_swap_b32 v161, v163
    buffer_store_dwordx4 v[160:163], v6, s[24:27], s35 offen offset:0
    v_cvt_pk_bf16_f32 v164, v40, v41
    v_cvt_pk_bf16_f32 v165, v42, v43
    v_cvt_pk_bf16_f32 v166, v44, v45
    v_cvt_pk_bf16_f32 v167, v46, v47
    s_nop 1
    v_permlane16_swap_b32 v164, v166
    v_permlane16_swap_b32 v165, v167
    buffer_store_dwordx4 v[164:167], v6, s[24:27], s35 offen offset:1024
    v_cvt_pk_bf16_f32 v168, v48, v49
    v_cvt_pk_bf16_f32 v169, v50, v51
    v_cvt_pk_bf16_f32 v170, v52, v53
    v_cvt_pk_bf16_f32 v171, v54, v55
    s_nop 1
    v_permlane16_swap_b32 v168, v170
    v_permlane16_swap_b32 v169, v171
    buffer_store_dwordx4 v[168:171], v6, s[24:27], s35 offen offset:2048
    v_cvt_pk_bf16_f32 v172, v56, v57
    v_cvt_pk_bf16_f32 v173, v58, v59
    v_cvt_pk_bf16_f32 v174, v60, v61
    v_cvt_pk_bf16_f32 v175, v62, v63
    s_nop 1
    v_permlane16_swap_b32 v172, v174
    v_permlane16_swap_b32 v173, v175
    buffer_store_dwordx4 v[172:175], v6, s[24:27], s35 offen offset:3072
    s_add_u32 s35, s35, 4096
    v_cvt_pk_bf16_f32 v176, v64, v65
    v_cvt_pk_bf16_f32 v177, v66, v67
    v_cvt_pk_bf16_f32 v178, v68, v69
    v_cvt_pk_bf16_f32 v179, v70, v71
    s_nop 1
    v_permlane16_swap_b32 v176, v178
    v_permlane16_swap_b32 v177, v179
    buffer_store_dwordx4 v[176:179], v6, s[24:27], s35 offen offset:0
    v_cvt_pk_bf16_f32 v180, v72, v73
    v_cvt_pk_bf16_f32 v181, v74, v75
    v_cvt_pk_bf16_f32 v182, v76, v77
    v_cvt_pk_bf16_f32 v183, v78, v79
    s_nop 1
    v_permlane16_swap_b32 v180, v182
    v_permlane16_swap_b32 v181, v183
    buffer_store_dwordx4 v[180:183], v6, s[24:27], s35 offen offset:1024
    v_cvt_pk_bf16_f32 v184, v80, v81
    v_cvt_pk_bf16_f32 v185, v82, v83
    v_cvt_pk_bf16_f32 v186, v84, v85
    v_cvt_pk_bf16_f32 v187, v86, v87
    s_nop 1
    v_permlane16_swap_b32 v184, v186
    v_permlane16_swap_b32 v185, v187
    buffer_store_dwordx4 v[184:187], v6, s[24:27], s35 offen offset:2048
    v_cvt_pk_bf16_f32 v188, v88, v89
    v_cvt_pk_bf16_f32 v189, v90, v91
    v_cvt_pk_bf16_f32 v190, v92, v93
    v_cvt_pk_bf16_f32 v191, v94, v95
    s_nop 1
    v_permlane16_swap_b32 v188, v190
    v_permlane16_swap_b32 v189, v191
    buffer_store_dwordx4 v[188:191], v6, s[24:27], s35 offen offset:3072
    s_add_u32 s35, s35, 4096
    v_cvt_pk_bf16_f32 v192, v96, v97
    v_cvt_pk_bf16_f32 v193, v98, v99
    v_cvt_pk_bf16_f32 v194, v100, v101
    v_cvt_pk_bf16_f32 v195, v102, v103
    s_nop 1
    v_permlane16_swap_b32 v192, v194
    v_permlane16_swap_b32 v193, v195
    buffer_store_dwordx4 v[192:195], v6, s[24:27], s35 offen offset:0
    v_cvt_pk_bf16_f32 v196, v104, v105
    v_cvt_pk_bf16_f32 v197, v106, v107
    v_cvt_pk_bf16_f32 v198, v108, v109
    v_cvt_pk_bf16_f32 v199, v110, v111
    s_nop 1
    v_permlane16_swap_b32 v196, v198
    v_permlane16_swap_b32 v197, v199
    buffer_store_dwordx4 v[196:199], v6, s[24:27], s35 offen offset:1024
    v_cvt_pk_bf16_f32 v200, v112, v113
    v_cvt_pk_bf16_f32 v201, v114, v115
    v_cvt_pk_bf16_f32 v202, v116, v117
    v_cvt_pk_bf16_f32 v203, v118, v119
    s_nop 1
    v_permlane16_swap_b32 v200, v202
    v_permlane16_swap_b32 v201, v203
    buffer_store_dwordx4 v[200:203], v6, s[24:27], s35 offen offset:2048
    v_cvt_pk_bf16_f32 v204, v120, v121
    v_cvt_pk_bf16_f32 v205, v122, v123
    v_cvt_pk_bf16_f32 v206, v124, v125
    v_cvt_pk_bf16_f32 v207, v126, v127
    s_nop 1
    v_permlane16_swap_b32 v204, v206
    v_permlane16_swap_b32 v205, v207
    buffer_store_dwordx4 v[204:207], v6, s[24:27], s35 offen offset:3072
    s_add_u32 s35, s35, 4096
    v_cvt_pk_bf16_f32 v208, v128, v129
    v_cvt_pk_bf16_f32 v209, v130, v131
    v_cvt_pk_bf16_f32 v210, v132, v133
    v_cvt_pk_bf16_f32 v211, v134, v135
    s_nop 1
    v_permlane16_swap_b32 v208, v210
    v_permlane16_swap_b32 v209, v211
    buffer_store_dwordx4 v[208:211], v6, s[24:27], s35 offen offset:0
    v_cvt_pk_bf16_f32 v212, v136, v137
    v_cvt_pk_bf16_f32 v213, v138, v139
    v_cvt_pk_bf16_f32 v214, v140, v141
    v_cvt_pk_bf16_f32 v215, v142, v143
    s_nop 1
    v_permlane16_swap_b32 v212, v214
    v_permlane16_swap_b32 v213, v215
    buffer_store_dwordx4 v[212:215], v6, s[24:27], s35 offen offset:1024
K1_END:
    s_endpgm
SLOW_0_0:
    s_nop 15
    v_mov_b32 v24, v22
    s_nop 1
    v_permlane32_swap_b32 v22, v24
    s_nop 1
    v_max_f32 v22, v22, v24
    v_mov_b32 v24, v22
    s_nop 1
    v_permlane16_swap_b32 v22, v24
    s_nop 1
    v_max_f32 v22, v22, v24
    v_add_f32 v22, 0x42c00000, v22
    v_max_f32 v22, 0, v22
    v_sub_f32 v20, 0, v22
    v_exp_f32 v20, v20
    s_nop 0
    v_mov_b32 v24, v23
    s_nop 1
    v_permlane32_swap_b32 v23, v24
    s_nop 1
    v_max_f32 v23, v23, v24
    v_mov_b32 v24, v23
    s_nop 1
    v_permlane16_swap_b32 v23, v24
    s_nop 1
    v_max_f32 v23, v23, v24
    v_add_f32 v23, 0x42c00000, v23
    v_max_f32 v23, 0, v23
    v_sub_f32 v21, 0, v23
    v_exp_f32 v21, v21
    s_nop 0
    v_sub_f32 v64, v64, v22
    v_sub_f32 v65, v65, v22
    v_sub_f32 v66, v66, v22
    v_sub_f32 v67, v67, v22
    v_sub_f32 v68, v68, v23
    v_sub_f32 v69, v69, v23
    v_sub_f32 v70, v70, v23
    v_sub_f32 v71, v71, v23
    v_sub_f32 v72, v72, v22
    v_sub_f32 v73, v73, v22
    v_sub_f32 v74, v74, v22
    v_sub_f32 v75, v75, v22
    v_sub_f32 v76, v76, v23
    v_sub_f32 v77, v77, v23
    v_sub_f32 v78, v78, v23
    v_sub_f32 v79, v79, v23
    v_sub_f32 v80, v80, v22
    v_sub_f32 v81, v81, v22
    v_sub_f32 v82, v82, v22
    v_sub_f32 v83, v83, v22
    v_sub_f32 v84, v84, v23
    v_sub_f32 v85, v85, v23
    v_sub_f32 v86, v86, v23
    v_sub_f32 v87, v87, v23
    v_sub_f32 v88, v88, v22
    v_sub_f32 v89, v89, v22
    v_sub_f32 v90, v90, v22
    v_sub_f32 v91, v91, v22
    v_sub_f32 v92, v92, v23
    v_sub_f32 v93, v93, v23
    v_sub_f32 v94, v94, v23
    v_sub_f32 v95, v95, v23
    v_sub_f32 v112, v112, v22
    v_sub_f32 v113, v113, v22
    v_sub_f32 v114, v114, v22
    v_sub_f32 v115, v115, v22
    v_sub_f32 v116, v116, v23
    v_sub_f32 v117, v117, v23
    v_sub_f32 v118, v118, v23
    v_sub_f32 v119, v119, v23
    v_mul_f32 v124, v124, v20
    v_mul_f32 v125, v125, v20
    v_mul_f32 v126, v126, v20
    v_mul_f32 v127, v127, v20
    v_mul_f32 v16, v16, v21
    v_mul_f32 v17, v17, v21
    v_mul_f32 v18, v18, v21
    v_mul_f32 v19, v19, v21
    v_accvgpr_read_b32 v24, a0
    v_accvgpr_read_b32 v25, a1
    v_accvgpr_read_b32 v26, a2
    v_accvgpr_read_b32 v27, a3
    v_mul_f32 v24, v24, v20
    v_mul_f32 v25, v25, v20
    v_mul_f32 v26, v26, v20
    v_mul_f32 v27, v27, v20
    v_accvgpr_write_b32 a0, v24
    v_accvgpr_write_b32 a1, v25
    v_accvgpr_write_b32 a2, v26
    v_accvgpr_write_b32 a3, v27
    v_accvgpr_read_b32 v24, a4
    v_accvgpr_read_b32 v25, a5
    v_accvgpr_read_b32 v26, a6
    v_accvgpr_read_b32 v27, a7
    v_mul_f32 v24, v24, v21
    v_mul_f32 v25, v25, v21
    v_mul_f32 v26, v26, v21
    v_mul_f32 v27, v27, v21
    v_accvgpr_write_b32 a4, v24
    v_accvgpr_write_b32 a5, v25
    v_accvgpr_write_b32 a6, v26
    v_accvgpr_write_b32 a7, v27
    v_accvgpr_read_b32 v24, a8
    v_accvgpr_read_b32 v25, a9
    v_accvgpr_read_b32 v26, a10
    v_accvgpr_read_b32 v27, a11
    v_mul_f32 v24, v24, v20
    v_mul_f32 v25, v25, v20
    v_mul_f32 v26, v26, v20
    v_mul_f32 v27, v27, v20
    v_accvgpr_write_b32 a8, v24
    v_accvgpr_write_b32 a9, v25
    v_accvgpr_write_b32 a10, v26
    v_accvgpr_write_b32 a11, v27
    v_accvgpr_read_b32 v24, a12
    v_accvgpr_read_b32 v25, a13
    v_accvgpr_read_b32 v26, a14
    v_accvgpr_read_b32 v27, a15
    v_mul_f32 v24, v24, v21
    v_mul_f32 v25, v25, v21
    v_mul_f32 v26, v26, v21
    v_mul_f32 v27, v27, v21
    v_accvgpr_write_b32 a12, v24
    v_accvgpr_write_b32 a13, v25
    v_accvgpr_write_b32 a14, v26
    v_accvgpr_write_b32 a15, v27
    v_accvgpr_read_b32 v24, a16
    v_accvgpr_read_b32 v25, a17
    v_accvgpr_read_b32 v26, a18
    v_accvgpr_read_b32 v27, a19
    v_mul_f32 v24, v24, v20
    v_mul_f32 v25, v25, v20
    v_mul_f32 v26, v26, v20
    v_mul_f32 v27, v27, v20
    v_accvgpr_write_b32 a16, v24
    v_accvgpr_write_b32 a17, v25
    v_accvgpr_write_b32 a18, v26
    v_accvgpr_write_b32 a19, v27
    v_accvgpr_read_b32 v24, a20
    v_accvgpr_read_b32 v25, a21
    v_accvgpr_read_b32 v26, a22
    v_accvgpr_read_b32 v27, a23
    v_mul_f32 v24, v24, v21
    v_mul_f32 v25, v25, v21
    v_mul_f32 v26, v26, v21
    v_mul_f32 v27, v27, v21
    v_accvgpr_write_b32 a20, v24
    v_accvgpr_write_b32 a21, v25
    v_accvgpr_write_b32 a22, v26
    v_accvgpr_write_b32 a23, v27
    v_accvgpr_read_b32 v24, a24
    v_accvgpr_read_b32 v25, a25
    v_accvgpr_read_b32 v26, a26
    v_accvgpr_read_b32 v27, a27
    v_mul_f32 v24, v24, v20
    v_mul_f32 v25, v25, v20
    v_mul_f32 v26, v26, v20
    v_mul_f32 v27, v27, v20
    v_accvgpr_write_b32 a24, v24
    v_accvgpr_write_b32 a25, v25
    v_accvgpr_write_b32 a26, v26
    v_accvgpr_write_b32 a27, v27
    v_accvgpr_read_b32 v24, a28
    v_accvgpr_read_b32 v25, a29
    v_accvgpr_read_b32 v26, a30
    v_accvgpr_read_b32 v27, a31
    v_mul_f32 v24, v24, v21
    v_mul_f32 v25, v25, v21
    v_mul_f32 v26, v26, v21
    v_mul_f32 v27, v27, v21
    v_accvgpr_write_b32 a28, v24
    v_accvgpr_write_b32 a29, v25
    v_accvgpr_write_b32 a30, v26
    v_accvgpr_write_b32 a31, v27
    v_accvgpr_read_b32 v24, a32
    v_accvgpr_read_b32 v25, a33
    v_accvgpr_read_b32 v26, a34
    v_accvgpr_read_b32 v27, a35
    v_mul_f32 v24, v24, v20
    v_mul_f32 v25, v25, v20
    v_mul_f32 v26, v26, v20
    v_mul_f32 v27, v27, v20
    v_accvgpr_write_b32 a32, v24
    v_accvgpr_write_b32 a33, v25
    v_accvgpr_write_b32 a34, v26
    v_accvgpr_write_b32 a35, v27
    v_accvgpr_read_b32 v24, a36
    v_accvgpr_read_b32 v25, a37
    v_accvgpr_read_b32 v26, a38
    v_accvgpr_read_b32 v27, a39
    v_mul_f32 v24, v24, v21
    v_mul_f32 v25, v25, v21
    v_mul_f32 v26, v26, v21
    v_mul_f32 v27, v27, v21
    v_accvgpr_write_b32 a36, v24
    v_accvgpr_write_b32 a37, v25
    v_accvgpr_write_b32 a38, v26
    v_accvgpr_write_b32 a39, v27
    v_accvgpr_read_b32 v24, a40
    v_accvgpr_read_b32 v25, a41
    v_accvgpr_read_b32 v26, a42
    v_accvgpr_read_b32 v27, a43
    v_mul_f32 v24, v24, v20
    v_mul_f32 v25, v25, v20
    v_mul_f32 v26, v26, v20
    v_mul_f32 v27, v27, v20
    v_accvgpr_write_b32 a40, v24
    v_accvgpr_write_b32 a41, v25
    v_accvgpr_write_b32 a42, v26
    v_accvgpr_write_b32 a43, v27
    v_accvgpr_read_b32 v24, a44
    v_accvgpr_read_b32 v25, a45
    v_accvgpr_read_b32 v26, a46
    v_accvgpr_read_b32 v27, a47
    v_mul_f32 v24, v24, v21
    v_mul_f32 v25, v25, v21
    v_mul_f32 v26, v26, v21
    v_mul_f32 v27, v27, v21
    v_accvgpr_write_b32 a44, v24
    v_accvgpr_write_b32 a45, v25
    v_accvgpr_write_b32 a46, v26
    v_accvgpr_write_b32 a47, v27
    v_accvgpr_read_b32 v24, a48
    v_accvgpr_read_b32 v25, a49
    v_accvgpr_read_b32 v26, a50
    v_accvgpr_read_b32 v27, a51
    v_mul_f32 v24, v24, v20
    v_mul_f32 v25, v25, v20
    v_mul_f32 v26, v26, v20
    v_mul_f32 v27, v27, v20
    v_accvgpr_write_b32 a48, v24
    v_accvgpr_write_b32 a49, v25
    v_accvgpr_write_b32 a50, v26
    v_accvgpr_write_b32 a51, v27
    v_accvgpr_read_b32 v24, a52
    v_accvgpr_read_b32 v25, a53
    v_accvgpr_read_b32 v26, a54
    v_accvgpr_read_b32 v27, a55
    v_mul_f32 v24, v24, v21
    v_mul_f32 v25, v25, v21
    v_mul_f32 v26, v26, v21
    v_mul_f32 v27, v27, v21
    v_accvgpr_write_b32 a52, v24
    v_accvgpr_write_b32 a53, v25
    v_accvgpr_write_b32 a54, v26
    v_accvgpr_write_b32 a55, v27
    v_accvgpr_read_b32 v24, a56
    v_accvgpr_read_b32 v25, a57
    v_accvgpr_read_b32 v26, a58
    v_accvgpr_read_b32 v27, a59
    v_mul_f32 v24, v24, v20
    v_mul_f32 v25, v25, v20
    v_mul_f32 v26, v26, v20
    v_mul_f32 v27, v27, v20
    v_accvgpr_write_b32 a56, v24
    v_accvgpr_write_b32 a57, v25
    v_accvgpr_write_b32 a58, v26
    v_accvgpr_write_b32 a59, v27
    v_accvgpr_read_b32 v24, a60
    v_accvgpr_read_b32 v25, a61
    v_accvgpr_read_b32 v26, a62
    v_accvgpr_read_b32 v27, a63
    v_mul_f32 v24, v24, v21
    v_mul_f32 v25, v25, v21
    v_mul_f32 v26, v26, v21
    v_mul_f32 v27, v27, v21
    v_accvgpr_write_b32 a60, v24
    v_accvgpr_write_b32 a61, v25
    v_accvgpr_write_b32 a62, v26
    v_accvgpr_write_b32 a63, v27
    v_accvgpr_read_b32 v24, a64
    v_accvgpr_read_b32 v25, a65
    v_accvgpr_read_b32 v26, a66
    v_accvgpr_read_b32 v27, a67
    v_mul_f32 v24, v24, v20
    v_mul_f32 v25, v25, v20
    v_mul_f32 v26, v26, v20
    v_mul_f32 v27, v27, v20
    v_accvgpr_write_b32 a64, v24
    v_accvgpr_write_b32 a65, v25
    v_accvgpr_write_b32 a66, v26
    v_accvgpr_write_b32 a67, v27
    v_accvgpr_read_b32 v24, a68
    v_accvgpr_read_b32 v25, a69
    v_accvgpr_read_b32 v26, a70
    v_accvgpr_read_b32 v27, a71
    v_mul_f32 v24, v24, v21
    v_mul_f32 v25, v25, v21
    v_mul_f32 v26, v26, v21
    v_mul_f32 v27, v27, v21
    v_accvgpr_write_b32 a68, v24
    v_accvgpr_write_b32 a69, v25
    v_accvgpr_write_b32 a70, v26
    v_accvgpr_write_b32 a71, v27
    v_accvgpr_read_b32 v24, a72
    v_accvgpr_read_b32 v25, a73
    v_accvgpr_read_b32 v26, a74
    v_accvgpr_read_b32 v27, a75
    v_mul_f32 v24, v24, v20
    v_mul_f32 v25, v25, v20
    v_mul_f32 v26, v26, v20
    v_mul_f32 v27, v27, v20
    v_accvgpr_write_b32 a72, v24
    v_accvgpr_write_b32 a73, v25
    v_accvgpr_write_b32 a74, v26
    v_accvgpr_write_b32 a75, v27
    v_accvgpr_read_b32 v24, a76
    v_accvgpr_read_b32 v25, a77
    v_accvgpr_read_b32 v26, a78
    v_accvgpr_read_b32 v27, a79
    v_mul_f32 v24, v24, v21
    v_mul_f32 v25, v25, v21
    v_mul_f32 v26, v26, v21
    v_mul_f32 v27, v27, v21
    v_accvgpr_write_b32 a76, v24
    v_accvgpr_write_b32 a77, v25
    v_accvgpr_write_b32 a78, v26
    v_accvgpr_write_b32 a79, v27
    v_accvgpr_read_b32 v24, a80
    v_accvgpr_read_b32 v25, a81
    v_accvgpr_read_b32 v26, a82
    v_accvgpr_read_b32 v27, a83
    v_mul_f32 v24, v24, v20
    v_mul_f32 v25, v25, v20
    v_mul_f32 v26, v26, v20
    v_mul_f32 v27, v27, v20
    v_accvgpr_write_b32 a80, v24
    v_accvgpr_write_b32 a81, v25
    v_accvgpr_write_b32 a82, v26
    v_accvgpr_write_b32 a83, v27
    v_accvgpr_read_b32 v24, a84
    v_accvgpr_read_b32 v25, a85
    v_accvgpr_read_b32 v26, a86
    v_accvgpr_read_b32 v27, a87
    v_mul_f32 v24, v24, v21
    v_mul_f32 v25, v25, v21
    v_mul_f32 v26, v26, v21
    v_mul_f32 v27, v27, v21
    v_accvgpr_write_b32 a84, v24
    v_accvgpr_write_b32 a85, v25
    v_accvgpr_write_b32 a86, v26
    v_accvgpr_write_b32 a87, v27
    v_accvgpr_read_b32 v24, a88
    v_accvgpr_read_b32 v25, a89
    v_accvgpr_read_b32 v26, a90
    v_accvgpr_read_b32 v27, a91
    v_mul_f32 v24, v24, v20
    v_mul_f32 v25, v25, v20
    v_mul_f32 v26, v26, v20
    v_mul_f32 v27, v27, v20
    v_accvgpr_write_b32 a88, v24
    v_accvgpr_write_b32 a89, v25
    v_accvgpr_write_b32 a90, v26
    v_accvgpr_write_b32 a91, v27
    v_accvgpr_read_b32 v24, a92
    v_accvgpr_read_b32 v25, a93
    v_accvgpr_read_b32 v26, a94
    v_accvgpr_read_b32 v27, a95
    v_mul_f32 v24, v24, v21
    v_mul_f32 v25, v25, v21
    v_mul_f32 v26, v26, v21
    v_mul_f32 v27, v27, v21
    v_accvgpr_write_b32 a92, v24
    v_accvgpr_write_b32 a93, v25
    v_accvgpr_write_b32 a94, v26
    v_accvgpr_write_b32 a95, v27
    v_accvgpr_read_b32 v24, a96
    v_accvgpr_read_b32 v25, a97
    v_accvgpr_read_b32 v26, a98
    v_accvgpr_read_b32 v27, a99
    v_mul_f32 v24, v24, v20
    v_mul_f32 v25, v25, v20
    v_mul_f32 v26, v26, v20
    v_mul_f32 v27, v27, v20
    v_accvgpr_write_b32 a96, v24
    v_accvgpr_write_b32 a97, v25
    v_accvgpr_write_b32 a98, v26
    v_accvgpr_write_b32 a99, v27
    v_accvgpr_read_b32 v24, a100
    v_accvgpr_read_b32 v25, a101
    v_accvgpr_read_b32 v26, a102
    v_accvgpr_read_b32 v27, a103
    v_mul_f32 v24, v24, v21
    v_mul_f32 v25, v25, v21
    v_mul_f32 v26, v26, v21
    v_mul_f32 v27, v27, v21
    v_accvgpr_write_b32 a100, v24
    v_accvgpr_write_b32 a101, v25
    v_accvgpr_write_b32 a102, v26
    v_accvgpr_write_b32 a103, v27
    v_accvgpr_read_b32 v24, a104
    v_accvgpr_read_b32 v25, a105
    v_accvgpr_read_b32 v26, a106
    v_accvgpr_read_b32 v27, a107
    v_mul_f32 v24, v24, v20
    v_mul_f32 v25, v25, v20
    v_mul_f32 v26, v26, v20
    v_mul_f32 v27, v27, v20
    v_accvgpr_write_b32 a104, v24
    v_accvgpr_write_b32 a105, v25
    v_accvgpr_write_b32 a106, v26
    v_accvgpr_write_b32 a107, v27
    v_accvgpr_read_b32 v24, a108
    v_accvgpr_read_b32 v25, a109
    v_accvgpr_read_b32 v26, a110
    v_accvgpr_read_b32 v27, a111
    v_mul_f32 v24, v24, v21
    v_mul_f32 v25, v25, v21
    v_mul_f32 v26, v26, v21
    v_mul_f32 v27, v27, v21
    v_accvgpr_write_b32 a108, v24
    v_accvgpr_write_b32 a109, v25
    v_accvgpr_write_b32 a110, v26
    v_accvgpr_write_b32 a111, v27
    v_accvgpr_read_b32 v24, a112
    v_accvgpr_read_b32 v25, a113
    v_accvgpr_read_b32 v26, a114
    v_accvgpr_read_b32 v27, a115
    v_mul_f32 v24, v24, v20
    v_mul_f32 v25, v25, v20
    v_mul_f32 v26, v26, v20
    v_mul_f32 v27, v27, v20
    v_accvgpr_write_b32 a112, v24
    v_accvgpr_write_b32 a113, v25
    v_accvgpr_write_b32 a114, v26
    v_accvgpr_write_b32 a115, v27
    v_accvgpr_read_b32 v24, a116
    v_accvgpr_read_b32 v25, a117
    v_accvgpr_read_b32 v26, a118
    v_accvgpr_read_b32 v27, a119
    v_mul_f32 v24, v24, v21
    v_mul_f32 v25, v25, v21
    v_mul_f32 v26, v26, v21
    v_mul_f32 v27, v27, v21
    v_accvgpr_write_b32 a116, v24
    v_accvgpr_write_b32 a117, v25
    v_accvgpr_write_b32 a118, v26
    v_accvgpr_write_b32 a119, v27
    v_accvgpr_read_b32 v24, a120
    v_accvgpr_read_b32 v25, a121
    v_accvgpr_read_b32 v26, a122
    v_accvgpr_read_b32 v27, a123
    v_mul_f32 v24, v24, v20
    v_mul_f32 v25, v25, v20
    v_mul_f32 v26, v26, v20
    v_mul_f32 v27, v27, v20
    v_accvgpr_write_b32 a120, v24
    v_accvgpr_write_b32 a121, v25
    v_accvgpr_write_b32 a122, v26
    v_accvgpr_write_b32 a123, v27
    v_accvgpr_read_b32 v24, a124
    v_accvgpr_read_b32 v25, a125
    v_accvgpr_read_b32 v26, a126
    v_accvgpr_read_b32 v27, a127
    v_mul_f32 v24, v24, v21
    v_mul_f32 v25, v25, v21
    v_mul_f32 v26, v26, v21
    v_mul_f32 v27, v27, v21
    v_accvgpr_write_b32 a124, v24
    v_accvgpr_write_b32 a125, v25
    v_accvgpr_write_b32 a126, v26
    v_accvgpr_write_b32 a127, v27
    s_nop 3
    s_branch BACK_0_0
SLOW_1_0:
    s_nop 15
    v_mov_b32 v24, v22
    s_nop 1
    v_permlane32_swap_b32 v22, v24
    s_nop 1
    v_max_f32 v22, v22, v24
    v_mov_b32 v24, v22
    s_nop 1
    v_permlane16_swap_b32 v22, v24
    s_nop 1
    v_max_f32 v22, v22, v24
    v_add_f32 v22, 0x42c00000, v22
    v_max_f32 v22, 0, v22
    v_sub_f32 v20, 0, v22
    v_exp_f32 v20, v20
    s_nop 0
    v_mov_b32 v24, v23
    s_nop 1
    v_permlane32_swap_b32 v23, v24
    s_nop 1
    v_max_f32 v23, v23, v24
    v_mov_b32 v24, v23
    s_nop 1
    v_permlane16_swap_b32 v23, v24
    s_nop 1
    v_max_f32 v23, v23, v24
    v_add_f32 v23, 0x42c00000, v23
    v_max_f32 v23, 0, v23
    v_sub_f32 v21, 0, v23
    v_exp_f32 v21, v21
    s_nop 0
    v_sub_f32 v32, v32, v22
    v_sub_f32 v33, v33, v22
    v_sub_f32 v34, v34, v22
    v_sub_f32 v35, v35, v22
    v_sub_f32 v36, v36, v23
    v_sub_f32 v37, v37, v23
    v_sub_f32 v38, v38, v23
    v_sub_f32 v39, v39, v23
    v_sub_f32 v40, v40, v22
    v_sub_f32 v41, v41, v22
    v_sub_f32 v42, v42, v22
    v_sub_f32 v43, v43, v22
    v_sub_f32 v44, v44, v23
    v_sub_f32 v45, v45, v23
    v_sub_f32 v46, v46, v23
    v_sub_f32 v47, v47, v23
    v_sub_f32 v48, v48, v22
    v_sub_f32 v49, v49, v22
    v_sub_f32 v50, v50, v22
    v_sub_f32 v51, v51, v22
    v_sub_f32 v52, v52, v23
    v_sub_f32 v53, v53, v23
    v_sub_f32 v54, v54, v23
    v_sub_f32 v55, v55, v23
    v_sub_f32 v56, v56, v22
    v_sub_f32 v57, v57, v22
    v_sub_f32 v58, v58, v22
    v_sub_f32 v59, v59, v22
    v_sub_f32 v60, v60, v23
    v_sub_f32 v61, v61, v23
    v_sub_f32 v62, v62, v23
    v_sub_f32 v63, v63, v23
    v_sub_f32 v112, v112, v22
    v_sub_f32 v113, v113, v22
    v_sub_f32 v114, v114, v22
    v_sub_f32 v115, v115, v22
    v_sub_f32 v116, v116, v23
    v_sub_f32 v117, v117, v23
    v_sub_f32 v118, v118, v23
    v_sub_f32 v119, v119, v23
    v_mul_f32 v124, v124, v20
    v_mul_f32 v125, v125, v20
    v_mul_f32 v126, v126, v20
    v_mul_f32 v127, v127, v20
    v_mul_f32 v16, v16, v21
    v_mul_f32 v17, v17, v21
    v_mul_f32 v18, v18, v21
    v_mul_f32 v19, v19, v21
    v_accvgpr_read_b32 v24, a0
    v_accvgpr_read_b32 v25, a1
    v_accvgpr_read_b32 v26, a2
    v_accvgpr_read_b32 v27, a3
    v_mul_f32 v24, v24, v20
    v_mul_f32 v25, v25, v20
    v_mul_f32 v26, v26, v20
    v_mul_f32 v27, v27, v20
    v_accvgpr_write_b32 a0, v24
    v_accvgpr_write_b32 a1, v25
    v_accvgpr_write_b32 a2, v26
    v_accvgpr_write_b32 a3, v27
    v_accvgpr_read_b32 v24, a4
    v_accvgpr_read_b32 v25, a5
    v_accvgpr_read_b32 v26, a6
    v_accvgpr_read_b32 v27, a7
    v_mul_f32 v24, v24, v21
    v_mul_f32 v25, v25, v21
    v_mul_f32 v26, v26, v21
    v_mul_f32 v27, v27, v21
    v_accvgpr_write_b32 a4, v24
    v_accvgpr_write_b32 a5, v25
    v_accvgpr_write_b32 a6, v26
    v_accvgpr_write_b32 a7, v27
    v_accvgpr_read_b32 v24, a8
    v_accvgpr_read_b32 v25, a9
    v_accvgpr_read_b32 v26, a10
    v_accvgpr_read_b32 v27, a11
    v_mul_f32 v24, v24, v20
    v_mul_f32 v25, v25, v20
    v_mul_f32 v26, v26, v20
    v_mul_f32 v27, v27, v20
    v_accvgpr_write_b32 a8, v24
    v_accvgpr_write_b32 a9, v25
    v_accvgpr_write_b32 a10, v26
    v_accvgpr_write_b32 a11, v27
    v_accvgpr_read_b32 v24, a12
    v_accvgpr_read_b32 v25, a13
    v_accvgpr_read_b32 v26, a14
    v_accvgpr_read_b32 v27, a15
    v_mul_f32 v24, v24, v21
    v_mul_f32 v25, v25, v21
    v_mul_f32 v26, v26, v21
    v_mul_f32 v27, v27, v21
    v_accvgpr_write_b32 a12, v24
    v_accvgpr_write_b32 a13, v25
    v_accvgpr_write_b32 a14, v26
    v_accvgpr_write_b32 a15, v27
    v_accvgpr_read_b32 v24, a16
    v_accvgpr_read_b32 v25, a17
    v_accvgpr_read_b32 v26, a18
    v_accvgpr_read_b32 v27, a19
    v_mul_f32 v24, v24, v20
    v_mul_f32 v25, v25, v20
    v_mul_f32 v26, v26, v20
    v_mul_f32 v27, v27, v20
    v_accvgpr_write_b32 a16, v24
    v_accvgpr_write_b32 a17, v25
    v_accvgpr_write_b32 a18, v26
    v_accvgpr_write_b32 a19, v27
    v_accvgpr_read_b32 v24, a20
    v_accvgpr_read_b32 v25, a21
    v_accvgpr_read_b32 v26, a22
    v_accvgpr_read_b32 v27, a23
    v_mul_f32 v24, v24, v21
    v_mul_f32 v25, v25, v21
    v_mul_f32 v26, v26, v21
    v_mul_f32 v27, v27, v21
    v_accvgpr_write_b32 a20, v24
    v_accvgpr_write_b32 a21, v25
    v_accvgpr_write_b32 a22, v26
    v_accvgpr_write_b32 a23, v27
    v_accvgpr_read_b32 v24, a24
    v_accvgpr_read_b32 v25, a25
    v_accvgpr_read_b32 v26, a26
    v_accvgpr_read_b32 v27, a27
    v_mul_f32 v24, v24, v20
    v_mul_f32 v25, v25, v20
    v_mul_f32 v26, v26, v20
    v_mul_f32 v27, v27, v20
    v_accvgpr_write_b32 a24, v24
    v_accvgpr_write_b32 a25, v25
    v_accvgpr_write_b32 a26, v26
    v_accvgpr_write_b32 a27, v27
    v_accvgpr_read_b32 v24, a28
    v_accvgpr_read_b32 v25, a29
    v_accvgpr_read_b32 v26, a30
    v_accvgpr_read_b32 v27, a31
    v_mul_f32 v24, v24, v21
    v_mul_f32 v25, v25, v21
    v_mul_f32 v26, v26, v21
    v_mul_f32 v27, v27, v21
    v_accvgpr_write_b32 a28, v24
    v_accvgpr_write_b32 a29, v25
    v_accvgpr_write_b32 a30, v26
    v_accvgpr_write_b32 a31, v27
    v_accvgpr_read_b32 v24, a32
    v_accvgpr_read_b32 v25, a33
    v_accvgpr_read_b32 v26, a34
    v_accvgpr_read_b32 v27, a35
    v_mul_f32 v24, v24, v20
    v_mul_f32 v25, v25, v20
    v_mul_f32 v26, v26, v20
    v_mul_f32 v27, v27, v20
    v_accvgpr_write_b32 a32, v24
    v_accvgpr_write_b32 a33, v25
    v_accvgpr_write_b32 a34, v26
    v_accvgpr_write_b32 a35, v27
    v_accvgpr_read_b32 v24, a36
    v_accvgpr_read_b32 v25, a37
    v_accvgpr_read_b32 v26, a38
    v_accvgpr_read_b32 v27, a39
    v_mul_f32 v24, v24, v21
    v_mul_f32 v25, v25, v21
    v_mul_f32 v26, v26, v21
    v_mul_f32 v27, v27, v21
    v_accvgpr_write_b32 a36, v24
    v_accvgpr_write_b32 a37, v25
    v_accvgpr_write_b32 a38, v26
    v_accvgpr_write_b32 a39, v27
    v_accvgpr_read_b32 v24, a40
    v_accvgpr_read_b32 v25, a41
    v_accvgpr_read_b32 v26, a42
    v_accvgpr_read_b32 v27, a43
    v_mul_f32 v24, v24, v20
    v_mul_f32 v25, v25, v20
    v_mul_f32 v26, v26, v20
    v_mul_f32 v27, v27, v20
    v_accvgpr_write_b32 a40, v24
    v_accvgpr_write_b32 a41, v25
    v_accvgpr_write_b32 a42, v26
    v_accvgpr_write_b32 a43, v27
    v_accvgpr_read_b32 v24, a44
    v_accvgpr_read_b32 v25, a45
    v_accvgpr_read_b32 v26, a46
    v_accvgpr_read_b32 v27, a47
    v_mul_f32 v24, v24, v21
    v_mul_f32 v25, v25, v21
    v_mul_f32 v26, v26, v21
    v_mul_f32 v27, v27, v21
    v_accvgpr_write_b32 a44, v24
    v_accvgpr_write_b32 a45, v25
    v_accvgpr_write_b32 a46, v26
    v_accvgpr_write_b32 a47, v27
    v_accvgpr_read_b32 v24, a48
    v_accvgpr_read_b32 v25, a49
    v_accvgpr_read_b32 v26, a50
    v_accvgpr_read_b32 v27, a51
    v_mul_f32 v24, v24, v20
    v_mul_f32 v25, v25, v20
    v_mul_f32 v26, v26, v20
    v_mul_f32 v27, v27, v20
    v_accvgpr_write_b32 a48, v24
    v_accvgpr_write_b32 a49, v25
    v_accvgpr_write_b32 a50, v26
    v_accvgpr_write_b32 a51, v27
    v_accvgpr_read_b32 v24, a52
    v_accvgpr_read_b32 v25, a53
    v_accvgpr_read_b32 v26, a54
    v_accvgpr_read_b32 v27, a55
    v_mul_f32 v24, v24, v21
    v_mul_f32 v25, v25, v21
    v_mul_f32 v26, v26, v21
    v_mul_f32 v27, v27, v21
    v_accvgpr_write_b32 a52, v24
    v_accvgpr_write_b32 a53, v25
    v_accvgpr_write_b32 a54, v26
    v_accvgpr_write_b32 a55, v27
    v_accvgpr_read_b32 v24, a56
    v_accvgpr_read_b32 v25, a57
    v_accvgpr_read_b32 v26, a58
    v_accvgpr_read_b32 v27, a59
    v_mul_f32 v24, v24, v20
    v_mul_f32 v25, v25, v20
    v_mul_f32 v26, v26, v20
    v_mul_f32 v27, v27, v20
    v_accvgpr_write_b32 a56, v24
    v_accvgpr_write_b32 a57, v25
    v_accvgpr_write_b32 a58, v26
    v_accvgpr_write_b32 a59, v27
    v_accvgpr_read_b32 v24, a60
    v_accvgpr_read_b32 v25, a61
    v_accvgpr_read_b32 v26, a62
    v_accvgpr_read_b32 v27, a63
    v_mul_f32 v24, v24, v21
    v_mul_f32 v25, v25, v21
    v_mul_f32 v26, v26, v21
    v_mul_f32 v27, v27, v21
    v_accvgpr_write_b32 a60, v24
    v_accvgpr_write_b32 a61, v25
    v_accvgpr_write_b32 a62, v26
    v_accvgpr_write_b32 a63, v27
    v_accvgpr_read_b32 v24, a64
    v_accvgpr_read_b32 v25, a65
    v_accvgpr_read_b32 v26, a66
    v_accvgpr_read_b32 v27, a67
    v_mul_f32 v24, v24, v20
    v_mul_f32 v25, v25, v20
    v_mul_f32 v26, v26, v20
    v_mul_f32 v27, v27, v20
    v_accvgpr_write_b32 a64, v24
    v_accvgpr_write_b32 a65, v25
    v_accvgpr_write_b32 a66, v26
    v_accvgpr_write_b32 a67, v27
    v_accvgpr_read_b32 v24, a68
    v_accvgpr_read_b32 v25, a69
    v_accvgpr_read_b32 v26, a70
    v_accvgpr_read_b32 v27, a71
    v_mul_f32 v24, v24, v21
    v_mul_f32 v25, v25, v21
    v_mul_f32 v26, v26, v21
    v_mul_f32 v27, v27, v21
    v_accvgpr_write_b32 a68, v24
    v_accvgpr_write_b32 a69, v25
    v_accvgpr_write_b32 a70, v26
    v_accvgpr_write_b32 a71, v27
    v_accvgpr_read_b32 v24, a72
    v_accvgpr_read_b32 v25, a73
    v_accvgpr_read_b32 v26, a74
    v_accvgpr_read_b32 v27, a75
    v_mul_f32 v24, v24, v20
    v_mul_f32 v25, v25, v20
    v_mul_f32 v26, v26, v20
    v_mul_f32 v27, v27, v20
    v_accvgpr_write_b32 a72, v24
    v_accvgpr_write_b32 a73, v25
    v_accvgpr_write_b32 a74, v26
    v_accvgpr_write_b32 a75, v27
    v_accvgpr_read_b32 v24, a76
    v_accvgpr_read_b32 v25, a77
    v_accvgpr_read_b32 v26, a78
    v_accvgpr_read_b32 v27, a79
    v_mul_f32 v24, v24, v21
    v_mul_f32 v25, v25, v21
    v_mul_f32 v26, v26, v21
    v_mul_f32 v27, v27, v21
    v_accvgpr_write_b32 a76, v24
    v_accvgpr_write_b32 a77, v25
    v_accvgpr_write_b32 a78, v26
    v_accvgpr_write_b32 a79, v27
    v_accvgpr_read_b32 v24, a80
    v_accvgpr_read_b32 v25, a81
    v_accvgpr_read_b32 v26, a82
    v_accvgpr_read_b32 v27, a83
    v_mul_f32 v24, v24, v20
    v_mul_f32 v25, v25, v20
    v_mul_f32 v26, v26, v20
    v_mul_f32 v27, v27, v20
    v_accvgpr_write_b32 a80, v24
    v_accvgpr_write_b32 a81, v25
    v_accvgpr_write_b32 a82, v26
    v_accvgpr_write_b32 a83, v27
    v_accvgpr_read_b32 v24, a84
    v_accvgpr_read_b32 v25, a85
    v_accvgpr_read_b32 v26, a86
    v_accvgpr_read_b32 v27, a87
    v_mul_f32 v24, v24, v21
    v_mul_f32 v25, v25, v21
    v_mul_f32 v26, v26, v21
    v_mul_f32 v27, v27, v21
    v_accvgpr_write_b32 a84, v24
    v_accvgpr_write_b32 a85, v25
    v_accvgpr_write_b32 a86, v26
    v_accvgpr_write_b32 a87, v27
    v_accvgpr_read_b32 v24, a88
    v_accvgpr_read_b32 v25, a89
    v_accvgpr_read_b32 v26, a90
    v_accvgpr_read_b32 v27, a91
    v_mul_f32 v24, v24, v20
    v_mul_f32 v25, v25, v20
    v_mul_f32 v26, v26, v20
    v_mul_f32 v27, v27, v20
    v_accvgpr_write_b32 a88, v24
    v_accvgpr_write_b32 a89, v25
    v_accvgpr_write_b32 a90, v26
    v_accvgpr_write_b32 a91, v27
    v_accvgpr_read_b32 v24, a92
    v_accvgpr_read_b32 v25, a93
    v_accvgpr_read_b32 v26, a94
    v_accvgpr_read_b32 v27, a95
    v_mul_f32 v24, v24, v21
    v_mul_f32 v25, v25, v21
    v_mul_f32 v26, v26, v21
    v_mul_f32 v27, v27, v21
    v_accvgpr_write_b32 a92, v24
    v_accvgpr_write_b32 a93, v25
    v_accvgpr_write_b32 a94, v26
    v_accvgpr_write_b32 a95, v27
    v_accvgpr_read_b32 v24, a96
    v_accvgpr_read_b32 v25, a97
    v_accvgpr_read_b32 v26, a98
    v_accvgpr_read_b32 v27, a99
    v_mul_f32 v24, v24, v20
    v_mul_f32 v25, v25, v20
    v_mul_f32 v26, v26, v20
    v_mul_f32 v27, v27, v20
    v_accvgpr_write_b32 a96, v24
    v_accvgpr_write_b32 a97, v25
    v_accvgpr_write_b32 a98, v26
    v_accvgpr_write_b32 a99, v27
    v_accvgpr_read_b32 v24, a100
    v_accvgpr_read_b32 v25, a101
    v_accvgpr_read_b32 v26, a102
    v_accvgpr_read_b32 v27, a103
    v_mul_f32 v24, v24, v21
    v_mul_f32 v25, v25, v21
    v_mul_f32 v26, v26, v21
    v_mul_f32 v27, v27, v21
    v_accvgpr_write_b32 a100, v24
    v_accvgpr_write_b32 a101, v25
    v_accvgpr_write_b32 a102, v26
    v_accvgpr_write_b32 a103, v27
    v_accvgpr_read_b32 v24, a104
    v_accvgpr_read_b32 v25, a105
    v_accvgpr_read_b32 v26, a106
    v_accvgpr_read_b32 v27, a107
    v_mul_f32 v24, v24, v20
    v_mul_f32 v25, v25, v20
    v_mul_f32 v26, v26, v20
    v_mul_f32 v27, v27, v20
    v_accvgpr_write_b32 a104, v24
    v_accvgpr_write_b32 a105, v25
    v_accvgpr_write_b32 a106, v26
    v_accvgpr_write_b32 a107, v27
    v_accvgpr_read_b32 v24, a108
    v_accvgpr_read_b32 v25, a109
    v_accvgpr_read_b32 v26, a110
    v_accvgpr_read_b32 v27, a111
    v_mul_f32 v24, v24, v21
    v_mul_f32 v25, v25, v21
    v_mul_f32 v26, v26, v21
    v_mul_f32 v27, v27, v21
    v_accvgpr_write_b32 a108, v24
    v_accvgpr_write_b32 a109, v25
    v_accvgpr_write_b32 a110, v26
    v_accvgpr_write_b32 a111, v27
    v_accvgpr_read_b32 v24, a112
    v_accvgpr_read_b32 v25, a113
    v_accvgpr_read_b32 v26, a114
    v_accvgpr_read_b32 v27, a115
    v_mul_f32 v24, v24, v20
    v_mul_f32 v25, v25, v20
    v_mul_f32 v26, v26, v20
    v_mul_f32 v27, v27, v20
    v_accvgpr_write_b32 a112, v24
    v_accvgpr_write_b32 a113, v25
    v_accvgpr_write_b32 a114, v26
    v_accvgpr_write_b32 a115, v27
    v_accvgpr_read_b32 v24, a116
    v_accvgpr_read_b32 v25, a117
    v_accvgpr_read_b32 v26, a118
    v_accvgpr_read_b32 v27, a119
    v_mul_f32 v24, v24, v21
    v_mul_f32 v25, v25, v21
    v_mul_f32 v26, v26, v21
    v_mul_f32 v27, v27, v21
    v_accvgpr_write_b32 a116, v24
    v_accvgpr_write_b32 a117, v25
    v_accvgpr_write_b32 a118, v26
    v_accvgpr_write_b32 a119, v27
    v_accvgpr_read_b32 v24, a120
    v_accvgpr_read_b32 v25, a121
    v_accvgpr_read_b32 v26, a122
    v_accvgpr_read_b32 v27, a123
    v_mul_f32 v24, v24, v20
    v_mul_f32 v25, v25, v20
    v_mul_f32 v26, v26, v20
    v_mul_f32 v27, v27, v20
    v_accvgpr_write_b32 a120, v24
    v_accvgpr_write_b32 a121, v25
    v_accvgpr_write_b32 a122, v26
    v_accvgpr_write_b32 a123, v27
    v_accvgpr_read_b32 v24, a124
    v_accvgpr_read_b32 v25, a125
    v_accvgpr_read_b32 v26, a126
    v_accvgpr_read_b32 v27, a127
    v_mul_f32 v24, v24, v21
    v_mul_f32 v25, v25, v21
    v_mul_f32 v26, v26, v21
    v_mul_f32 v27, v27, v21
    v_accvgpr_write_b32 a124, v24
    v_accvgpr_write_b32 a125, v25
    v_accvgpr_write_b32 a126, v26
    v_accvgpr_write_b32 a127, v27
    s_nop 3
    s_branch BACK_1_0
SLOW_30_0:
    s_nop 15
    v_mov_b32 v24, v22
    s_nop 1
    v_permlane32_swap_b32 v22, v24
    s_nop 1
    v_max_f32 v22, v22, v24
    v_mov_b32 v24, v22
    s_nop 1
    v_permlane16_swap_b32 v22, v24
    s_nop 1
    v_max_f32 v22, v22, v24
    v_add_f32 v22, 0x42c00000, v22
    v_max_f32 v22, 0, v22
    v_sub_f32 v20, 0, v22
    v_exp_f32 v20, v20
    s_nop 0
    v_mov_b32 v24, v23
    s_nop 1
    v_permlane32_swap_b32 v23, v24
    s_nop 1
    v_max_f32 v23, v23, v24
    v_mov_b32 v24, v23
    s_nop 1
    v_permlane16_swap_b32 v23, v24
    s_nop 1
    v_max_f32 v23, v23, v24
    v_add_f32 v23, 0x42c00000, v23
    v_max_f32 v23, 0, v23
    v_sub_f32 v21, 0, v23
    v_exp_f32 v21, v21
    s_nop 0
    v_sub_f32 v64, v64, v22
    v_sub_f32 v65, v65, v22
    v_sub_f32 v66, v66, v22
    v_sub_f32 v67, v67, v22
    v_sub_f32 v68, v68, v23
    v_sub_f32 v69, v69, v23
    v_sub_f32 v70, v70, v23
    v_sub_f32 v71, v71, v23
    v_sub_f32 v72, v72, v22
    v_sub_f32 v73, v73, v22
    v_sub_f32 v74, v74, v22
    v_sub_f32 v75, v75, v22
    v_sub_f32 v76, v76, v23
    v_sub_f32 v77, v77, v23
    v_sub_f32 v78, v78, v23
    v_sub_f32 v79, v79, v23
    v_sub_f32 v80, v80, v22
    v_sub_f32 v81, v81, v22
    v_sub_f32 v82, v82, v22
    v_sub_f32 v83, v83, v22
    v_sub_f32 v84, v84, v23
    v_sub_f32 v85, v85, v23
    v_sub_f32 v86, v86, v23
    v_sub_f32 v87, v87, v23
    v_sub_f32 v88, v88, v22
    v_sub_f32 v89, v89, v22
    v_sub_f32 v90, v90, v22
    v_sub_f32 v91, v91, v22
    v_sub_f32 v92, v92, v23
    v_sub_f32 v93, v93, v23
    v_sub_f32 v94, v94, v23
    v_sub_f32 v95, v95, v23
    v_sub_f32 v112, v112, v22
    v_sub_f32 v113, v113, v22
    v_sub_f32 v114, v114, v22
    v_sub_f32 v115, v115, v22
    v_sub_f32 v116, v116, v23
    v_sub_f32 v117, v117, v23
    v_sub_f32 v118, v118, v23
    v_sub_f32 v119, v119, v23
    v_mul_f32 v124, v124, v20
    v_mul_f32 v125, v125, v20
    v_mul_f32 v126, v126, v20
    v_mul_f32 v127, v127, v20
    v_mul_f32 v16, v16, v21
    v_mul_f32 v17, v17, v21
    v_mul_f32 v18, v18, v21
    v_mul_f32 v19, v19, v21
    v_accvgpr_read_b32 v24, a0
    v_accvgpr_read_b32 v25, a1
    v_accvgpr_read_b32 v26, a2
    v_accvgpr_read_b32 v27, a3
    v_mul_f32 v24, v24, v20
    v_mul_f32 v25, v25, v20
    v_mul_f32 v26, v26, v20
    v_mul_f32 v27, v27, v20
    v_accvgpr_write_b32 a0, v24
    v_accvgpr_write_b32 a1, v25
    v_accvgpr_write_b32 a2, v26
    v_accvgpr_write_b32 a3, v27
    v_accvgpr_read_b32 v24, a4
    v_accvgpr_read_b32 v25, a5
    v_accvgpr_read_b32 v26, a6
    v_accvgpr_read_b32 v27, a7
    v_mul_f32 v24, v24, v21
    v_mul_f32 v25, v25, v21
    v_mul_f32 v26, v26, v21
    v_mul_f32 v27, v27, v21
    v_accvgpr_write_b32 a4, v24
    v_accvgpr_write_b32 a5, v25
    v_accvgpr_write_b32 a6, v26
    v_accvgpr_write_b32 a7, v27
    v_accvgpr_read_b32 v24, a8
    v_accvgpr_read_b32 v25, a9
    v_accvgpr_read_b32 v26, a10
    v_accvgpr_read_b32 v27, a11
    v_mul_f32 v24, v24, v20
    v_mul_f32 v25, v25, v20
    v_mul_f32 v26, v26, v20
    v_mul_f32 v27, v27, v20
    v_accvgpr_write_b32 a8, v24
    v_accvgpr_write_b32 a9, v25
    v_accvgpr_write_b32 a10, v26
    v_accvgpr_write_b32 a11, v27
    v_accvgpr_read_b32 v24, a12
    v_accvgpr_read_b32 v25, a13
    v_accvgpr_read_b32 v26, a14
    v_accvgpr_read_b32 v27, a15
    v_mul_f32 v24, v24, v21
    v_mul_f32 v25, v25, v21
    v_mul_f32 v26, v26, v21
    v_mul_f32 v27, v27, v21
    v_accvgpr_write_b32 a12, v24
    v_accvgpr_write_b32 a13, v25
    v_accvgpr_write_b32 a14, v26
    v_accvgpr_write_b32 a15, v27
    v_accvgpr_read_b32 v24, a16
    v_accvgpr_read_b32 v25, a17
    v_accvgpr_read_b32 v26, a18
    v_accvgpr_read_b32 v27, a19
    v_mul_f32 v24, v24, v20
    v_mul_f32 v25, v25, v20
    v_mul_f32 v26, v26, v20
    v_mul_f32 v27, v27, v20
    v_accvgpr_write_b32 a16, v24
    v_accvgpr_write_b32 a17, v25
    v_accvgpr_write_b32 a18, v26
    v_accvgpr_write_b32 a19, v27
    v_accvgpr_read_b32 v24, a20
    v_accvgpr_read_b32 v25, a21
    v_accvgpr_read_b32 v26, a22
    v_accvgpr_read_b32 v27, a23
    v_mul_f32 v24, v24, v21
    v_mul_f32 v25, v25, v21
    v_mul_f32 v26, v26, v21
    v_mul_f32 v27, v27, v21
    v_accvgpr_write_b32 a20, v24
    v_accvgpr_write_b32 a21, v25
    v_accvgpr_write_b32 a22, v26
    v_accvgpr_write_b32 a23, v27
    v_accvgpr_read_b32 v24, a24
    v_accvgpr_read_b32 v25, a25
    v_accvgpr_read_b32 v26, a26
    v_accvgpr_read_b32 v27, a27
    v_mul_f32 v24, v24, v20
    v_mul_f32 v25, v25, v20
    v_mul_f32 v26, v26, v20
    v_mul_f32 v27, v27, v20
    v_accvgpr_write_b32 a24, v24
    v_accvgpr_write_b32 a25, v25
    v_accvgpr_write_b32 a26, v26
    v_accvgpr_write_b32 a27, v27
    v_accvgpr_read_b32 v24, a28
    v_accvgpr_read_b32 v25, a29
    v_accvgpr_read_b32 v26, a30
    v_accvgpr_read_b32 v27, a31
    v_mul_f32 v24, v24, v21
    v_mul_f32 v25, v25, v21
    v_mul_f32 v26, v26, v21
    v_mul_f32 v27, v27, v21
    v_accvgpr_write_b32 a28, v24
    v_accvgpr_write_b32 a29, v25
    v_accvgpr_write_b32 a30, v26
    v_accvgpr_write_b32 a31, v27
    v_accvgpr_read_b32 v24, a32
    v_accvgpr_read_b32 v25, a33
    v_accvgpr_read_b32 v26, a34
    v_accvgpr_read_b32 v27, a35
    v_mul_f32 v24, v24, v20
    v_mul_f32 v25, v25, v20
    v_mul_f32 v26, v26, v20
    v_mul_f32 v27, v27, v20
    v_accvgpr_write_b32 a32, v24
    v_accvgpr_write_b32 a33, v25
    v_accvgpr_write_b32 a34, v26
    v_accvgpr_write_b32 a35, v27
    v_accvgpr_read_b32 v24, a36
    v_accvgpr_read_b32 v25, a37
    v_accvgpr_read_b32 v26, a38
    v_accvgpr_read_b32 v27, a39
    v_mul_f32 v24, v24, v21
    v_mul_f32 v25, v25, v21
    v_mul_f32 v26, v26, v21
    v_mul_f32 v27, v27, v21
    v_accvgpr_write_b32 a36, v24
    v_accvgpr_write_b32 a37, v25
    v_accvgpr_write_b32 a38, v26
    v_accvgpr_write_b32 a39, v27
    v_accvgpr_read_b32 v24, a40
    v_accvgpr_read_b32 v25, a41
    v_accvgpr_read_b32 v26, a42
    v_accvgpr_read_b32 v27, a43
    v_mul_f32 v24, v24, v20
    v_mul_f32 v25, v25, v20
    v_mul_f32 v26, v26, v20
    v_mul_f32 v27, v27, v20
    v_accvgpr_write_b32 a40, v24
    v_accvgpr_write_b32 a41, v25
    v_accvgpr_write_b32 a42, v26
    v_accvgpr_write_b32 a43, v27
    v_accvgpr_read_b32 v24, a44
    v_accvgpr_read_b32 v25, a45
    v_accvgpr_read_b32 v26, a46
    v_accvgpr_read_b32 v27, a47
    v_mul_f32 v24, v24, v21
    v_mul_f32 v25, v25, v21
    v_mul_f32 v26, v26, v21
    v_mul_f32 v27, v27, v21
    v_accvgpr_write_b32 a44, v24
    v_accvgpr_write_b32 a45, v25
    v_accvgpr_write_b32 a46, v26
    v_accvgpr_write_b32 a47, v27
    v_accvgpr_read_b32 v24, a48
    v_accvgpr_read_b32 v25, a49
    v_accvgpr_read_b32 v26, a50
    v_accvgpr_read_b32 v27, a51
    v_mul_f32 v24, v24, v20
    v_mul_f32 v25, v25, v20
    v_mul_f32 v26, v26, v20
    v_mul_f32 v27, v27, v20
    v_accvgpr_write_b32 a48, v24
    v_accvgpr_write_b32 a49, v25
    v_accvgpr_write_b32 a50, v26
    v_accvgpr_write_b32 a51, v27
    v_accvgpr_read_b32 v24, a52
    v_accvgpr_read_b32 v25, a53
    v_accvgpr_read_b32 v26, a54
    v_accvgpr_read_b32 v27, a55
    v_mul_f32 v24, v24, v21
    v_mul_f32 v25, v25, v21
    v_mul_f32 v26, v26, v21
    v_mul_f32 v27, v27, v21
    v_accvgpr_write_b32 a52, v24
    v_accvgpr_write_b32 a53, v25
    v_accvgpr_write_b32 a54, v26
    v_accvgpr_write_b32 a55, v27
    v_accvgpr_read_b32 v24, a56
    v_accvgpr_read_b32 v25, a57
    v_accvgpr_read_b32 v26, a58
    v_accvgpr_read_b32 v27, a59
    v_mul_f32 v24, v24, v20
    v_mul_f32 v25, v25, v20
    v_mul_f32 v26, v26, v20
    v_mul_f32 v27, v27, v20
    v_accvgpr_write_b32 a56, v24
    v_accvgpr_write_b32 a57, v25
    v_accvgpr_write_b32 a58, v26
    v_accvgpr_write_b32 a59, v27
    v_accvgpr_read_b32 v24, a60
    v_accvgpr_read_b32 v25, a61
    v_accvgpr_read_b32 v26, a62
    v_accvgpr_read_b32 v27, a63
    v_mul_f32 v24, v24, v21
    v_mul_f32 v25, v25, v21
    v_mul_f32 v26, v26, v21
    v_mul_f32 v27, v27, v21
    v_accvgpr_write_b32 a60, v24
    v_accvgpr_write_b32 a61, v25
    v_accvgpr_write_b32 a62, v26
    v_accvgpr_write_b32 a63, v27
    v_accvgpr_read_b32 v24, a64
    v_accvgpr_read_b32 v25, a65
    v_accvgpr_read_b32 v26, a66
    v_accvgpr_read_b32 v27, a67
    v_mul_f32 v24, v24, v20
    v_mul_f32 v25, v25, v20
    v_mul_f32 v26, v26, v20
    v_mul_f32 v27, v27, v20
    v_accvgpr_write_b32 a64, v24
    v_accvgpr_write_b32 a65, v25
    v_accvgpr_write_b32 a66, v26
    v_accvgpr_write_b32 a67, v27
    v_accvgpr_read_b32 v24, a68
    v_accvgpr_read_b32 v25, a69
    v_accvgpr_read_b32 v26, a70
    v_accvgpr_read_b32 v27, a71
    v_mul_f32 v24, v24, v21
    v_mul_f32 v25, v25, v21
    v_mul_f32 v26, v26, v21
    v_mul_f32 v27, v27, v21
    v_accvgpr_write_b32 a68, v24
    v_accvgpr_write_b32 a69, v25
    v_accvgpr_write_b32 a70, v26
    v_accvgpr_write_b32 a71, v27
    v_accvgpr_read_b32 v24, a72
    v_accvgpr_read_b32 v25, a73
    v_accvgpr_read_b32 v26, a74
    v_accvgpr_read_b32 v27, a75
    v_mul_f32 v24, v24, v20
    v_mul_f32 v25, v25, v20
    v_mul_f32 v26, v26, v20
    v_mul_f32 v27, v27, v20
    v_accvgpr_write_b32 a72, v24
    v_accvgpr_write_b32 a73, v25
    v_accvgpr_write_b32 a74, v26
    v_accvgpr_write_b32 a75, v27
    v_accvgpr_read_b32 v24, a76
    v_accvgpr_read_b32 v25, a77
    v_accvgpr_read_b32 v26, a78
    v_accvgpr_read_b32 v27, a79
    v_mul_f32 v24, v24, v21
    v_mul_f32 v25, v25, v21
    v_mul_f32 v26, v26, v21
    v_mul_f32 v27, v27, v21
    v_accvgpr_write_b32 a76, v24
    v_accvgpr_write_b32 a77, v25
    v_accvgpr_write_b32 a78, v26
    v_accvgpr_write_b32 a79, v27
    v_accvgpr_read_b32 v24, a80
    v_accvgpr_read_b32 v25, a81
    v_accvgpr_read_b32 v26, a82
    v_accvgpr_read_b32 v27, a83
    v_mul_f32 v24, v24, v20
    v_mul_f32 v25, v25, v20
    v_mul_f32 v26, v26, v20
    v_mul_f32 v27, v27, v20
    v_accvgpr_write_b32 a80, v24
    v_accvgpr_write_b32 a81, v25
    v_accvgpr_write_b32 a82, v26
    v_accvgpr_write_b32 a83, v27
    v_accvgpr_read_b32 v24, a84
    v_accvgpr_read_b32 v25, a85
    v_accvgpr_read_b32 v26, a86
    v_accvgpr_read_b32 v27, a87
    v_mul_f32 v24, v24, v21
    v_mul_f32 v25, v25, v21
    v_mul_f32 v26, v26, v21
    v_mul_f32 v27, v27, v21
    v_accvgpr_write_b32 a84, v24
    v_accvgpr_write_b32 a85, v25
    v_accvgpr_write_b32 a86, v26
    v_accvgpr_write_b32 a87, v27
    v_accvgpr_read_b32 v24, a88
    v_accvgpr_read_b32 v25, a89
    v_accvgpr_read_b32 v26, a90
    v_accvgpr_read_b32 v27, a91
    v_mul_f32 v24, v24, v20
    v_mul_f32 v25, v25, v20
    v_mul_f32 v26, v26, v20
    v_mul_f32 v27, v27, v20
    v_accvgpr_write_b32 a88, v24
    v_accvgpr_write_b32 a89, v25
    v_accvgpr_write_b32 a90, v26
    v_accvgpr_write_b32 a91, v27
    v_accvgpr_read_b32 v24, a92
    v_accvgpr_read_b32 v25, a93
    v_accvgpr_read_b32 v26, a94
    v_accvgpr_read_b32 v27, a95
    v_mul_f32 v24, v24, v21
    v_mul_f32 v25, v25, v21
    v_mul_f32 v26, v26, v21
    v_mul_f32 v27, v27, v21
    v_accvgpr_write_b32 a92, v24
    v_accvgpr_write_b32 a93, v25
    v_accvgpr_write_b32 a94, v26
    v_accvgpr_write_b32 a95, v27
    v_accvgpr_read_b32 v24, a96
    v_accvgpr_read_b32 v25, a97
    v_accvgpr_read_b32 v26, a98
    v_accvgpr_read_b32 v27, a99
    v_mul_f32 v24, v24, v20
    v_mul_f32 v25, v25, v20
    v_mul_f32 v26, v26, v20
    v_mul_f32 v27, v27, v20
    v_accvgpr_write_b32 a96, v24
    v_accvgpr_write_b32 a97, v25
    v_accvgpr_write_b32 a98, v26
    v_accvgpr_write_b32 a99, v27
    v_accvgpr_read_b32 v24, a100
    v_accvgpr_read_b32 v25, a101
    v_accvgpr_read_b32 v26, a102
    v_accvgpr_read_b32 v27, a103
    v_mul_f32 v24, v24, v21
    v_mul_f32 v25, v25, v21
    v_mul_f32 v26, v26, v21
    v_mul_f32 v27, v27, v21
    v_accvgpr_write_b32 a100, v24
    v_accvgpr_write_b32 a101, v25
    v_accvgpr_write_b32 a102, v26
    v_accvgpr_write_b32 a103, v27
    v_accvgpr_read_b32 v24, a104
    v_accvgpr_read_b32 v25, a105
    v_accvgpr_read_b32 v26, a106
    v_accvgpr_read_b32 v27, a107
    v_mul_f32 v24, v24, v20
    v_mul_f32 v25, v25, v20
    v_mul_f32 v26, v26, v20
    v_mul_f32 v27, v27, v20
    v_accvgpr_write_b32 a104, v24
    v_accvgpr_write_b32 a105, v25
    v_accvgpr_write_b32 a106, v26
    v_accvgpr_write_b32 a107, v27
    v_accvgpr_read_b32 v24, a108
    v_accvgpr_read_b32 v25, a109
    v_accvgpr_read_b32 v26, a110
    v_accvgpr_read_b32 v27, a111
    v_mul_f32 v24, v24, v21
    v_mul_f32 v25, v25, v21
    v_mul_f32 v26, v26, v21
    v_mul_f32 v27, v27, v21
    v_accvgpr_write_b32 a108, v24
    v_accvgpr_write_b32 a109, v25
    v_accvgpr_write_b32 a110, v26
    v_accvgpr_write_b32 a111, v27
    v_accvgpr_read_b32 v24, a112
    v_accvgpr_read_b32 v25, a113
    v_accvgpr_read_b32 v26, a114
    v_accvgpr_read_b32 v27, a115
    v_mul_f32 v24, v24, v20
    v_mul_f32 v25, v25, v20
    v_mul_f32 v26, v26, v20
    v_mul_f32 v27, v27, v20
    v_accvgpr_write_b32 a112, v24
    v_accvgpr_write_b32 a113, v25
    v_accvgpr_write_b32 a114, v26
    v_accvgpr_write_b32 a115, v27
    v_accvgpr_read_b32 v24, a116
    v_accvgpr_read_b32 v25, a117
    v_accvgpr_read_b32 v26, a118
    v_accvgpr_read_b32 v27, a119
    v_mul_f32 v24, v24, v21
    v_mul_f32 v25, v25, v21
    v_mul_f32 v26, v26, v21
    v_mul_f32 v27, v27, v21
    v_accvgpr_write_b32 a116, v24
    v_accvgpr_write_b32 a117, v25
    v_accvgpr_write_b32 a118, v26
    v_accvgpr_write_b32 a119, v27
    v_accvgpr_read_b32 v24, a120
    v_accvgpr_read_b32 v25, a121
    v_accvgpr_read_b32 v26, a122
    v_accvgpr_read_b32 v27, a123
    v_mul_f32 v24, v24, v20
    v_mul_f32 v25, v25, v20
    v_mul_f32 v26, v26, v20
    v_mul_f32 v27, v27, v20
    v_accvgpr_write_b32 a120, v24
    v_accvgpr_write_b32 a121, v25
    v_accvgpr_write_b32 a122, v26
    v_accvgpr_write_b32 a123, v27
    v_accvgpr_read_b32 v24, a124
    v_accvgpr_read_b32 v25, a125
    v_accvgpr_read_b32 v26, a126
    v_accvgpr_read_b32 v27, a127
    v_mul_f32 v24, v24, v21
    v_mul_f32 v25, v25, v21
    v_mul_f32 v26, v26, v21
    v_mul_f32 v27, v27, v21
    v_accvgpr_write_b32 a124, v24
    v_accvgpr_write_b32 a125, v25
    v_accvgpr_write_b32 a126, v26
    v_accvgpr_write_b32 a127, v27
    s_nop 3
    s_branch BACK_30_0
.globl k2_kernel
.p2align 8
.type k2_kernel,@function
k2_kernel:
    s_cmp_ge_u32 s2, 256
    s_cbranch_scc1 K2_END
    s_load_dwordx2 s[4:5], s[0:1], 0
    s_load_dwordx2 s[8:9], s[0:1], 48
    s_load_dwordx2 s[12:13], s[0:1], 112
    s_load_dwordx2 s[16:17], s[0:1], 96
    s_load_dwordx2 s[36:37], s[0:1], 104
    s_load_dwordx2 s[40:41], s[0:1], 56
    s_load_dwordx2 s[44:45], s[0:1], 64
    s_load_dwordx2 s[48:49], s[0:1], 72
    s_waitcnt lgkmcnt(0)
    s_and_b32 s5, s5, 0xffff
    s_mov_b32 s6, 1835008
    s_mov_b32 s7, 0x00020000
    s_and_b32 s9, s9, 0xffff
    s_mov_b32 s10, 896
    s_mov_b32 s11, 0x00020000
    s_and_b32 s13, s13, 0xffff
    s_mov_b32 s14, 18874368
    s_mov_b32 s15, 0x00020000
    s_and_b32 s17, s17, 0xffff
    s_mov_b32 s18, 1835008
    s_mov_b32 s19, 0x00020000
    s_and_b32 s37, s37, 0xffff
    s_mov_b32 s38, 256
    s_mov_b32 s39, 0x00020000
    s_and_b32 s41, s41, 0xffff
    s_mov_b32 s42, 1605632
    s_mov_b32 s43, 0x00020000
    s_and_b32 s45, s45, 0xffff
    s_mov_b32 s46, 1605632
    s_mov_b32 s47, 0x00020000
    s_and_b32 s49, s49, 0xffff
    s_mov_b32 s50, 1605632
    s_mov_b32 s51, 0x00020000
    v_and_b32 v1, 7, v0
    v_lshrrev_b32 v2, 3, v0
    s_lshr_b32 s20, s2, 2
    s_mul_i32 s20, s20, 28672
    s_and_b32 s21, s2, 3
    s_lshl_b32 s21, s21, 7
    s_add_u32 s20, s20, s21
    s_add_u32 s20, s20, 4194304
    v_lshlrev_b32 v3, 9, v2
    v_lshl_add_u32 v3, v1, 4, v3
    v_add_u32 v4, 16384, v3
    v_cmp_gt_u32 vcc, 24, v2
    v_mov_b32 v9, 0x7ff00000
    s_nop 1
    v_cndmask_b32 v4, v9, v4, vcc
    s_lshl_b32 s22, s2, 3
    v_add_u32 v5, s22, v1
    v_mul_u32_u24 v6, 896, v5
    v_lshl_add_u32 v6, v2, 4, v6
    v_add_u32 v7, 512, v6
    v_cndmask_b32 v7, v9, v7, vcc
    v_lshlrev_b32 v8, 5, v2
    v_add_u32 v10, 1024, v8
    v_cndmask_b32 v10, v9, v10, vcc
    v_lshlrev_b32 v11, 4, v2
    v_add_u32 v12, 512, v11
    v_cndmask_b32 v12, v9, v12, vcc
    buffer_load_dwordx4 v[32:35], v3, s[12:15], s20 offen
    buffer_load_dwordx4 v[36:39], v4, s[12:15], s20 offen
    s_add_u32 s20, s20, 1835008
    buffer_load_dwordx4 v[40:43], v3, s[12:15], s20 offen
    buffer_load_dwordx4 v[44:47], v4, s[12:15], s20 offen
    s_add_u32 s20, s20, 1835008
    buffer_load_dwordx4 v[48:51], v3, s[12:15], s20 offen
    buffer_load_dwordx4 v[52:55], v4, s[12:15], s20 offen
    s_add_u32 s20, s20, 1835008
    buffer_load_dwordx4 v[56:59], v3, s[12:15], s20 offen
    buffer_load_dwordx4 v[60:63], v4, s[12:15], s20 offen
    s_add_u32 s20, s20, 1835008
    buffer_load_dwordx4 v[64:67], v3, s[12:15], s20 offen
    buffer_load_dwordx4 v[68:71], v4, s[12:15], s20 offen
    s_add_u32 s20, s20, 1835008
    buffer_load_dwordx4 v[72:75], v3, s[12:15], s20 offen
    buffer_load_dwordx4 v[76:79], v4, s[12:15], s20 offen
    s_add_u32 s20, s20, 1835008
    buffer_load_dwordx4 v[80:83], v3, s[12:15], s20 offen
    buffer_load_dwordx4 v[84:87], v4, s[12:15], s20 offen
    s_add_u32 s20, s20, 1835008
    buffer_load_dwordx4 v[88:91], v3, s[12:15], s20 offen
    buffer_load_dwordx4 v[92:95], v4, s[12:15], s20 offen
    s_add_u32 s20, s20, 1835008
    buffer_load_dwordx4 v[96:99], v6, s[4:7], 0 offen
    buffer_load_dwordx4 v[100:103], v7, s[4:7], 0 offen
    buffer_load_dwordx4 v[104:107], v11, s[8:11], 0 offen
    buffer_load_dwordx4 v[108:111], v12, s[8:11], 0 offen
    s_mov_b32 s21, 3584
    buffer_load_dwordx4 v[112:115], v8, s[12:15], s21 offen
    buffer_load_dwordx4 v[116:119], v8, s[12:15], s21 offen offset:16
    buffer_load_dwordx4 v[120:123], v10, s[12:15], s21 offen
    buffer_load_dwordx4 v[124:127], v10, s[12:15], s21 offen offset:16
    s_mov_b32 s21, 7168
    buffer_load_dwordx4 v[128:131], v8, s[12:15], s21 offen
    buffer_load_dwordx4 v[132:135], v8, s[12:15], s21 offen offset:16
    buffer_load_dwordx4 v[136:139], v10, s[12:15], s21 offen
    buffer_load_dwordx4 v[140:143], v10, s[12:15], s21 offen offset:16
    s_mov_b32 s21, 5376
    buffer_load_dwordx4 v[144:147], v8, s[12:15], s21 offen
    buffer_load_dwordx4 v[148:151], v8, s[12:15], s21 offen offset:16
    buffer_load_dwordx4 v[152:155], v10, s[12:15], s21 offen
    buffer_load_dwordx4 v[156:159], v10, s[12:15], s21 offen offset:16
    s_mov_b32 s21, 8960
    buffer_load_dwordx4 v[160:163], v8, s[12:15], s21 offen
    buffer_load_dwordx4 v[164:167], v8, s[12:15], s21 offen offset:16
    buffer_load_dwordx4 v[168:171], v10, s[12:15], s21 offen
    buffer_load_dwordx4 v[172:175], v10, s[12:15], s21 offen offset:16
    s_waitcnt vmcnt(20)
    v_lshlrev_b32 v176, 16, v32
    v_and_b32 v177, 0xffff0000, v32
    v_lshlrev_b32 v178, 16, v33
    v_and_b32 v179, 0xffff0000, v33
    v_lshlrev_b32 v180, 16, v34
    v_and_b32 v181, 0xffff0000, v34
    v_lshlrev_b32 v182, 16, v35
    v_and_b32 v183, 0xffff0000, v35
    v_lshlrev_b32 v184, 16, v36
    v_and_b32 v185, 0xffff0000, v36
    v_lshlrev_b32 v186, 16, v37
    v_and_b32 v187, 0xffff0000, v37
    v_lshlrev_b32 v188, 16, v38
    v_and_b32 v189, 0xffff0000, v38
    v_lshlrev_b32 v190, 16, v39
    v_and_b32 v191, 0xffff0000, v39
    v_lshlrev_b32 v192, 16, v40
    v_and_b32 v193, 0xffff0000, v40
    v_lshlrev_b32 v194, 16, v41
    v_and_b32 v195, 0xffff0000, v41
    v_lshlrev_b32 v196, 16, v42
    v_and_b32 v197, 0xffff0000, v42
    v_lshlrev_b32 v198, 16, v43
    v_and_b32 v199, 0xffff0000, v43
    v_add_f32 v176, v176, v192
    v_add_f32 v177, v177, v193
    v_add_f32 v178, v178, v194
    v_add_f32 v179, v179, v195
    v_add_f32 v180, v180, v196
    v_add_f32 v181, v181, v197
    v_add_f32 v182, v182, v198
    v_add_f32 v183, v183, v199
    v_lshlrev_b32 v192, 16, v44
    v_and_b32 v193, 0xffff0000, v44
    v_lshlrev_b32 v194, 16, v45
    v_and_b32 v195, 0xffff0000, v45
    v_lshlrev_b32 v196, 16, v46
    v_and_b32 v197, 0xffff0000, v46
    v_lshlrev_b32 v198, 16, v47
    v_and_b32 v199, 0xffff0000, v47
    v_add_f32 v184, v184, v192
    v_add_f32 v185, v185, v193
    v_add_f32 v186, v186, v194
    v_add_f32 v187, v187, v195
    v_add_f32 v188, v188, v196
    v_add_f32 v189, v189, v197
    v_add_f32 v190, v190, v198
    v_add_f32 v191, v191, v199
    v_lshlrev_b32 v192, 16, v48
    v_and_b32 v193, 0xffff0000, v48
    v_lshlrev_b32 v194, 16, v49
    v_and_b32 v195, 0xffff0000, v49
    v_lshlrev_b32 v196, 16, v50
    v_and_b32 v197, 0xffff0000, v50
    v_lshlrev_b32 v198, 16, v51
    v_and_b32 v199, 0xffff0000, v51
    v_add_f32 v176, v176, v192
    v_add_f32 v177, v177, v193
    v_add_f32 v178, v178, v194
    v_add_f32 v179, v179, v195
    v_add_f32 v180, v180, v196
    v_add_f32 v181, v181, v197
    v_add_f32 v182, v182, v198
    v_add_f32 v183, v183, v199
    v_lshlrev_b32 v192, 16, v52
    v_and_b32 v193, 0xffff0000, v52
    v_lshlrev_b32 v194, 16, v53
    v_and_b32 v195, 0xffff0000, v53
    v_lshlrev_b32 v196, 16, v54
    v_and_b32 v197, 0xffff0000, v54
    v_lshlrev_b32 v198, 16, v55
    v_and_b32 v199, 0xffff0000, v55
    v_add_f32 v184, v184, v192
    v_add_f32 v185, v185, v193
    v_add_f32 v186, v186, v194
    v_add_f32 v187, v187, v195
    v_add_f32 v188, v188, v196
    v_add_f32 v189, v189, v197
    v_add_f32 v190, v190, v198
    v_add_f32 v191, v191, v199
    v_lshlrev_b32 v192, 16, v56
    v_and_b32 v193, 0xffff0000, v56
    v_lshlrev_b32 v194, 16, v57
    v_and_b32 v195, 0xffff0000, v57
    v_lshlrev_b32 v196, 16, v58
    v_and_b32 v197, 0xffff0000, v58
    v_lshlrev_b32 v198, 16, v59
    v_and_b32 v199, 0xffff0000, v59
    v_add_f32 v176, v176, v192
    v_add_f32 v177, v177, v193
    v_add_f32 v178, v178, v194
    v_add_f32 v179, v179, v195
    v_add_f32 v180, v180, v196
    v_add_f32 v181, v181, v197
    v_add_f32 v182, v182, v198
    v_add_f32 v183, v183, v199
    v_lshlrev_b32 v192, 16, v60
    v_and_b32 v193, 0xffff0000, v60
    v_lshlrev_b32 v194, 16, v61
    v_and_b32 v195, 0xffff0000, v61
    v_lshlrev_b32 v196, 16, v62
    v_and_b32 v197, 0xffff0000, v62
    v_lshlrev_b32 v198, 16, v63
    v_and_b32 v199, 0xffff0000, v63
    v_add_f32 v184, v184, v192
    v_add_f32 v185, v185, v193
    v_add_f32 v186, v186, v194
    v_add_f32 v187, v187, v195
    v_add_f32 v188, v188, v196
    v_add_f32 v189, v189, v197
    v_add_f32 v190, v190, v198
    v_add_f32 v191, v191, v199
    v_lshlrev_b32 v192, 16, v64
    v_and_b32 v193, 0xffff0000, v64
    v_lshlrev_b32 v194, 16, v65
    v_and_b32 v195, 0xffff0000, v65
    v_lshlrev_b32 v196, 16, v66
    v_and_b32 v197, 0xffff0000, v66
    v_lshlrev_b32 v198, 16, v67
    v_and_b32 v199, 0xffff0000, v67
    v_add_f32 v176, v176, v192
    v_add_f32 v177, v177, v193
    v_add_f32 v178, v178, v194
    v_add_f32 v179, v179, v195
    v_add_f32 v180, v180, v196
    v_add_f32 v181, v181, v197
    v_add_f32 v182, v182, v198
    v_add_f32 v183, v183, v199
    v_lshlrev_b32 v192, 16, v68
    v_and_b32 v193, 0xffff0000, v68
    v_lshlrev_b32 v194, 16, v69
    v_and_b32 v195, 0xffff0000, v69
    v_lshlrev_b32 v196, 16, v70
    v_and_b32 v197, 0xffff0000, v70
    v_lshlrev_b32 v198, 16, v71
    v_and_b32 v199, 0xffff0000, v71
    v_add_f32 v184, v184, v192
    v_add_f32 v185, v185, v193
    v_add_f32 v186, v186, v194
    v_add_f32 v187, v187, v195
    v_add_f32 v188, v188, v196
    v_add_f32 v189, v189, v197
    v_add_f32 v190, v190, v198
    v_add_f32 v191, v191, v199
    v_lshlrev_b32 v192, 16, v72
    v_and_b32 v193, 0xffff0000, v72
    v_lshlrev_b32 v194, 16, v73
    v_and_b32 v195, 0xffff0000, v73
    v_lshlrev_b32 v196, 16, v74
    v_and_b32 v197, 0xffff0000, v74
    v_lshlrev_b32 v198, 16, v75
    v_and_b32 v199, 0xffff0000, v75
    v_add_f32 v176, v176, v192
    v_add_f32 v177, v177, v193
    v_add_f32 v178, v178, v194
    v_add_f32 v179, v179, v195
    v_add_f32 v180, v180, v196
    v_add_f32 v181, v181, v197
    v_add_f32 v182, v182, v198
    v_add_f32 v183, v183, v199
    v_lshlrev_b32 v192, 16, v76
    v_and_b32 v193, 0xffff0000, v76
    v_lshlrev_b32 v194, 16, v77
    v_and_b32 v195, 0xffff0000, v77
    v_lshlrev_b32 v196, 16, v78
    v_and_b32 v197, 0xffff0000, v78
    v_lshlrev_b32 v198, 16, v79
    v_and_b32 v199, 0xffff0000, v79
    v_add_f32 v184, v184, v192
    v_add_f32 v185, v185, v193
    v_add_f32 v186, v186, v194
    v_add_f32 v187, v187, v195
    v_add_f32 v188, v188, v196
    v_add_f32 v189, v189, v197
    v_add_f32 v190, v190, v198
    v_add_f32 v191, v191, v199
    v_lshlrev_b32 v192, 16, v80
    v_and_b32 v193, 0xffff0000, v80
    v_lshlrev_b32 v194, 16, v81
    v_and_b32 v195, 0xffff0000, v81
    v_lshlrev_b32 v196, 16, v82
    v_and_b32 v197, 0xffff0000, v82
    v_lshlrev_b32 v198, 16, v83
    v_and_b32 v199, 0xffff0000, v83
    v_add_f32 v176, v176, v192
    v_add_f32 v177, v177, v193
    v_add_f32 v178, v178, v194
    v_add_f32 v179, v179, v195
    v_add_f32 v180, v180, v196
    v_add_f32 v181, v181, v197
    v_add_f32 v182, v182, v198
    v_add_f32 v183, v183, v199
    v_lshlrev_b32 v192, 16, v84
    v_and_b32 v193, 0xffff0000, v84
    v_lshlrev_b32 v194, 16, v85
    v_and_b32 v195, 0xffff0000, v85
    v_lshlrev_b32 v196, 16, v86
    v_and_b32 v197, 0xffff0000, v86
    v_lshlrev_b32 v198, 16, v87
    v_and_b32 v199, 0xffff0000, v87
    v_add_f32 v184, v184, v192
    v_add_f32 v185, v185, v193
    v_add_f32 v186, v186, v194
    v_add_f32 v187, v187, v195
    v_add_f32 v188, v188, v196
    v_add_f32 v189, v189, v197
    v_add_f32 v190, v190, v198
    v_add_f32 v191, v191, v199
    v_lshlrev_b32 v192, 16, v88
    v_and_b32 v193, 0xffff0000, v88
    v_lshlrev_b32 v194, 16, v89
    v_and_b32 v195, 0xffff0000, v89
    v_lshlrev_b32 v196, 16, v90
    v_and_b32 v197, 0xffff0000, v90
    v_lshlrev_b32 v198, 16, v91
    v_and_b32 v199, 0xffff0000, v91
    v_add_f32 v176, v176, v192
    v_add_f32 v177, v177, v193
    v_add_f32 v178, v178, v194
    v_add_f32 v179, v179, v195
    v_add_f32 v180, v180, v196
    v_add_f32 v181, v181, v197
    v_add_f32 v182, v182, v198
    v_add_f32 v183, v183, v199
    v_lshlrev_b32 v192, 16, v92
    v_and_b32 v193, 0xffff0000, v92
    v_lshlrev_b32 v194, 16, v93
    v_and_b32 v195, 0xffff0000, v93
    v_lshlrev_b32 v196, 16, v94
    v_and_b32 v197, 0xffff0000, v94
    v_lshlrev_b32 v198, 16, v95
    v_and_b32 v199, 0xffff0000, v95
    v_add_f32 v184, v184, v192
    v_add_f32 v185, v185, v193
    v_add_f32 v186, v186, v194
    v_add_f32 v187, v187, v195
    v_add_f32 v188, v188, v196
    v_add_f32 v189, v189, v197
    v_add_f32 v190, v190, v198
    v_add_f32 v191, v191, v199
    s_waitcnt vmcnt(0)
    v_lshlrev_b32 v192, 16, v96
    v_and_b32 v193, 0xffff0000, v96
    v_lshlrev_b32 v194, 16, v97
    v_and_b32 v195, 0xffff0000, v97
    v_lshlrev_b32 v196, 16, v98
    v_and_b32 v197, 0xffff0000, v98
    v_lshlrev_b32 v198, 16, v99
    v_and_b32 v199, 0xffff0000, v99
    v_lshlrev_b32 v200, 16, v100
    v_and_b32 v201, 0xffff0000, v100
    v_lshlrev_b32 v202, 16, v101
    v_and_b32 v203, 0xffff0000, v101
    v_lshlrev_b32 v204, 16, v102
    v_and_b32 v205, 0xffff0000, v102
    v_lshlrev_b32 v206, 16, v103
    v_and_b32 v207, 0xffff0000, v103
    v_mov_b32 v14, 0
    v_mov_b32 v15, 0
    v_cvt_pk_bf16_f32 v176, v176, v176
    v_lshlrev_b32 v176, 16, v176
    v_mul_f32 v176, v176, v112
    v_cvt_pk_bf16_f32 v176, v176, v176
    v_lshlrev_b32 v176, 16, v176
    v_add_f32 v176, v176, v192
    v_cvt_pk_bf16_f32 v176, v176, v176
    v_lshlrev_b32 v176, 16, v176
    v_add_f32 v14, v14, v176
    v_fmac_f32 v15, v176, v176
    v_cvt_pk_bf16_f32 v177, v177, v177
    v_lshlrev_b32 v177, 16, v177
    v_mul_f32 v177, v177, v113
    v_cvt_pk_bf16_f32 v177, v177, v177
    v_lshlrev_b32 v177, 16, v177
    v_add_f32 v177, v177, v193
    v_cvt_pk_bf16_f32 v177, v177, v177
    v_lshlrev_b32 v177, 16, v177
    v_add_f32 v14, v14, v177
    v_fmac_f32 v15, v177, v177
    v_cvt_pk_bf16_f32 v178, v178, v178
    v_lshlrev_b32 v178, 16, v178
    v_mul_f32 v178, v178, v114
    v_cvt_pk_bf16_f32 v178, v178, v178
    v_lshlrev_b32 v178, 16, v178
    v_add_f32 v178, v178, v194
    v_cvt_pk_bf16_f32 v178, v178, v178
    v_lshlrev_b32 v178, 16, v178
    v_add_f32 v14, v14, v178
    v_fmac_f32 v15, v178, v178
    v_cvt_pk_bf16_f32 v179, v179, v179
    v_lshlrev_b32 v179, 16, v179
    v_mul_f32 v179, v179, v115
    v_cvt_pk_bf16_f32 v179, v179, v179
    v_lshlrev_b32 v179, 16, v179
    v_add_f32 v179, v179, v195
    v_cvt_pk_bf16_f32 v179, v179, v179
    v_lshlrev_b32 v179, 16, v179
    v_add_f32 v14, v14, v179
    v_fmac_f32 v15, v179, v179
    v_cvt_pk_bf16_f32 v180, v180, v180
    v_lshlrev_b32 v180, 16, v180
    v_mul_f32 v180, v180, v116
    v_cvt_pk_bf16_f32 v180, v180, v180
    v_lshlrev_b32 v180, 16, v180
    v_add_f32 v180, v180, v196
    v_cvt_pk_bf16_f32 v180, v180, v180
    v_lshlrev_b32 v180, 16, v180
    v_add_f32 v14, v14, v180
    v_fmac_f32 v15, v180, v180
    v_cvt_pk_bf16_f32 v181, v181, v181
    v_lshlrev_b32 v181, 16, v181
    v_mul_f32 v181, v181, v117
    v_cvt_pk_bf16_f32 v181, v181, v181
    v_lshlrev_b32 v181, 16, v181
    v_add_f32 v181, v181, v197
    v_cvt_pk_bf16_f32 v181, v181, v181
    v_lshlrev_b32 v181, 16, v181
    v_add_f32 v14, v14, v181
    v_fmac_f32 v15, v181, v181
    v_cvt_pk_bf16_f32 v182, v182, v182
    v_lshlrev_b32 v182, 16, v182
    v_mul_f32 v182, v182, v118
    v_cvt_pk_bf16_f32 v182, v182, v182
    v_lshlrev_b32 v182, 16, v182
    v_add_f32 v182, v182, v198
    v_cvt_pk_bf16_f32 v182, v182, v182
    v_lshlrev_b32 v182, 16, v182
    v_add_f32 v14, v14, v182
    v_fmac_f32 v15, v182, v182
    v_cvt_pk_bf16_f32 v183, v183, v183
    v_lshlrev_b32 v183, 16, v183
    v_mul_f32 v183, v183, v119
    v_cvt_pk_bf16_f32 v183, v183, v183
    v_lshlrev_b32 v183, 16, v183
    v_add_f32 v183, v183, v199
    v_cvt_pk_bf16_f32 v183, v183, v183
    v_lshlrev_b32 v183, 16, v183
    v_add_f32 v14, v14, v183
    v_fmac_f32 v15, v183, v183
    v_cvt_pk_bf16_f32 v184, v184, v184
    v_lshlrev_b32 v184, 16, v184
    v_mul_f32 v184, v184, v120
    v_cvt_pk_bf16_f32 v184, v184, v184
    v_lshlrev_b32 v184, 16, v184
    v_add_f32 v184, v184, v200
    v_cvt_pk_bf16_f32 v184, v184, v184
    v_lshlrev_b32 v184, 16, v184
    v_add_f32 v14, v14, v184
    v_fmac_f32 v15, v184, v184
    v_cvt_pk_bf16_f32 v185, v185, v185
    v_lshlrev_b32 v185, 16, v185
    v_mul_f32 v185, v185, v121
    v_cvt_pk_bf16_f32 v185, v185, v185
    v_lshlrev_b32 v185, 16, v185
    v_add_f32 v185, v185, v201
    v_cvt_pk_bf16_f32 v185, v185, v185
    v_lshlrev_b32 v185, 16, v185
    v_add_f32 v14, v14, v185
    v_fmac_f32 v15, v185, v185
    v_cvt_pk_bf16_f32 v186, v186, v186
    v_lshlrev_b32 v186, 16, v186
    v_mul_f32 v186, v186, v122
    v_cvt_pk_bf16_f32 v186, v186, v186
    v_lshlrev_b32 v186, 16, v186
    v_add_f32 v186, v186, v202
    v_cvt_pk_bf16_f32 v186, v186, v186
    v_lshlrev_b32 v186, 16, v186
    v_add_f32 v14, v14, v186
    v_fmac_f32 v15, v186, v186
    v_cvt_pk_bf16_f32 v187, v187, v187
    v_lshlrev_b32 v187, 16, v187
    v_mul_f32 v187, v187, v123
    v_cvt_pk_bf16_f32 v187, v187, v187
    v_lshlrev_b32 v187, 16, v187
    v_add_f32 v187, v187, v203
    v_cvt_pk_bf16_f32 v187, v187, v187
    v_lshlrev_b32 v187, 16, v187
    v_add_f32 v14, v14, v187
    v_fmac_f32 v15, v187, v187
    v_cvt_pk_bf16_f32 v188, v188, v188
    v_lshlrev_b32 v188, 16, v188
    v_mul_f32 v188, v188, v124
    v_cvt_pk_bf16_f32 v188, v188, v188
    v_lshlrev_b32 v188, 16, v188
    v_add_f32 v188, v188, v204
    v_cvt_pk_bf16_f32 v188, v188, v188
    v_lshlrev_b32 v188, 16, v188
    v_add_f32 v14, v14, v188
    v_fmac_f32 v15, v188, v188
    v_cvt_pk_bf16_f32 v189, v189, v189
    v_lshlrev_b32 v189, 16, v189
    v_mul_f32 v189, v189, v125
    v_cvt_pk_bf16_f32 v189, v189, v189
    v_lshlrev_b32 v189, 16, v189
    v_add_f32 v189, v189, v205
    v_cvt_pk_bf16_f32 v189, v189, v189
    v_lshlrev_b32 v189, 16, v189
    v_add_f32 v14, v14, v189
    v_fmac_f32 v15, v189, v189
    v_cvt_pk_bf16_f32 v190, v190, v190
    v_lshlrev_b32 v190, 16, v190
    v_mul_f32 v190, v190, v126
    v_cvt_pk_bf16_f32 v190, v190, v190
    v_lshlrev_b32 v190, 16, v190
    v_add_f32 v190, v190, v206
    v_cvt_pk_bf16_f32 v190, v190, v190
    v_lshlrev_b32 v190, 16, v190
    v_add_f32 v14, v14, v190
    v_fmac_f32 v15, v190, v190
    v_cvt_pk_bf16_f32 v191, v191, v191
    v_lshlrev_b32 v191, 16, v191
    v_mul_f32 v191, v191, v127
    v_cvt_pk_bf16_f32 v191, v191, v191
    v_lshlrev_b32 v191, 16, v191
    v_add_f32 v191, v191, v207
    v_cvt_pk_bf16_f32 v191, v191, v191
    v_lshlrev_b32 v191, 16, v191
    v_add_f32 v14, v14, v191
    v_fmac_f32 v15, v191, v191
    s_nop 1
    v_add_f32_dpp v14, v14, v14 row_ror:8 row_mask:0xf bank_mask:0xf
    v_mov_b32 v17, v14
    s_nop 1
    v_permlane16_swap_b32 v14, v17
    s_nop 1
    v_add_f32 v14, v14, v17
    v_mov_b32 v17, v14
    s_nop 1
    v_permlane32_swap_b32 v14, v17
    s_nop 1
    v_add_f32 v14, v14, v17
    s_nop 1
    v_add_f32_dpp v15, v15, v15 row_ror:8 row_mask:0xf bank_mask:0xf
    v_mov_b32 v17, v15
    s_nop 1
    v_permlane16_swap_b32 v15, v17
    s_nop 1
    v_add_f32 v15, v15, v17
    v_mov_b32 v17, v15
    s_nop 1
    v_permlane32_swap_b32 v15, v17
    s_nop 1
    v_add_f32 v15, v15, v17
    v_lshrrev_b32 v13, 6, v0
    v_lshlrev_b32 v13, 6, v13
    v_lshlrev_b32 v16, 3, v1
    v_add_u32 v13, v13, v16
    ds_write_b64 v13, v[14:15]
    s_waitcnt lgkmcnt(0)
    s_barrier
    ds_read_b64 v[32:33], v16 offset:0
    ds_read_b64 v[34:35], v16 offset:64
    ds_read_b64 v[36:37], v16 offset:128
    ds_read_b64 v[38:39], v16 offset:192
    s_waitcnt lgkmcnt(0)
    v_add_f32 v32, v32, v34
    v_add_f32 v33, v33, v35
    v_add_f32 v32, v32, v36
    v_add_f32 v33, v33, v37
    v_add_f32 v32, v32, v38
    v_add_f32 v33, v33, v39
    v_mul_f32 v32, 0x3b124925, v32
    v_mul_f32 v33, 0x3b124925, v33
    v_fma_f32 v33, -v32, v32, v33
    v_max_f32 v33, 0, v33
    v_add_f32 v33, 0x3727c5ac, v33
    v_rsq_f32 v33, v33
    s_nop 0
    v_mul_f32 v32, v32, v33
    v_lshlrev_b32 v40, 16, v104
    v_and_b32 v41, 0xffff0000, v104
    v_lshlrev_b32 v42, 16, v105
    v_and_b32 v43, 0xffff0000, v105
    v_lshlrev_b32 v44, 16, v106
    v_and_b32 v45, 0xffff0000, v106
    v_lshlrev_b32 v46, 16, v107
    v_and_b32 v47, 0xffff0000, v107
    v_lshlrev_b32 v48, 16, v108
    v_and_b32 v49, 0xffff0000, v108
    v_lshlrev_b32 v50, 16, v109
    v_and_b32 v51, 0xffff0000, v109
    v_lshlrev_b32 v52, 16, v110
    v_and_b32 v53, 0xffff0000, v110
    v_lshlrev_b32 v54, 16, v111
    v_and_b32 v55, 0xffff0000, v111
    v_mov_b32 v14, 0
    v_fma_f32 v56, v176, v33, -v32
    v_fma_f32 v56, v56, v128, v144
    v_cvt_pk_bf16_f32 v56, v56, v56
    v_lshlrev_b32 v56, 16, v56
    v_fmac_f32 v14, v56, v40
    v_mul_f32 v192, v56, v160
    v_cvt_pk_bf16_f32 v192, v192, v192
    v_lshlrev_b32 v192, 16, v192
    v_add_f32 v192, v192, v176
    v_fma_f32 v57, v177, v33, -v32
    v_fma_f32 v57, v57, v129, v145
    v_cvt_pk_bf16_f32 v57, v57, v57
    v_lshlrev_b32 v57, 16, v57
    v_fmac_f32 v14, v57, v41
    v_mul_f32 v193, v57, v161
    v_cvt_pk_bf16_f32 v193, v193, v193
    v_lshlrev_b32 v193, 16, v193
    v_add_f32 v193, v193, v177
    v_fma_f32 v58, v178, v33, -v32
    v_fma_f32 v58, v58, v130, v146
    v_cvt_pk_bf16_f32 v58, v58, v58
    v_lshlrev_b32 v58, 16, v58
    v_fmac_f32 v14, v58, v42
    v_mul_f32 v194, v58, v162
    v_cvt_pk_bf16_f32 v194, v194, v194
    v_lshlrev_b32 v194, 16, v194
    v_add_f32 v194, v194, v178
    v_fma_f32 v59, v179, v33, -v32
    v_fma_f32 v59, v59, v131, v147
    v_cvt_pk_bf16_f32 v59, v59, v59
    v_lshlrev_b32 v59, 16, v59
    v_fmac_f32 v14, v59, v43
    v_mul_f32 v195, v59, v163
    v_cvt_pk_bf16_f32 v195, v195, v195
    v_lshlrev_b32 v195, 16, v195
    v_add_f32 v195, v195, v179
    v_fma_f32 v60, v180, v33, -v32
    v_fma_f32 v60, v60, v132, v148
    v_cvt_pk_bf16_f32 v60, v60, v60
    v_lshlrev_b32 v60, 16, v60
    v_fmac_f32 v14, v60, v44
    v_mul_f32 v196, v60, v164
    v_cvt_pk_bf16_f32 v196, v196, v196
    v_lshlrev_b32 v196, 16, v196
    v_add_f32 v196, v196, v180
    v_fma_f32 v61, v181, v33, -v32
    v_fma_f32 v61, v61, v133, v149
    v_cvt_pk_bf16_f32 v61, v61, v61
    v_lshlrev_b32 v61, 16, v61
    v_fmac_f32 v14, v61, v45
    v_mul_f32 v197, v61, v165
    v_cvt_pk_bf16_f32 v197, v197, v197
    v_lshlrev_b32 v197, 16, v197
    v_add_f32 v197, v197, v181
    v_fma_f32 v62, v182, v33, -v32
    v_fma_f32 v62, v62, v134, v150
    v_cvt_pk_bf16_f32 v62, v62, v62
    v_lshlrev_b32 v62, 16, v62
    v_fmac_f32 v14, v62, v46
    v_mul_f32 v198, v62, v166
    v_cvt_pk_bf16_f32 v198, v198, v198
    v_lshlrev_b32 v198, 16, v198
    v_add_f32 v198, v198, v182
    v_fma_f32 v63, v183, v33, -v32
    v_fma_f32 v63, v63, v135, v151
    v_cvt_pk_bf16_f32 v63, v63, v63
    v_lshlrev_b32 v63, 16, v63
    v_fmac_f32 v14, v63, v47
    v_mul_f32 v199, v63, v167
    v_cvt_pk_bf16_f32 v199, v199, v199
    v_lshlrev_b32 v199, 16, v199
    v_add_f32 v199, v199, v183
    v_fma_f32 v64, v184, v33, -v32
    v_fma_f32 v64, v64, v136, v152
    v_cvt_pk_bf16_f32 v64, v64, v64
    v_lshlrev_b32 v64, 16, v64
    v_fmac_f32 v14, v64, v48
    v_mul_f32 v200, v64, v168
    v_cvt_pk_bf16_f32 v200, v200, v200
    v_lshlrev_b32 v200, 16, v200
    v_add_f32 v200, v200, v184
    v_fma_f32 v65, v185, v33, -v32
    v_fma_f32 v65, v65, v137, v153
    v_cvt_pk_bf16_f32 v65, v65, v65
    v_lshlrev_b32 v65, 16, v65
    v_fmac_f32 v14, v65, v49
    v_mul_f32 v201, v65, v169
    v_cvt_pk_bf16_f32 v201, v201, v201
    v_lshlrev_b32 v201, 16, v201
    v_add_f32 v201, v201, v185
    v_fma_f32 v66, v186, v33, -v32
    v_fma_f32 v66, v66, v138, v154
    v_cvt_pk_bf16_f32 v66, v66, v66
    v_lshlrev_b32 v66, 16, v66
    v_fmac_f32 v14, v66, v50
    v_mul_f32 v202, v66, v170
    v_cvt_pk_bf16_f32 v202, v202, v202
    v_lshlrev_b32 v202, 16, v202
    v_add_f32 v202, v202, v186
    v_fma_f32 v67, v187, v33, -v32
    v_fma_f32 v67, v67, v139, v155
    v_cvt_pk_bf16_f32 v67, v67, v67
    v_lshlrev_b32 v67, 16, v67
    v_fmac_f32 v14, v67, v51
    v_mul_f32 v203, v67, v171
    v_cvt_pk_bf16_f32 v203, v203, v203
    v_lshlrev_b32 v203, 16, v203
    v_add_f32 v203, v203, v187
    v_fma_f32 v68, v188, v33, -v32
    v_fma_f32 v68, v68, v140, v156
    v_cvt_pk_bf16_f32 v68, v68, v68
    v_lshlrev_b32 v68, 16, v68
    v_fmac_f32 v14, v68, v52
    v_mul_f32 v204, v68, v172
    v_cvt_pk_bf16_f32 v204, v204, v204
    v_lshlrev_b32 v204, 16, v204
    v_add_f32 v204, v204, v188
    v_fma_f32 v69, v189, v33, -v32
    v_fma_f32 v69, v69, v141, v157
    v_cvt_pk_bf16_f32 v69, v69, v69
    v_lshlrev_b32 v69, 16, v69
    v_fmac_f32 v14, v69, v53
    v_mul_f32 v205, v69, v173
    v_cvt_pk_bf16_f32 v205, v205, v205
    v_lshlrev_b32 v205, 16, v205
    v_add_f32 v205, v205, v189
    v_fma_f32 v70, v190, v33, -v32
    v_fma_f32 v70, v70, v142, v158
    v_cvt_pk_bf16_f32 v70, v70, v70
    v_lshlrev_b32 v70, 16, v70
    v_fmac_f32 v14, v70, v54
    v_mul_f32 v206, v70, v174
    v_cvt_pk_bf16_f32 v206, v206, v206
    v_lshlrev_b32 v206, 16, v206
    v_add_f32 v206, v206, v190
    v_fma_f32 v71, v191, v33, -v32
    v_fma_f32 v71, v71, v143, v159
    v_cvt_pk_bf16_f32 v71, v71, v71
    v_lshlrev_b32 v71, 16, v71
    v_fmac_f32 v14, v71, v55
    v_mul_f32 v207, v71, v175
    v_cvt_pk_bf16_f32 v207, v207, v207
    v_lshlrev_b32 v207, 16, v207
    v_add_f32 v207, v207, v191
    s_nop 1
    v_add_f32_dpp v14, v14, v14 row_ror:8 row_mask:0xf bank_mask:0xf
    v_mov_b32 v17, v14
    s_nop 1
    v_permlane16_swap_b32 v14, v17
    s_nop 1
    v_add_f32 v14, v14, v17
    v_mov_b32 v17, v14
    s_nop 1
    v_permlane32_swap_b32 v14, v17
    s_nop 1
    v_add_f32 v14, v14, v17
    ds_write_b32 v13, v14 offset:4096
    v_cvt_pk_bf16_f32 v72, v192, v193
    v_cvt_pk_bf16_f32 v80, v56, v57
    v_cvt_pk_bf16_f32 v88, v176, v177
    v_cvt_pk_bf16_f32 v73, v194, v195
    v_cvt_pk_bf16_f32 v81, v58, v59
    v_cvt_pk_bf16_f32 v89, v178, v179
    v_cvt_pk_bf16_f32 v74, v196, v197
    v_cvt_pk_bf16_f32 v82, v60, v61
    v_cvt_pk_bf16_f32 v90, v180, v181
    v_cvt_pk_bf16_f32 v75, v198, v199
    v_cvt_pk_bf16_f32 v83, v62, v63
    v_cvt_pk_bf16_f32 v91, v182, v183
    v_cvt_pk_bf16_f32 v76, v200, v201
    v_cvt_pk_bf16_f32 v84, v64, v65
    v_cvt_pk_bf16_f32 v92, v184, v185
    v_cvt_pk_bf16_f32 v77, v202, v203
    v_cvt_pk_bf16_f32 v85, v66, v67
    v_cvt_pk_bf16_f32 v93, v186, v187
    v_cvt_pk_bf16_f32 v78, v204, v205
    v_cvt_pk_bf16_f32 v86, v68, v69
    v_cvt_pk_bf16_f32 v94, v188, v189
    v_cvt_pk_bf16_f32 v79, v206, v207
    v_cvt_pk_bf16_f32 v87, v70, v71
    v_cvt_pk_bf16_f32 v95, v190, v191
    s_mov_b32 s20, 262144
    s_mov_b32 s21, 2359296
    buffer_store_dwordx4 v[72:75], v6, s[16:19], 0 offen sc0 sc1
    buffer_store_dwordx4 v[76:79], v7, s[16:19], 0 offen sc0 sc1
    buffer_store_dwordx4 v[80:83], v6, s[12:15], s20 offen sc0 sc1
    buffer_store_dwordx4 v[84:87], v7, s[12:15], s20 offen sc0 sc1
    buffer_store_dwordx4 v[88:91], v6, s[12:15], s21 offen sc0 sc1
    buffer_store_dwordx4 v[92:95], v7, s[12:15], s21 offen sc0 sc1
    s_waitcnt lgkmcnt(0) vmcnt(0)
    s_barrier
    v_cmp_gt_u32 vcc, 8, v0
    s_and_saveexec_b64 s[24:25], vcc
    s_cbranch_execz K2_P2
    s_nop 0
    ds_read_b32 v96, v16 offset:4096
    ds_read_b32 v97, v16 offset:4160
    ds_read_b32 v98, v16 offset:4224
    ds_read_b32 v99, v16 offset:4288
    s_waitcnt lgkmcnt(0)
    v_add_f32 v96, v96, v97
    v_add_f32 v96, v96, v98
    v_add_f32 v96, v96, v99
    v_cvt_pk_bf16_f32 v96, v96, v96
    v_lshlrev_b32 v96, 16, v96
    v_ashrrev_i32 v97, 31, v96
    v_or_b32 v97, 0x80000000, v97
    v_xor_b32 v96, v96, v97
    v_and_b32 v96, 0xffff0000, v96
    v_sub_u32 v97, 0x87ff, v5
    v_or_b32 v96, v96, v97
    s_nop 1
    v_readlane_b32 s26, v96, 0
    v_readlane_b32 s27, v96, 1
    s_nop 3
    s_max_u32 s26, s26, s27
    v_readlane_b32 s27, v96, 2
    s_nop 3
    s_max_u32 s26, s26, s27
    v_readlane_b32 s27, v96, 3
    s_nop 3
    s_max_u32 s26, s26, s27
    v_readlane_b32 s27, v96, 4
    s_nop 3
    s_max_u32 s26, s26, s27
    v_readlane_b32 s27, v96, 5
    s_nop 3
    s_max_u32 s26, s26, s27
    v_readlane_b32 s27, v96, 6
    s_nop 3
    s_max_u32 s26, s26, s27
    v_readlane_b32 s27, v96, 7
    s_nop 3
    s_max_u32 s26, s26, s27
    v_cmp_eq_u32 vcc, 0, v0
    s_and_b64 exec, exec, vcc
    v_mov_b32 v96, s26
    s_lshl_b32 s27, s2, 2
    s_add_u32 s27, s27, 16384
    v_mov_b32 v97, 0
    buffer_store_dword v96, v97, s[12:15], s27 offen sc0 sc1
K2_P2:
    s_mov_b64 exec, -1
    s_cmp_ge_u32 s2, 56
    s_cbranch_scc1 K2_END
    s_and_b32 s24, s2, 7
    s_mul_i32 s24, s24, 7
    s_lshr_b32 s2, s2, 3
    s_add_u32 s2, s2, s24
    v_and_b32 v20, 3, v0
    v_lshrrev_b32 v21, 2, v0
    v_mul_u32_u24 v22, 7*3584, v21
    v_lshl_add_u32 v22, v20, 4, v22
    v_mul_u32_u24 v25, 7*896, v0
    s_lshl_b32 s24, s2, 6
    s_lshl_b32 s25, s2, 4
    buffer_load_dwordx4 v[32:35], v22, s[40:43], s24 offen
    buffer_load_dwordx4 v[60:63], v22, s[44:47], s24 offen
    buffer_load_dwordx4 v[88:91], v25, s[48:51], s25 offen
    s_add_u32 s24, s24, 3584
    s_add_u32 s25, s25, 896
    buffer_load_dwordx4 v[36:39], v22, s[40:43], s24 offen
    buffer_load_dwordx4 v[64:67], v22, s[44:47], s24 offen
    buffer_load_dwordx4 v[92:95], v25, s[48:51], s25 offen
    s_add_u32 s24, s24, 3584
    s_add_u32 s25, s25, 896
    buffer_load_dwordx4 v[40:43], v22, s[40:43], s24 offen
    buffer_load_dwordx4 v[68:71], v22, s[44:47], s24 offen
    buffer_load_dwordx4 v[96:99], v25, s[48:51], s25 offen
    s_add_u32 s24, s24, 3584
    s_add_u32 s25, s25, 896
    buffer_load_dwordx4 v[44:47], v22, s[40:43], s24 offen
    buffer_load_dwordx4 v[72:75], v22, s[44:47], s24 offen
    buffer_load_dwordx4 v[100:103], v25, s[48:51], s25 offen
    s_add_u32 s24, s24, 3584
    s_add_u32 s25, s25, 896
    buffer_load_dwordx4 v[48:51], v22, s[40:43], s24 offen
    buffer_load_dwordx4 v[76:79], v22, s[44:47], s24 offen
    buffer_load_dwordx4 v[104:107], v25, s[48:51], s25 offen
    s_add_u32 s24, s24, 3584
    s_add_u32 s25, s25, 896
    buffer_load_dwordx4 v[52:55], v22, s[40:43], s24 offen
    buffer_load_dwordx4 v[80:83], v22, s[44:47], s24 offen
    buffer_load_dwordx4 v[108:111], v25, s[48:51], s25 offen
    s_add_u32 s24, s24, 3584
    s_add_u32 s25, s25, 896
    buffer_load_dwordx4 v[56:59], v22, s[40:43], s24 offen
    buffer_load_dwordx4 v[84:87], v22, s[44:47], s24 offen
    buffer_load_dwordx4 v[112:115], v25, s[48:51], s25 offen
    s_add_u32 s24, s24, 3584
    s_add_u32 s25, s25, 896
    v_and_b32 v26, 7, v0
    v_lshlrev_b32 v23, 2, v26
    s_lshl_b32 s25, s2, 5
    s_add_u32 s24, s25, 8960
    buffer_load_dword v116, v23, s[12:15], s24 offen
    v_and_b32 v2, 63, v0
    v_lshlrev_b32 v2, 4, v2
    s_mov_b32 s24, 16384
K2_SPIN:
    buffer_load_dwordx4 v[4:7], v2, s[12:15], s24 offen sc0 sc1
    s_waitcnt vmcnt(0)
    v_and_b32 v8, v4, v5
    v_and_b32 v9, v6, v7
    v_and_b32 v8, v8, v9
    v_and_b32 v8, 0x8000, v8
    v_cmp_ne_u32 vcc, 0, v8
    s_nop 3
    s_cmp_eq_u64 vcc, -1
    s_cbranch_scc1 K2_GO
    s_sleep 1
    s_branch K2_SPIN
K2_GO:
    v_max3_u32 v4, v4, v5, v6
    v_max_u32 v4, v4, v7
    v_mov_b32 v5, v4
    s_nop 1
    v_permlane32_swap_b32 v4, v5
    s_nop 1
    v_max_u32 v4, v4, v5
    v_mov_b32 v5, v4
    s_nop 1
    v_permlane16_swap_b32 v4, v5
    s_nop 1
    v_max_u32 v4, v4, v5
    s_nop 1
    v_max_u32_dpp v4, v4, v4 row_ror:8 row_mask:0xf bank_mask:0xf
    s_nop 1
    v_max_u32_dpp v4, v4, v4 row_ror:4 row_mask:0xf bank_mask:0xf
    s_nop 1
    v_max_u32_dpp v4, v4, v4 row_ror:2 row_mask:0xf bank_mask:0xf
    s_nop 1
    v_max_u32_dpp v4, v4, v4 row_ror:1 row_mask:0xf bank_mask:0xf
    s_nop 1
    v_readfirstlane_b32 s30, v4
    s_nop 3
    s_and_b32 s31, s30, 0x7ff
    s_sub_u32 s31, 2047, s31
    s_mul_i32 s32, s31, 896
    s_add_u32 s33, s32, 262144
    v_mul_u32_u24 v27, 14, v21
    buffer_load_ushort v12, v27, s[12:15], s33 offen offset:0 sc0 sc1
    buffer_load_ushort v13, v27, s[12:15], s33 offen offset:2 sc0 sc1
    buffer_load_ushort v14, v27, s[12:15], s33 offen offset:4 sc0 sc1
    buffer_load_ushort v15, v27, s[12:15], s33 offen offset:6 sc0 sc1
    buffer_load_ushort v16, v27, s[12:15], s33 offen offset:8 sc0 sc1
    buffer_load_ushort v17, v27, s[12:15], s33 offen offset:10 sc0 sc1
    buffer_load_ushort v18, v27, s[12:15], s33 offen offset:12 sc0 sc1
    s_lshl_b32 s25, s2, 4
    s_add_u32 s32, s32, s25
    s_add_u32 s33, s33, s25
    s_add_u32 s34, s32, 2359296
    v_lshlrev_b32 v24, 1, v26
    buffer_load_ushort v117, v24, s[12:15], s33 offen sc0 sc1
    buffer_load_ushort v118, v24, s[12:15], s34 offen sc0 sc1
    s_mov_b32 s35, 0xffff0000
    v_mov_b32 v128, 0
    v_mov_b32 v129, 0
    v_mov_b32 v130, 0
    v_mov_b32 v131, 0
    v_mov_b32 v132, 0
    v_mov_b32 v133, 0
    v_mov_b32 v134, 0
    v_mov_b32 v135, 0
    v_mov_b32 v136, 0
    v_mov_b32 v137, 0
    v_mov_b32 v138, 0
    v_mov_b32 v139, 0
    v_mov_b32 v140, 0
    v_mov_b32 v141, 0
    v_mov_b32 v142, 0
    v_mov_b32 v143, 0
    s_waitcnt vmcnt(2)
    v_lshlrev_b32 v12, 16, v12
    v_lshlrev_b32 v120, 16, v32
    v_and_b32 v121, s35, v32
    v_fmac_f32 v128, v120, v12
    v_fmac_f32 v129, v121, v12
    v_lshlrev_b32 v120, 16, v33
    v_and_b32 v121, s35, v33
    v_fmac_f32 v130, v120, v12
    v_fmac_f32 v131, v121, v12
    v_lshlrev_b32 v120, 16, v34
    v_and_b32 v121, s35, v34
    v_fmac_f32 v132, v120, v12
    v_fmac_f32 v133, v121, v12
    v_lshlrev_b32 v120, 16, v35
    v_and_b32 v121, s35, v35
    v_fmac_f32 v134, v120, v12
    v_fmac_f32 v135, v121, v12
    v_lshlrev_b32 v120, 16, v60
    v_and_b32 v121, s35, v60
    v_fmac_f32 v136, v120, v12
    v_fmac_f32 v137, v121, v12
    v_lshlrev_b32 v120, 16, v61
    v_and_b32 v121, s35, v61
    v_fmac_f32 v138, v120, v12
    v_fmac_f32 v139, v121, v12
    v_lshlrev_b32 v120, 16, v62
    v_and_b32 v121, s35, v62
    v_fmac_f32 v140, v120, v12
    v_fmac_f32 v141, v121, v12
    v_lshlrev_b32 v120, 16, v63
    v_and_b32 v121, s35, v63
    v_fmac_f32 v142, v120, v12
    v_fmac_f32 v143, v121, v12
    v_lshlrev_b32 v13, 16, v13
    v_lshlrev_b32 v120, 16, v36
    v_and_b32 v121, s35, v36
    v_fmac_f32 v128, v120, v13
    v_fmac_f32 v129, v121, v13
    v_lshlrev_b32 v120, 16, v37
    v_and_b32 v121, s35, v37
    v_fmac_f32 v130, v120, v13
    v_fmac_f32 v131, v121, v13
    v_lshlrev_b32 v120, 16, v38
    v_and_b32 v121, s35, v38
    v_fmac_f32 v132, v120, v13
    v_fmac_f32 v133, v121, v13
    v_lshlrev_b32 v120, 16, v39
    v_and_b32 v121, s35, v39
    v_fmac_f32 v134, v120, v13
    v_fmac_f32 v135, v121, v13
    v_lshlrev_b32 v120, 16, v64
    v_and_b32 v121, s35, v64
    v_fmac_f32 v136, v120, v13
    v_fmac_f32 v137, v121, v13
    v_lshlrev_b32 v120, 16, v65
    v_and_b32 v121, s35, v65
    v_fmac_f32 v138, v120, v13
    v_fmac_f32 v139, v121, v13
    v_lshlrev_b32 v120, 16, v66
    v_and_b32 v121, s35, v66
    v_fmac_f32 v140, v120, v13
    v_fmac_f32 v141, v121, v13
    v_lshlrev_b32 v120, 16, v67
    v_and_b32 v121, s35, v67
    v_fmac_f32 v142, v120, v13
    v_fmac_f32 v143, v121, v13
    v_lshlrev_b32 v14, 16, v14
    v_lshlrev_b32 v120, 16, v40
    v_and_b32 v121, s35, v40
    v_fmac_f32 v128, v120, v14
    v_fmac_f32 v129, v121, v14
    v_lshlrev_b32 v120, 16, v41
    v_and_b32 v121, s35, v41
    v_fmac_f32 v130, v120, v14
    v_fmac_f32 v131, v121, v14
    v_lshlrev_b32 v120, 16, v42
    v_and_b32 v121, s35, v42
    v_fmac_f32 v132, v120, v14
    v_fmac_f32 v133, v121, v14
    v_lshlrev_b32 v120, 16, v43
    v_and_b32 v121, s35, v43
    v_fmac_f32 v134, v120, v14
    v_fmac_f32 v135, v121, v14
    v_lshlrev_b32 v120, 16, v68
    v_and_b32 v121, s35, v68
    v_fmac_f32 v136, v120, v14
    v_fmac_f32 v137, v121, v14
    v_lshlrev_b32 v120, 16, v69
    v_and_b32 v121, s35, v69
    v_fmac_f32 v138, v120, v14
    v_fmac_f32 v139, v121, v14
    v_lshlrev_b32 v120, 16, v70
    v_and_b32 v121, s35, v70
    v_fmac_f32 v140, v120, v14
    v_fmac_f32 v141, v121, v14
    v_lshlrev_b32 v120, 16, v71
    v_and_b32 v121, s35, v71
    v_fmac_f32 v142, v120, v14
    v_fmac_f32 v143, v121, v14
    v_lshlrev_b32 v15, 16, v15
    v_lshlrev_b32 v120, 16, v44
    v_and_b32 v121, s35, v44
    v_fmac_f32 v128, v120, v15
    v_fmac_f32 v129, v121, v15
    v_lshlrev_b32 v120, 16, v45
    v_and_b32 v121, s35, v45
    v_fmac_f32 v130, v120, v15
    v_fmac_f32 v131, v121, v15
    v_lshlrev_b32 v120, 16, v46
    v_and_b32 v121, s35, v46
    v_fmac_f32 v132, v120, v15
    v_fmac_f32 v133, v121, v15
    v_lshlrev_b32 v120, 16, v47
    v_and_b32 v121, s35, v47
    v_fmac_f32 v134, v120, v15
    v_fmac_f32 v135, v121, v15
    v_lshlrev_b32 v120, 16, v72
    v_and_b32 v121, s35, v72
    v_fmac_f32 v136, v120, v15
    v_fmac_f32 v137, v121, v15
    v_lshlrev_b32 v120, 16, v73
    v_and_b32 v121, s35, v73
    v_fmac_f32 v138, v120, v15
    v_fmac_f32 v139, v121, v15
    v_lshlrev_b32 v120, 16, v74
    v_and_b32 v121, s35, v74
    v_fmac_f32 v140, v120, v15
    v_fmac_f32 v141, v121, v15
    v_lshlrev_b32 v120, 16, v75
    v_and_b32 v121, s35, v75
    v_fmac_f32 v142, v120, v15
    v_fmac_f32 v143, v121, v15
    v_lshlrev_b32 v16, 16, v16
    v_lshlrev_b32 v120, 16, v48
    v_and_b32 v121, s35, v48
    v_fmac_f32 v128, v120, v16
    v_fmac_f32 v129, v121, v16
    v_lshlrev_b32 v120, 16, v49
    v_and_b32 v121, s35, v49
    v_fmac_f32 v130, v120, v16
    v_fmac_f32 v131, v121, v16
    v_lshlrev_b32 v120, 16, v50
    v_and_b32 v121, s35, v50
    v_fmac_f32 v132, v120, v16
    v_fmac_f32 v133, v121, v16
    v_lshlrev_b32 v120, 16, v51
    v_and_b32 v121, s35, v51
    v_fmac_f32 v134, v120, v16
    v_fmac_f32 v135, v121, v16
    v_lshlrev_b32 v120, 16, v76
    v_and_b32 v121, s35, v76
    v_fmac_f32 v136, v120, v16
    v_fmac_f32 v137, v121, v16
    v_lshlrev_b32 v120, 16, v77
    v_and_b32 v121, s35, v77
    v_fmac_f32 v138, v120, v16
    v_fmac_f32 v139, v121, v16
    v_lshlrev_b32 v120, 16, v78
    v_and_b32 v121, s35, v78
    v_fmac_f32 v140, v120, v16
    v_fmac_f32 v141, v121, v16
    v_lshlrev_b32 v120, 16, v79
    v_and_b32 v121, s35, v79
    v_fmac_f32 v142, v120, v16
    v_fmac_f32 v143, v121, v16
    v_lshlrev_b32 v17, 16, v17
    v_lshlrev_b32 v120, 16, v52
    v_and_b32 v121, s35, v52
    v_fmac_f32 v128, v120, v17
    v_fmac_f32 v129, v121, v17
    v_lshlrev_b32 v120, 16, v53
    v_and_b32 v121, s35, v53
    v_fmac_f32 v130, v120, v17
    v_fmac_f32 v131, v121, v17
    v_lshlrev_b32 v120, 16, v54
    v_and_b32 v121, s35, v54
    v_fmac_f32 v132, v120, v17
    v_fmac_f32 v133, v121, v17
    v_lshlrev_b32 v120, 16, v55
    v_and_b32 v121, s35, v55
    v_fmac_f32 v134, v120, v17
    v_fmac_f32 v135, v121, v17
    v_lshlrev_b32 v120, 16, v80
    v_and_b32 v121, s35, v80
    v_fmac_f32 v136, v120, v17
    v_fmac_f32 v137, v121, v17
    v_lshlrev_b32 v120, 16, v81
    v_and_b32 v121, s35, v81
    v_fmac_f32 v138, v120, v17
    v_fmac_f32 v139, v121, v17
    v_lshlrev_b32 v120, 16, v82
    v_and_b32 v121, s35, v82
    v_fmac_f32 v140, v120, v17
    v_fmac_f32 v141, v121, v17
    v_lshlrev_b32 v120, 16, v83
    v_and_b32 v121, s35, v83
    v_fmac_f32 v142, v120, v17
    v_fmac_f32 v143, v121, v17
    v_lshlrev_b32 v18, 16, v18
    v_lshlrev_b32 v120, 16, v56
    v_and_b32 v121, s35, v56
    v_fmac_f32 v128, v120, v18
    v_fmac_f32 v129, v121, v18
    v_lshlrev_b32 v120, 16, v57
    v_and_b32 v121, s35, v57
    v_fmac_f32 v130, v120, v18
    v_fmac_f32 v131, v121, v18
    v_lshlrev_b32 v120, 16, v58
    v_and_b32 v121, s35, v58
    v_fmac_f32 v132, v120, v18
    v_fmac_f32 v133, v121, v18
    v_lshlrev_b32 v120, 16, v59
    v_and_b32 v121, s35, v59
    v_fmac_f32 v134, v120, v18
    v_fmac_f32 v135, v121, v18
    v_lshlrev_b32 v120, 16, v84
    v_and_b32 v121, s35, v84
    v_fmac_f32 v136, v120, v18
    v_fmac_f32 v137, v121, v18
    v_lshlrev_b32 v120, 16, v85
    v_and_b32 v121, s35, v85
    v_fmac_f32 v138, v120, v18
    v_fmac_f32 v139, v121, v18
    v_lshlrev_b32 v120, 16, v86
    v_and_b32 v121, s35, v86
    v_fmac_f32 v140, v120, v18
    v_fmac_f32 v141, v121, v18
    v_lshlrev_b32 v120, 16, v87
    v_and_b32 v121, s35, v87
    v_fmac_f32 v142, v120, v18
    v_fmac_f32 v143, v121, v18
    v_lshlrev_b32 v28, 8, v21
    v_lshl_add_u32 v28, v20, 5, v28
    ds_write_b128 v28, v[128:131]
    ds_write_b128 v28, v[132:135] offset:16
    ds_write_b128 v28, v[136:139] offset:128
    ds_write_b128 v28, v[140:143] offset:144
    s_waitcnt lgkmcnt(0)
    s_barrier
    v_and_b32 v29, 63, v0
    v_lshrrev_b32 v30, 6, v0
    v_lshlrev_b32 v31, 12, v30
    v_lshl_add_u32 v31, v29, 2, v31
    ds_read_b32 v128, v31 offset:0
    ds_read_b32 v129, v31 offset:256
    ds_read_b32 v130, v31 offset:512
    ds_read_b32 v131, v31 offset:768
    ds_read_b32 v132, v31 offset:1024
    ds_read_b32 v133, v31 offset:1280
    ds_read_b32 v134, v31 offset:1536
    ds_read_b32 v135, v31 offset:1792
    ds_read_b32 v136, v31 offset:2048
    ds_read_b32 v137, v31 offset:2304
    ds_read_b32 v138, v31 offset:2560
    ds_read_b32 v139, v31 offset:2816
    ds_read_b32 v140, v31 offset:3072
    ds_read_b32 v141, v31 offset:3328
    ds_read_b32 v142, v31 offset:3584
    ds_read_b32 v143, v31 offset:3840
    s_waitcnt lgkmcnt(0)
    v_add_f32 v128, v128, v129
    v_add_f32 v128, v128, v130
    v_add_f32 v128, v128, v131
    v_add_f32 v128, v128, v132
    v_add_f32 v128, v128, v133
    v_add_f32 v128, v128, v134
    v_add_f32 v128, v128, v135
    v_add_f32 v128, v128, v136
    v_add_f32 v128, v128, v137
    v_add_f32 v128, v128, v138
    v_add_f32 v128, v128, v139
    v_add_f32 v128, v128, v140
    v_add_f32 v128, v128, v141
    v_add_f32 v128, v128, v142
    v_add_f32 v128, v128, v143
    v_lshlrev_b32 v31, 2, v0
    ds_write_b32 v31, v128 offset:16384
    s_waitcnt lgkmcnt(0)
    s_barrier
    v_cmp_gt_u32 vcc, 32, v0
    s_and_saveexec_b64 s[26:27], vcc
    s_cbranch_execz K3_PUB
    ds_read_b32 v128, v31 offset:16384
    ds_read_b32 v132, v31 offset:16512
    ds_read_b32 v129, v31 offset:16640
    ds_read_b32 v133, v31 offset:16768
    ds_read_b32 v130, v31 offset:16896
    ds_read_b32 v134, v31 offset:17024
    ds_read_b32 v131, v31 offset:17152
    ds_read_b32 v135, v31 offset:17280
    s_waitcnt lgkmcnt(0)
    v_add_f32 v128, v128, v129
    v_add_f32 v132, v132, v133
    v_add_f32 v128, v128, v130
    v_add_f32 v132, v132, v134
    v_add_f32 v128, v128, v131
    v_add_f32 v132, v132, v135
    v_cvt_pk_bf16_f32 v128, v128, v128
    v_lshlrev_b32 v128, 16, v128
    v_cvt_pk_bf16_f32 v132, v132, v132
    v_lshlrev_b32 v132, 16, v132
    v_mul_f32 v129, 0xbfb8aa3b, v128
    v_exp_f32 v129, v129
    s_nop 0
    v_add_f32 v129, 1.0, v129
    v_rcp_f32 v129, v129
    s_nop 0
    v_mul_f32 v128, v128, v129
    v_cvt_pk_bf16_f32 v128, v128, v128
    v_lshlrev_b32 v128, 16, v128
    v_mul_f32 v128, v128, v132
    v_cvt_pk_bf16_f32 v128, v128, v128
    v_lshlrev_b32 v128, 16, v128
    v_or_b32 v128, 1, v128
    s_lshl_b32 s25, s2, 7
    s_add_u32 s25, s25, 17408
    buffer_store_dword v128, v31, s[12:15], s25 offen sc0 sc1
K3_PUB:
    s_mov_b64 exec, -1
    v_mul_u32_u24 v2, 28, v0
    s_mov_b32 s24, 17408
    s_and_b32 s36, s30, 0xffff0000
    s_cmp_lt_i32 s36, 0
    s_cbranch_scc1 K4_POS
    s_not_b32 s36, s36
    s_and_b32 s36, s36, 0xffff0000
    s_branch K4_RD
K4_POS:
    s_and_b32 s36, s36, 0x7fffffff
K4_RD:
    v_mov_b32 v16, s36
    v_mul_f32 v16, 0xbfb8aa3b, v16
    v_exp_f32 v16, v16
    s_nop 0
    v_add_f32 v16, 1.0, v16
    v_rcp_f32 v16, v16
    s_nop 0
    v_cvt_pk_bf16_f32 v16, v16, v16
    v_lshlrev_b32 v16, 16, v16
K3_SPIN:
    buffer_load_dwordx4 v[4:7], v2, s[12:15], s24 offen sc0 sc1
    buffer_load_dwordx3 v[8:10], v2, s[12:15], s24 offen offset:16 sc0 sc1
    s_waitcnt vmcnt(0)
    v_and_b32 v11, v4, v5
    v_and_b32 v12, v6, v7
    v_and_b32 v13, v8, v9
    v_and_b32 v11, v11, v12
    v_and_b32 v13, v13, v10
    v_and_b32 v11, v11, v13
    v_and_b32 v11, 1, v11
    v_cmp_ne_u32 vcc, 0, v11
    s_nop 3
    s_cmp_eq_u64 vcc, -1
    s_cbranch_scc1 K3_GO
    s_sleep 1
    s_branch K3_SPIN
K3_GO:
    v_mov_b32 v128, 0
    v_mov_b32 v129, 0
    v_mov_b32 v130, 0
    v_mov_b32 v131, 0
    v_mov_b32 v132, 0
    v_mov_b32 v133, 0
    v_mov_b32 v134, 0
    v_mov_b32 v135, 0
    v_and_b32 v4, s35, v4
    v_lshlrev_b32 v120, 16, v88
    v_and_b32 v121, s35, v88
    v_fmac_f32 v128, v120, v4
    v_fmac_f32 v129, v121, v4
    v_lshlrev_b32 v120, 16, v89
    v_and_b32 v121, s35, v89
    v_fmac_f32 v130, v120, v4
    v_fmac_f32 v131, v121, v4
    v_lshlrev_b32 v120, 16, v90
    v_and_b32 v121, s35, v90
    v_fmac_f32 v132, v120, v4
    v_fmac_f32 v133, v121, v4
    v_lshlrev_b32 v120, 16, v91
    v_and_b32 v121, s35, v91
    v_fmac_f32 v134, v120, v4
    v_fmac_f32 v135, v121, v4
    v_and_b32 v5, s35, v5
    v_lshlrev_b32 v120, 16, v92
    v_and_b32 v121, s35, v92
    v_fmac_f32 v128, v120, v5
    v_fmac_f32 v129, v121, v5
    v_lshlrev_b32 v120, 16, v93
    v_and_b32 v121, s35, v93
    v_fmac_f32 v130, v120, v5
    v_fmac_f32 v131, v121, v5
    v_lshlrev_b32 v120, 16, v94
    v_and_b32 v121, s35, v94
    v_fmac_f32 v132, v120, v5
    v_fmac_f32 v133, v121, v5
    v_lshlrev_b32 v120, 16, v95
    v_and_b32 v121, s35, v95
    v_fmac_f32 v134, v120, v5
    v_fmac_f32 v135, v121, v5
    v_and_b32 v6, s35, v6
    v_lshlrev_b32 v120, 16, v96
    v_and_b32 v121, s35, v96
    v_fmac_f32 v128, v120, v6
    v_fmac_f32 v129, v121, v6
    v_lshlrev_b32 v120, 16, v97
    v_and_b32 v121, s35, v97
    v_fmac_f32 v130, v120, v6
    v_fmac_f32 v131, v121, v6
    v_lshlrev_b32 v120, 16, v98
    v_and_b32 v121, s35, v98
    v_fmac_f32 v132, v120, v6
    v_fmac_f32 v133, v121, v6
    v_lshlrev_b32 v120, 16, v99
    v_and_b32 v121, s35, v99
    v_fmac_f32 v134, v120, v6
    v_fmac_f32 v135, v121, v6
    v_and_b32 v7, s35, v7
    v_lshlrev_b32 v120, 16, v100
    v_and_b32 v121, s35, v100
    v_fmac_f32 v128, v120, v7
    v_fmac_f32 v129, v121, v7
    v_lshlrev_b32 v120, 16, v101
    v_and_b32 v121, s35, v101
    v_fmac_f32 v130, v120, v7
    v_fmac_f32 v131, v121, v7
    v_lshlrev_b32 v120, 16, v102
    v_and_b32 v121, s35, v102
    v_fmac_f32 v132, v120, v7
    v_fmac_f32 v133, v121, v7
    v_lshlrev_b32 v120, 16, v103
    v_and_b32 v121, s35, v103
    v_fmac_f32 v134, v120, v7
    v_fmac_f32 v135, v121, v7
    v_and_b32 v8, s35, v8
    v_lshlrev_b32 v120, 16, v104
    v_and_b32 v121, s35, v104
    v_fmac_f32 v128, v120, v8
    v_fmac_f32 v129, v121, v8
    v_lshlrev_b32 v120, 16, v105
    v_and_b32 v121, s35, v105
    v_fmac_f32 v130, v120, v8
    v_fmac_f32 v131, v121, v8
    v_lshlrev_b32 v120, 16, v106
    v_and_b32 v121, s35, v106
    v_fmac_f32 v132, v120, v8
    v_fmac_f32 v133, v121, v8
    v_lshlrev_b32 v120, 16, v107
    v_and_b32 v121, s35, v107
    v_fmac_f32 v134, v120, v8
    v_fmac_f32 v135, v121, v8
    v_and_b32 v9, s35, v9
    v_lshlrev_b32 v120, 16, v108
    v_and_b32 v121, s35, v108
    v_fmac_f32 v128, v120, v9
    v_fmac_f32 v129, v121, v9
    v_lshlrev_b32 v120, 16, v109
    v_and_b32 v121, s35, v109
    v_fmac_f32 v130, v120, v9
    v_fmac_f32 v131, v121, v9
    v_lshlrev_b32 v120, 16, v110
    v_and_b32 v121, s35, v110
    v_fmac_f32 v132, v120, v9
    v_fmac_f32 v133, v121, v9
    v_lshlrev_b32 v120, 16, v111
    v_and_b32 v121, s35, v111
    v_fmac_f32 v134, v120, v9
    v_fmac_f32 v135, v121, v9
    v_and_b32 v10, s35, v10
    v_lshlrev_b32 v120, 16, v112
    v_and_b32 v121, s35, v112
    v_fmac_f32 v128, v120, v10
    v_fmac_f32 v129, v121, v10
    v_lshlrev_b32 v120, 16, v113
    v_and_b32 v121, s35, v113
    v_fmac_f32 v130, v120, v10
    v_fmac_f32 v131, v121, v10
    v_lshlrev_b32 v120, 16, v114
    v_and_b32 v121, s35, v114
    v_fmac_f32 v132, v120, v10
    v_fmac_f32 v133, v121, v10
    v_lshlrev_b32 v120, 16, v115
    v_and_b32 v121, s35, v115
    v_fmac_f32 v134, v120, v10
    v_fmac_f32 v135, v121, v10
    v_lshlrev_b32 v31, 5, v0
    ds_write_b128 v31, v[128:131]
    ds_write_b128 v31, v[132:135] offset:16
    s_waitcnt lgkmcnt(0)
    s_barrier
    v_cmp_gt_u32 vcc, 64, v0
    s_and_saveexec_b64 s[26:27], vcc
    s_cbranch_execz K2_END
    v_lshlrev_b32 v31, 2, v0
    ds_read_b32 v32, v31 offset:0
    ds_read_b32 v33, v31 offset:256
    ds_read_b32 v34, v31 offset:512
    ds_read_b32 v35, v31 offset:768
    ds_read_b32 v36, v31 offset:1024
    ds_read_b32 v37, v31 offset:1280
    ds_read_b32 v38, v31 offset:1536
    ds_read_b32 v39, v31 offset:1792
    ds_read_b32 v40, v31 offset:2048
    ds_read_b32 v41, v31 offset:2304
    ds_read_b32 v42, v31 offset:2560
    ds_read_b32 v43, v31 offset:2816
    ds_read_b32 v44, v31 offset:3072
    ds_read_b32 v45, v31 offset:3328
    ds_read_b32 v46, v31 offset:3584
    ds_read_b32 v47, v31 offset:3840
    ds_read_b32 v48, v31 offset:4096
    ds_read_b32 v49, v31 offset:4352
    ds_read_b32 v50, v31 offset:4608
    ds_read_b32 v51, v31 offset:4864
    ds_read_b32 v52, v31 offset:5120
    ds_read_b32 v53, v31 offset:5376
    ds_read_b32 v54, v31 offset:5632
    ds_read_b32 v55, v31 offset:5888
    ds_read_b32 v56, v31 offset:6144
    ds_read_b32 v57, v31 offset:6400
    ds_read_b32 v58, v31 offset:6656
    ds_read_b32 v59, v31 offset:6912
    ds_read_b32 v60, v31 offset:7168
    ds_read_b32 v61, v31 offset:7424
    ds_read_b32 v62, v31 offset:7680
    ds_read_b32 v63, v31 offset:7936
    s_waitcnt lgkmcnt(0)
    v_add_f32 v32, v32, v33
    v_add_f32 v32, v32, v34
    v_add_f32 v32, v32, v35
    v_add_f32 v32, v32, v36
    v_add_f32 v32, v32, v37
    v_add_f32 v32, v32, v38
    v_add_f32 v32, v32, v39
    v_add_f32 v32, v32, v40
    v_add_f32 v32, v32, v41
    v_add_f32 v32, v32, v42
    v_add_f32 v32, v32, v43
    v_add_f32 v32, v32, v44
    v_add_f32 v32, v32, v45
    v_add_f32 v32, v32, v46
    v_add_f32 v32, v32, v47
    v_add_f32 v32, v32, v48
    v_add_f32 v32, v32, v49
    v_add_f32 v32, v32, v50
    v_add_f32 v32, v32, v51
    v_add_f32 v32, v32, v52
    v_add_f32 v32, v32, v53
    v_add_f32 v32, v32, v54
    v_add_f32 v32, v32, v55
    v_add_f32 v32, v32, v56
    v_add_f32 v32, v32, v57
    v_add_f32 v32, v32, v58
    v_add_f32 v32, v32, v59
    v_add_f32 v32, v32, v60
    v_add_f32 v32, v32, v61
    v_add_f32 v32, v32, v62
    v_add_f32 v32, v32, v63
    v_mov_b32 v33, v32
    s_nop 1
    v_permlane32_swap_b32 v32, v33
    s_nop 1
    v_add_f32 v32, v32, v33
    v_mov_b32 v33, v32
    s_nop 1
    v_permlane16_swap_b32 v32, v33
    s_nop 1
    v_add_f32 v32, v32, v33
    s_nop 1
    v_add_f32_dpp v32, v32, v32 row_ror:8 row_mask:0xf bank_mask:0xf
    v_cmp_gt_u32 vcc, 8, v0
    s_and_b64 exec, exec, vcc
    v_cvt_pk_bf16_f32 v32, v32, v32
    v_lshlrev_b32 v32, 16, v32
    v_mul_f32 v32, v32, v16
    v_cvt_pk_bf16_f32 v32, v32, v32
    v_lshlrev_b32 v32, 16, v32
    v_lshlrev_b32 v117, 16, v117
    v_lshlrev_b32 v118, 16, v118
    v_add_f32 v32, v32, v117
    v_cvt_pk_bf16_f32 v32, v32, v32
    v_lshlrev_b32 v32, 16, v32
    v_mul_f32 v32, v32, v116
    v_cvt_pk_bf16_f32 v32, v32, v32
    v_lshlrev_b32 v32, 16, v32
    v_add_f32 v32, v32, v118
    v_cvt_pk_bf16_f32 v32, v32, v32
    buffer_store_short v32, v24, s[16:19], s32 offen sc0 sc1
K2_END:
    s_endpgm
.section .rodata,"a"
.p2align 6
.amdhsa_kernel adaLN_cond__gqa_block_cached__moe_arch_mod__prompt_kernel
  .amdhsa_next_free_vgpr 512
  .amdhsa_next_free_sgpr 102
  .amdhsa_accum_offset 256
  .amdhsa_group_segment_fixed_size 0
  .amdhsa_kernarg_size 120
  .amdhsa_user_sgpr_count 2
  .amdhsa_user_sgpr_kernarg_segment_ptr 1
  .amdhsa_system_sgpr_workgroup_id_x 1
.end_amdhsa_kernel
.p2align 6
.amdhsa_kernel k2_kernel
  .amdhsa_next_free_vgpr 208
  .amdhsa_next_free_sgpr 102
  .amdhsa_accum_offset 208
  .amdhsa_group_segment_fixed_size 0
  .amdhsa_kernarg_size 120
  .amdhsa_user_sgpr_count 2
  .amdhsa_user_sgpr_kernarg_segment_ptr 1
  .amdhsa_system_sgpr_workgroup_id_x 1
.end_amdhsa_kernel
```
